```python
import torch

def _softmax(x, axis=-1):
    return torch.softmax(x, dim=axis)

def _gelu(x):
    return torch.nn.functional.gelu(x, approximate='tanh')

def _silu(x):
    return torch.nn.functional.silu(x)

def _sigmoid(x):
    return torch.sigmoid(x)

def _layernorm(x, axis=-1, eps=1e-05):
    m = x.mean(dim=axis, keepdim=True)
    v = x.var(dim=axis, keepdim=True, unbiased=False)
    return (x - m) / torch.sqrt(v + eps)

def _scatter_add(tgt, idx, src, axis=0):
    return tgt.clone().index_add_(axis, idx, src)

def _segment_sum(src, seg, n):
    out = torch.zeros((n,) + src.shape[1:], dtype=src.dtype)
    return out.index_add_(0, seg, src)

def _pad(x, pw):
    flat = tuple((v for pair in reversed(pw) for v in pair))
    return torch.nn.functional.pad(x, flat)
kernel_name = 'gated_mix__memory_aug_recurrent_mem_tr__moe_arch_mod__prompt'

def setup_inputs():

    _w = lambda a: (lambda t: t.to(torch.bfloat16) if t.is_floating_point() else t)(torch.as_tensor(a))

    def _A_setup():
        B, S, Dm = (1, 2048, 576)
        H, Dh = (32, 128)
        M, seg = (8, 32)
        seg = min(seg, S)
        S = S // seg * seg
        return {'x': _w((lambda *s: torch.randn(*s, dtype=torch.bfloat16) * 0.05)(B, S, Dm)), 'mem0': _w((lambda *s: torch.randn(*s, dtype=torch.bfloat16) * 0.8)(B, M, Dm)), 'Wq': _w((lambda *s: torch.randn(*s, dtype=torch.bfloat16) * 3.2)(Dm, H, Dh) * Dm ** (-0.5)), 'Wk': _w((lambda *s: torch.randn(*s, dtype=torch.bfloat16) * 3.2)(Dm, H, Dh) * Dm ** (-0.5)), 'Wv': _w((lambda *s: torch.randn(*s, dtype=torch.bfloat16) * 0.8)(Dm, H, Dh) * Dm ** (-0.5)), 'Wo': _w((lambda *s: torch.randn(*s, dtype=torch.bfloat16) * 0.8)(H, Dh, Dm) * (H * Dh) ** (-0.5)), 'seg_len': seg}
    _A_in = _A_setup()

    def _B_setup():
        B, S, D, F, C = (1, 2048, 576, 4608, 8)
        return {'x': _w((lambda *s: torch.randn(*s, dtype=torch.bfloat16) * 0.05)(B, S, D)), 'w_r': _w((lambda *s: torch.randn(*s, dtype=torch.bfloat16) * 3.2)(D)), 'w_gate': _w((lambda *s: torch.randn(*s, dtype=torch.bfloat16) * 0.1)(D, F)), 'w_up': _w((lambda *s: torch.randn(*s, dtype=torch.bfloat16) * 0.1)(D, F)), 'w_down': _w((lambda *s: torch.randn(*s, dtype=torch.bfloat16) * 0.1)(F, D))}
    _B_in = _B_setup()
    return {'A_x': _A_in['x'], 'A_mem0': _A_in['mem0'], 'A_Wq': _A_in['Wq'], 'A_Wk': _A_in['Wk'], 'A_Wv': _A_in['Wv'], 'A_Wo': _A_in['Wo'], 'A_seg_len': _A_in['seg_len'], 'B_x': _B_in['x'], 'B_w_r': _B_in['w_r'], 'B_w_gate': _B_in['w_gate'], 'B_w_up': _B_in['w_up'], 'B_w_down': _B_in['w_down'], 'gate_w': _w((lambda *s: torch.randn(*s, dtype=torch.bfloat16) * 0.05)(576) * 16.0)}

def reference(A_x, A_mem0, A_Wq, A_Wk, A_Wv, A_Wo, A_seg_len, B_x, B_w_r, B_w_gate, B_w_up, B_w_down, gate_w):

    def _A_ref(x, mem0, Wq, Wk, Wv, Wo, seg_len):
        B, S, Dm = x.shape
        H, Dh = (Wq.shape[1], Wq.shape[2])
        M = mem0.shape[1]
        scale = Dh ** (-0.5)
        n_seg = S // seg_len
        L = M + seg_len
        idx = torch.arange(L)
        mask = (idx[:, None] < M) | (idx[:, None] >= idx[None, :])
        mem = mem0
        outs = []
        for s in range(n_seg):
            xs = x[:, s * seg_len:(s + 1) * seg_len, :].clone()
            h = torch.concatenate([mem, xs], axis=1)
            q = torch.einsum('btd,dhe->bhte', h, Wq)
            k = torch.einsum('btd,dhe->bhte', h, Wk)
            v = torch.einsum('btd,dhe->bhte', h, Wv)
            scores = torch.einsum('bhqe,bhke->bhqk', q, k) * scale
            scores = torch.where(mask[None, None], scores, -1000000000.0)
            p = _softmax(scores, axis=-1)
            o = torch.einsum('bhqk,bhke->bhqe', p, v)
            o = torch.einsum('bhte,hed->btd', o, Wo)
            mem = o[:, :M, :].clone()
            outs.append(o[:, M:, :])
        return torch.concatenate(outs, axis=1)

    def _B_ref(x, w_r, w_gate, w_up, w_down):
        B, S, D = x.shape
        C = 8
        r = x @ w_r
        idx = torch.argsort(-r, axis=-1)[:, :C]
        idx_e = (lambda x, n, axis: torch.repeat_interleave(x, n, dim=axis))(idx.reshape(B, C, 1), D, axis=2)
        x_sel = (lambda x, i, axis: torch.take_along_dim(x, i, dim=axis))(x, idx_e, axis=1)
        g = _silu(x_sel @ w_gate)
        u = x_sel @ w_up
        y = g * u @ w_down
        r_sel = _sigmoid((lambda x, i, axis: torch.take_along_dim(x, i, dim=axis))(r, idx, axis=1))
        y = y * r_sel.reshape(B, C, 1)
        b_off = (torch.arange(B) * S).reshape(B, 1)
        flat_idx = (idx + b_off).reshape(B * C)
        zero = (x * 0.0).reshape(B * S, D)
        upd = _scatter_add(zero, flat_idx, y.reshape(B * C, D), axis=0)
        return x + upd.reshape(B, S, D)
    x = A_x
    g = _sigmoid((x * gate_w).sum(-1, keepdims=True))
    a = _A_ref(x, A_mem0, A_Wq, A_Wk, A_Wv, A_Wo, A_seg_len)
    b = _B_ref(x, B_w_r, B_w_gate, B_w_up, B_w_down)
    return g * a + (1 - g) * b
```

```asm
; @launch grid=(256,1,1) block=(256,1,1) lds=163840
.amdgcn_target "amdgcn-amd-amdhsa--gfx950"
.text
.globl gated_mix__memory_aug_recurrent_mem_tr__moe_arch_mod__prompt_kernel
.p2align 8
.type gated_mix__memory_aug_recurrent_mem_tr__moe_arch_mod__prompt_kernel,@function
gated_mix__memory_aug_recurrent_mem_tr__moe_arch_mod__prompt_kernel:
  s_cmp_ge_u32 s2, 256
  s_cbranch_scc1 L_end
  s_load_dwordx16 s[64:79], s[0:1], 0
  s_load_dwordx16 s[80:95], s[0:1], 64
  s_waitcnt lgkmcnt(0)
  s_mov_b32 s4, s94
  s_mov_b32 s5, s95
  s_mov_b32 s6, 0x10000000
  s_mov_b32 s7, 0x20000
  s_mov_b32 s8, s92
  s_mov_b32 s9, s93
  s_mov_b32 s10, 0x100
  s_mov_b32 s11, 0x20000
  v_lshrrev_b32 v1, 6, v0
  v_and_b32 v0, 63, v0
  v_readfirstlane_b32 s30, v1
  s_getreg_b32 s33, hwreg(HW_REG_XCC_ID)
  s_and_b32 s33, s33, 7
  s_mov_b32 s31, 2097152
  v_mov_b32 v3, 0
  s_lshl_b32 s33, s33, 2
  s_lshr_b32 s33, 0x43210765, s33
  s_and_b32 s33, s33, 7
  s_cmp_lg_u32 s30, 0
  s_cbranch_scc1 L_claimed
  s_mov_b32 s34, 0
L_claim:
  s_add_u32 s35, s33, s34
  s_and_b32 s35, s35, 7
  s_lshl_b32 s36, s35, 2
  s_cselect_b32 s36, s36, 128
  v_lshl_add_u32 v1, v0, 8, s36
  v_mov_b32 v2, 1
  buffer_atomic_add v2, v1, s[8:11], 0 offen sc0
  s_waitcnt vmcnt(0)
  v_readfirstlane_b32 s36, v2
  s_nop 0
  s_cmp_lt_u32 s36, 32
  s_cbranch_scc1 L_got
  s_add_u32 s34, s34, 1
  s_cmp_lt_u32 s34, 8
  s_cbranch_scc1 L_claim
  s_mov_b32 s35, 8
  s_mov_b32 s36, 0
L_got:
  s_lshl_b32 s35, s35, 8
  s_or_b32 s35, s35, s36
  s_lshl_b32 s34, s34, 16
  s_or_b32 s35, s35, s34
  v_mov_b32 v2, s35
  ds_write_b32 v3, v2
  s_waitcnt lgkmcnt(0)
L_claimed:
  s_barrier
  ds_read_b32 v2, v3
  s_waitcnt lgkmcnt(0)
  v_readfirstlane_b32 s33, v2
  s_nop 0
  s_and_b32 s29, s33, 0xff
  s_bfe_u32 s28, s33, 0x80008
  s_lshr_b32 s32, s33, 16
  s_min_u32 s32, s32, 1
  s_barrier
  s_cmp_eq_u32 s28, 0
  s_cbranch_scc1 L_chain
  s_cmp_lt_u32 s28, 5
  s_cbranch_scc1 L_pa
  s_cmp_ge_u32 s28, 8
  s_cbranch_scc1 L_exit
  s_cmp_lt_u32 s29, 18
  s_cbranch_scc1 L_o
  s_cmp_lt_u32 s29, 30
  s_cbranch_scc1 L_mod
  s_branch L_init
L_exit:
L_end:
  s_endpgm
L_chain:
  s_mov_b32 s12, s68
  s_mov_b32 s13, s69
  s_mov_b32 s14, 0x480000
  s_mov_b32 s15, 0x20000
  s_mov_b32 s16, s70
  s_mov_b32 s17, s71
  s_mov_b32 s18, 0x480000
  s_mov_b32 s19, 0x20000
  s_mov_b32 s20, s72
  s_mov_b32 s21, s73
  s_mov_b32 s22, 0x480000
  s_mov_b32 s23, 0x20000
  s_mov_b32 s24, s74
  s_mov_b32 s25, s75
  s_mov_b32 s26, 0x480000
  s_mov_b32 s27, 0x20000
  s_xor_b32 s34, s29, 0
  v_mov_b32 v79, v0
  v_and_b32 v78, 15, v79
  v_lshrrev_b32 v77, 4, v79
  v_lshlrev_b32 v0, 4, v79
  s_lshl_b32 s78, s34, 8
  s_lshr_b32 s37, s30, 1
  s_mul_i32 s39, s37, 73728
  s_add_u32 s39, s39, 20480
  s_and_b32 s33, s30, 1
  s_lshl_b32 s36, s33, 12
  s_add_u32 s36, s36, s39
  s_lshl_b32 s33, s33, 5
  v_lshrrev_b32 v47, 3, v79
  v_add_u32 v47, s33, v47
  v_bfe_u32 v76, v79, 4, 1
  v_lshlrev_b32 v76, 1, v76
  v_and_b32 v75, 7, v79
  v_xor_b32 v76, v76, v75
  v_mul_u32_u24 v40, 8192, v47
  v_lshl_add_u32 v40, v76, 4, v40
  s_lshr_b32 s33, s30, 1
  s_lshl_b32 s33, s33, 7
  s_add_u32 s33, s33, s78
  v_add_u32 v40, s33, v40
  v_xor_b32 v41, 64, v40
  s_mul_i32 s78, s34, 147456
  v_bfe_u32 v76, v79, 5, 1
  v_lshlrev_b32 v76, 2, v76
  v_and_b32 v75, 7, v79
  v_xor_b32 v76, v76, v75
  v_mul_u32_u24 v42, 1152, v47
  v_lshl_add_u32 v42, v76, 4, v42
  s_lshr_b32 s33, s30, 1
  s_lshl_b32 s33, s33, 7
  s_add_u32 s33, s33, s78
  v_add_u32 v42, s33, v42
  s_add_u32 m0, s36, 0
  s_mov_b32 s37, 0x0
  buffer_load_dwordx4 v40, s[16:19], s37 offen  lds
  s_add_u32 m0, s36, 1024
  s_mov_b32 s37, 0x10000
  buffer_load_dwordx4 v41, s[16:19], s37 offen  lds
  s_add_u32 m0, s36, 2048
  s_mov_b32 s37, 0x20000
  buffer_load_dwordx4 v40, s[16:19], s37 offen  lds
  s_add_u32 m0, s36, 3072
  s_mov_b32 s37, 0x30000
  buffer_load_dwordx4 v41, s[16:19], s37 offen  lds
  s_add_u32 m0, s36, 8192
  s_mov_b32 s37, 0x0
  buffer_load_dwordx4 v40, s[20:23], s37 offen  lds
  s_add_u32 m0, s36, 9216
  s_mov_b32 s37, 0x10000
  buffer_load_dwordx4 v41, s[20:23], s37 offen  lds
  s_add_u32 m0, s36, 10240
  s_mov_b32 s37, 0x20000
  buffer_load_dwordx4 v40, s[20:23], s37 offen  lds
  s_add_u32 m0, s36, 11264
  s_mov_b32 s37, 0x30000
  buffer_load_dwordx4 v41, s[20:23], s37 offen  lds
  s_add_u32 m0, s36, 16384
  s_mov_b32 s37, 0x80000
  buffer_load_dwordx4 v40, s[16:19], s37 offen  lds
  s_add_u32 m0, s36, 17408
  s_mov_b32 s37, 0x90000
  buffer_load_dwordx4 v41, s[16:19], s37 offen  lds
  s_add_u32 m0, s36, 18432
  s_mov_b32 s37, 0xa0000
  buffer_load_dwordx4 v40, s[16:19], s37 offen  lds
  s_add_u32 m0, s36, 19456
  s_mov_b32 s37, 0xb0000
  buffer_load_dwordx4 v41, s[16:19], s37 offen  lds
  s_lshl_b32 s37, s32, 16
  s_add_u32 s37, s37, 1
  v_mov_b32 v16, s37
  s_lshl_b32 s37, s30, 6
  v_add_u32 v50, s37, v79
  v_lshlrev_b32 v50, 8, v50
  buffer_atomic_add v16, v50, s[8:11], 0 offen offset:192
  v_lshrrev_b32 v76, 2, v78
  v_lshl_add_u32 v75, v77, 3, v76
  v_lshlrev_b32 v75, 7, v75
  v_and_b32 v74, 3, v78
  v_lshl_add_u32 v75, v74, 3, v75
  v_lshrrev_b32 v76, 1, v76
  v_and_b32 v74, 1, v77
  v_lshl_add_u32 v76, v74, 1, v76
  s_and_b32 s33, s30, 1
  s_lshl_b32 s33, s33, 1
  v_xor_b32 v76, s33, v76
  v_lshl_add_u32 v75, v76, 5, v75
  v_add_u32 v43, s39, v75
  v_xor_b32 v44, 32, v43
  v_lshlrev_b32 v46, 4, v79
  v_add_u32 v46, s36, v46
  v_lshrrev_b32 v76, 1, v79
  v_mul_u32_u24 v48, 1152, v76
  v_and_b32 v75, 1, v79
  v_lshl_add_u32 v48, v75, 4, v48
  s_lshl_b32 s33, s30, 5
  s_add_u32 s37, s78, s33
  s_add_u32 s37, s37, 1024
  v_add_u32 v48, s37, v48
  s_and_b32 s33, s30, 1
  s_mul_i32 s78, s33, 69632
  s_add_u32 s78, s78, s39
  s_sub_u32 s78, s78, 4096
  s_lshl_b32 s37, s33, 13
  s_add_u32 s37, s37, s39
  s_sub_u32 s37, s37, 4096
  v_add_u32 v2, s37, v0
  v_and_b32 v74, 1, v77
  v_lshlrev_b32 v74, 4, v74
  v_lshrrev_b32 v76, 1, v77
  v_lshl_add_u32 v74, v76, 3, v74
  v_lshrrev_b32 v76, 3, v78
  v_lshl_add_u32 v74, v76, 2, v74
  v_bfe_u32 v76, v78, 2, 1
  v_add_u32 v74, v74, v76
  v_lshlrev_b32 v76, 5, v74
  v_and_b32 v75, 3, v78
  v_lshl_add_u32 v49, v75, 3, v76
  v_add_u32 v49, s78, v49
  v_bfe_u32 v76, v74, 2, 1
  s_and_b32 s33, s30, 1
  v_xor_b32 v76, s33, v76
  v_lshlrev_b32 v76, 6, v76
  v_lshl_add_u32 v76, v74, 7, v76
  v_and_b32 v75, 3, v78
  v_lshl_add_u32 v76, v75, 4, v76
  v_add_u32 v45, s39, v76
  s_add_u32 m0, s78, 0
  s_mov_b32 s37, 0
  buffer_load_dwordx4 v48, s[24:27], s37 offen lds
  s_add_u32 m0, s78, 1024
  s_mov_b32 s37, 36864
  buffer_load_dwordx4 v48, s[24:27], s37 offen lds
  s_add_u32 m0, s78, 2048
  s_mov_b32 s37, 73728
  buffer_load_dwordx4 v48, s[24:27], s37 offen lds
  s_add_u32 m0, s78, 3072
  s_mov_b32 s37, 110592
  buffer_load_dwordx4 v48, s[24:27], s37 offen lds
  s_add_u32 m0, s36, 24576
  s_mov_b32 s37, 0x100
  buffer_load_dwordx4 v42, s[24:27], s37 offen  lds
  s_add_u32 m0, s36, 25600
  s_mov_b32 s37, 0x2500
  buffer_load_dwordx4 v42, s[24:27], s37 offen  lds
  s_add_u32 m0, s36, 26624
  s_mov_b32 s37, 0x4900
  buffer_load_dwordx4 v42, s[24:27], s37 offen  lds
  s_add_u32 m0, s36, 27648
  s_mov_b32 s37, 0x6d00
  buffer_load_dwordx4 v42, s[24:27], s37 offen  lds
  s_add_u32 m0, s36, 32768
  s_mov_b32 s37, 0x80000
  buffer_load_dwordx4 v40, s[20:23], s37 offen  lds
  s_add_u32 m0, s36, 33792
  s_mov_b32 s37, 0x90000
  buffer_load_dwordx4 v41, s[20:23], s37 offen  lds
  s_add_u32 m0, s36, 34816
  s_mov_b32 s37, 0xa0000
  buffer_load_dwordx4 v40, s[20:23], s37 offen  lds
  s_add_u32 m0, s36, 35840
  s_mov_b32 s37, 0xb0000
  buffer_load_dwordx4 v41, s[20:23], s37 offen  lds
  s_add_u32 m0, s36, 40960
  s_mov_b32 s37, 0x100000
  buffer_load_dwordx4 v40, s[16:19], s37 offen  lds
  s_add_u32 m0, s36, 41984
  s_mov_b32 s37, 0x110000
  buffer_load_dwordx4 v41, s[16:19], s37 offen  lds
  s_add_u32 m0, s36, 43008
  s_mov_b32 s37, 0x120000
  buffer_load_dwordx4 v40, s[16:19], s37 offen  lds
  s_add_u32 m0, s36, 44032
  s_mov_b32 s37, 0x130000
  buffer_load_dwordx4 v41, s[16:19], s37 offen  lds
  s_add_u32 m0, s36, 49152
  s_mov_b32 s37, 0x100000
  buffer_load_dwordx4 v40, s[20:23], s37 offen  lds
  s_add_u32 m0, s36, 50176
  s_mov_b32 s37, 0x110000
  buffer_load_dwordx4 v41, s[20:23], s37 offen  lds
  s_add_u32 m0, s36, 51200
  s_mov_b32 s37, 0x120000
  buffer_load_dwordx4 v40, s[20:23], s37 offen  lds
  s_add_u32 m0, s36, 52224
  s_mov_b32 s37, 0x130000
  buffer_load_dwordx4 v41, s[20:23], s37 offen  lds
  s_add_u32 m0, s36, 57344
  s_mov_b32 s37, 0x12100
  buffer_load_dwordx4 v42, s[24:27], s37 offen  lds
  s_add_u32 m0, s36, 58368
  s_mov_b32 s37, 0x14500
  buffer_load_dwordx4 v42, s[24:27], s37 offen  lds
  s_add_u32 m0, s36, 59392
  s_mov_b32 s37, 0x16900
  buffer_load_dwordx4 v42, s[24:27], s37 offen  lds
  s_add_u32 m0, s36, 60416
  s_mov_b32 s37, 0x18d00
  buffer_load_dwordx4 v42, s[24:27], s37 offen  lds
  s_waitcnt vmcnt(33) lgkmcnt(0)
  s_barrier
  ds_read_b64_tr_b16 a[0:1], v43 offset:0
  ds_read_b64_tr_b16 a[2:3], v43 offset:512
  ds_read_b64_tr_b16 a[4:5], v43 offset:4096
  ds_read_b64_tr_b16 a[6:7], v43 offset:4608
  ds_read_b64_tr_b16 a[8:9], v44 offset:0
  ds_read_b64_tr_b16 a[10:11], v44 offset:512
  ds_read_b64_tr_b16 a[12:13], v44 offset:4096
  ds_read_b64_tr_b16 a[14:15], v44 offset:4608
  s_lshl_b32 s53, s30, 5
  s_add_u32 s53, s53, s34
  s_lshl_b32 s53, s53, 6
  s_lshr_b32 s54, s34, 1
  s_add_u32 s54, s54, 128
  s_lshl_b32 s54, s54, 6
  s_and_b32 s38, s34, 1
  v_mov_b32 v11, -1
  v_mov_b32 v1, 0x4444
  v_mov_b32 v76, 0xeeee
  v_and_b32 v75, 2, v79
  v_cmp_ne_u32 vcc, 0, v75
  s_nop 1
  v_cndmask_b32 v1, v1, v76, vcc
  v_lshrrev_b32 v76, 3, v78
  v_lshl_add_u32 v76, v76, 2, v77
  v_lshlrev_b32 v76, 11, v76
  v_and_b32 v75, 7, v78
  v_lshl_add_u32 v3, v75, 3, v76
  s_lshl_b32 s37, s30, 14
  s_lshl_b32 s33, s34, 6
  s_add_u32 s37, s37, s33
  v_add_u32 v3, s37, v3
  v_and_b32 v76, 8, v78
  v_and_b32 v75, 3, v78
  v_lshl_add_u32 v76, v75, 1, v76
  v_bfe_u32 v75, v78, 2, 1
  v_add_u32 v76, v76, v75
  v_lshlrev_b32 v76, 2, v76
  v_lshl_add_u32 v4, v77, 11, v76
  s_lshl_b32 s37, s30, 13
  s_add_u32 s37, s37, s33
  s_add_u32 s37, s37, 262144
  v_add_u32 v4, s37, v4
  v_and_b32 v76, 1, v78
  v_lshl_add_u32 v76, v76, 1, v77
  v_lshlrev_b32 v76, 4, v76
  v_bfe_u32 v75, v78, 1, 1
  v_lshl_add_u32 v5, v75, 3, v76
  v_and_b32 v76, 0x2c, v79
  v_mov_b32 v75, 0x40000000
  v_cmp_eq_u32 vcc, 0, v76
  s_nop 1
  v_cndmask_b32 v5, v75, v5, vcc
  v_and_b32 v76, 1, v79
  v_cmp_eq_u32 vcc, 0, v76
  s_nop 1
  v_cndmask_b32 v10, 0, 1, vcc
  v_lshlrev_b32 v76, 3, v79
  v_and_b32 v75, 32, v79
  v_lshlrev_b32 v75, 1, v75
  v_xor_b32 v7, v76, v75
  v_lshrrev_b32 v76, 2, v79
  v_lshlrev_b32 v76, 3, v76
  v_and_b32 v75, 2, v79
  v_lshlrev_b32 v75, 5, v75
  v_xor_b32 v76, v76, v75
  v_and_b32 v75, 3, v79
  v_lshl_add_u32 v8, v75, 7, v76
  v_mov_b64 v[16:17], 0
  v_mov_b64 v[18:19], 0
  ds_write_b128 v0, v[16:19] offset:15360
  v_mov_b32 v75, 0x38000
  v_and_b32 v76, 13, v78
  v_and_b32 v74, 1, v77
  v_lshl_add_u32 v76, v74, 1, v76
  v_lshrrev_b32 v74, 1, v77
  v_lshl_add_u32 v76, v74, 4, v76
  v_lshlrev_b32 v9, 4, v76
  v_and_b32 v76, 2, v78
  v_cmp_ne_u32 vcc, 0, v76
  s_nop 1
  v_cndmask_b32 v9, v75, v9, vcc
  s_mov_b32 s70, 0x3e0293ee
  s_waitcnt vmcnt(29) lgkmcnt(0)
  s_barrier
  ds_read_b64_tr_b16 a[16:17], v43 offset:8192
  ds_read_b64_tr_b16 a[18:19], v43 offset:8704
  ds_read_b64_tr_b16 a[20:21], v43 offset:12288
  ds_read_b64_tr_b16 a[22:23], v43 offset:12800
  ds_read_b64_tr_b16 a[24:25], v44 offset:8192
  ds_read_b64_tr_b16 a[26:27], v44 offset:8704
  ds_read_b64_tr_b16 a[28:29], v44 offset:12288
  ds_read_b64_tr_b16 a[30:31], v44 offset:12800
  s_add_u32 m0, s36, 0
  s_mov_b32 s37, 0x180000
  buffer_load_dwordx4 v40, s[16:19], s37 offen  lds
  s_add_u32 m0, s36, 1024
  s_mov_b32 s37, 0x190000
  buffer_load_dwordx4 v41, s[16:19], s37 offen  lds
  s_add_u32 m0, s36, 2048
  s_mov_b32 s37, 0x1a0000
  buffer_load_dwordx4 v40, s[16:19], s37 offen  lds
  s_add_u32 m0, s36, 3072
  s_mov_b32 s37, 0x1b0000
  buffer_load_dwordx4 v41, s[16:19], s37 offen  lds
  s_mov_b32 s60, 0xf0f0f0f0
  s_mov_b32 s61, 0xf0f0f0f0
  s_mov_b32 s62, 0x110011
  s_mov_b32 s63, 0x110011
  s_mov_b32 s64, 0x440044
  s_mov_b32 s65, 0x440044
  s_mov_b32 s66, 0x220022
  s_mov_b32 s67, 0x220022
  s_mov_b32 s68, 0x880088
  s_mov_b32 s69, 0x880088
  s_mov_b32 s72, 0xcccccccc
  s_mov_b32 s73, 0xcccccccc
  s_cmp_eq_u32 s38, 0
  s_cselect_b64 s[46:47], -1, 0
  s_mov_b32 s35, 0
  s_mov_b32 s71, 0x58000
  s_lshl_b32 s3, s34, 2
  s_add_u32 s3, s3, s71
  s_lshl_b32 s38, s34, 1
  s_add_u32 s38, s38, 0x58080
  s_and_b32 s37, s34, 3
  s_lshl_b32 s37, s37, 8
  s_add_u32 s71, s71, s37
  s_mov_b32 s48, 3145728
  s_lshl_b32 s37, s30, 10
  s_add_u32 s74, s37, 3149824
  s_mov_b32 s75, 3153920
  s_lshl_b32 s55, s34, 14
  s_lshl_b32 s37, s30, 12
  s_add_u32 s55, s55, s37
  s_add_u32 s55, s55, 0x1000000
  s_lshl_b32 s58, s34, 8
  s_add_u32 s58, s58, 0x60000
  s_add_u32 s57, s53, 0x1f0000
  s_add_u32 s59, s54, 0x1f0000
  s_mov_b32 s77, 74752
  s_mov_b32 s40, 0
  s_mov_b32 s41, 0x10000
  s_mov_b32 s42, 0x20000
  s_mov_b32 s43, 0x30000
  s_lshl_b32 s44, s53, 5
  s_lshl_b32 s45, s54, 5
  s_mov_b32 s56, 524288
  s_mul_i32 s51, s34, 384
  s_add_u32 s51, s51, 3164160
  s_waitcnt vmcnt(29) lgkmcnt(0)
  s_barrier
  ds_read_b64_tr_b16 a[48:49], v43 offset:16384
  ds_read_b64_tr_b16 a[50:51], v43 offset:16896
  ds_read_b64_tr_b16 a[52:53], v43 offset:20480
  ds_read_b64_tr_b16 a[54:55], v43 offset:20992
  ds_read_b64_tr_b16 a[56:57], v44 offset:16384
  ds_read_b64_tr_b16 a[58:59], v44 offset:16896
  ds_read_b64_tr_b16 a[60:61], v44 offset:20480
  ds_read_b64_tr_b16 a[62:63], v44 offset:20992
  s_add_u32 m0, s36, 8192
  s_mov_b32 s37, 0x180000
  buffer_load_dwordx4 v40, s[20:23], s37 offen  lds
  s_add_u32 m0, s36, 9216
  s_mov_b32 s37, 0x190000
  buffer_load_dwordx4 v41, s[20:23], s37 offen  lds
  s_add_u32 m0, s36, 10240
  s_mov_b32 s37, 0x1a0000
  buffer_load_dwordx4 v40, s[20:23], s37 offen  lds
  s_add_u32 m0, s36, 11264
  s_mov_b32 s37, 0x1b0000
  buffer_load_dwordx4 v41, s[20:23], s37 offen  lds
  s_waitcnt vmcnt(24) lgkmcnt(0)
  s_barrier
  ds_read_b64_tr_b16 v[176:177], v45 offset:24576
  ds_read_b64_tr_b16 v[178:179], v45 offset:24832
  ds_read_b64_tr_b16 v[180:181], v45 offset:28672
  ds_read_b64_tr_b16 v[182:183], v45 offset:28928
  ds_read_b64_tr_b16 v[184:185], v45 offset:24584
  ds_read_b64_tr_b16 v[186:187], v45 offset:24840
  ds_read_b64_tr_b16 v[188:189], v45 offset:28680
  ds_read_b64_tr_b16 v[190:191], v45 offset:28936
  s_add_u32 m0, s36, 16384
  s_mov_b32 s37, 0x200000
  buffer_load_dwordx4 v40, s[16:19], s37 offen  lds
  s_add_u32 m0, s36, 17408
  s_mov_b32 s37, 0x210000
  buffer_load_dwordx4 v41, s[16:19], s37 offen  lds
  s_add_u32 m0, s36, 18432
  s_mov_b32 s37, 0x220000
  buffer_load_dwordx4 v40, s[16:19], s37 offen  lds
  s_add_u32 m0, s36, 19456
  s_mov_b32 s37, 0x230000
  buffer_load_dwordx4 v41, s[16:19], s37 offen  lds
  s_waitcnt vmcnt(24) lgkmcnt(0)
  s_barrier
  ds_read_b64_tr_b16 a[64:65], v43 offset:32768
  ds_read_b64_tr_b16 a[66:67], v43 offset:33280
  ds_read_b64_tr_b16 a[68:69], v43 offset:36864
  ds_read_b64_tr_b16 a[70:71], v43 offset:37376
  ds_read_b64_tr_b16 a[72:73], v44 offset:32768
  ds_read_b64_tr_b16 a[74:75], v44 offset:33280
  ds_read_b64_tr_b16 a[76:77], v44 offset:36864
  ds_read_b64_tr_b16 a[78:79], v44 offset:37376
  s_add_u32 m0, s36, 24576
  s_mov_b32 s37, 0x200
  buffer_load_dwordx4 v42, s[24:27], s37 offen  lds
  s_add_u32 m0, s36, 25600
  s_mov_b32 s37, 0x2600
  buffer_load_dwordx4 v42, s[24:27], s37 offen  lds
  s_add_u32 m0, s36, 26624
  s_mov_b32 s37, 0x4a00
  buffer_load_dwordx4 v42, s[24:27], s37 offen  lds
  s_add_u32 m0, s36, 27648
  s_mov_b32 s37, 0x6e00
  buffer_load_dwordx4 v42, s[24:27], s37 offen  lds
  ds_read_b64_tr_b16 v[56:57], v49 offset:0
  ds_read_b64_tr_b16 v[58:59], v49 offset:64
  ds_read_b64_tr_b16 v[60:61], v49 offset:1024
  ds_read_b64_tr_b16 v[62:63], v49 offset:1088
  ds_read_b64_tr_b16 v[64:65], v49 offset:2048
  ds_read_b64_tr_b16 v[66:67], v49 offset:2112
  ds_read_b64_tr_b16 v[68:69], v49 offset:3072
  ds_read_b64_tr_b16 v[70:71], v49 offset:3136
  v_add_u32 v16, s78, v0
  s_waitcnt lgkmcnt(0)
  ds_write_b128 v16, v[56:59] offset:0
  ds_write_b128 v16, v[60:63] offset:1024
  ds_write_b128 v16, v[64:67] offset:2048
  ds_write_b128 v16, v[68:71] offset:3072
  s_waitcnt vmcnt(24) lgkmcnt(0)
  s_barrier
  ds_read_b64_tr_b16 a[80:81], v43 offset:40960
  ds_read_b64_tr_b16 a[82:83], v43 offset:41472
  ds_read_b64_tr_b16 a[84:85], v43 offset:45056
  ds_read_b64_tr_b16 a[86:87], v43 offset:45568
  ds_read_b64_tr_b16 a[88:89], v44 offset:40960
  ds_read_b64_tr_b16 a[90:91], v44 offset:41472
  ds_read_b64_tr_b16 a[92:93], v44 offset:45056
  ds_read_b64_tr_b16 a[94:95], v44 offset:45568
  s_add_u32 m0, s36, 32768
  s_mov_b32 s37, 0x200000
  buffer_load_dwordx4 v40, s[20:23], s37 offen  lds
  s_add_u32 m0, s36, 33792
  s_mov_b32 s37, 0x210000
  buffer_load_dwordx4 v41, s[20:23], s37 offen  lds
  s_add_u32 m0, s36, 34816
  s_mov_b32 s37, 0x220000
  buffer_load_dwordx4 v40, s[20:23], s37 offen  lds
  s_add_u32 m0, s36, 35840
  s_mov_b32 s37, 0x230000
  buffer_load_dwordx4 v41, s[20:23], s37 offen  lds
  s_waitcnt vmcnt(24) lgkmcnt(0)
  s_barrier
  ds_read_b64_tr_b16 a[96:97], v43 offset:49152
  ds_read_b64_tr_b16 a[98:99], v43 offset:49664
  ds_read_b64_tr_b16 a[100:101], v43 offset:53248
  ds_read_b64_tr_b16 a[102:103], v43 offset:53760
  ds_read_b64_tr_b16 a[104:105], v44 offset:49152
  ds_read_b64_tr_b16 a[106:107], v44 offset:49664
  ds_read_b64_tr_b16 a[108:109], v44 offset:53248
  ds_read_b64_tr_b16 a[110:111], v44 offset:53760
  s_add_u32 m0, s36, 40960
  s_mov_b32 s37, 0x280000
  buffer_load_dwordx4 v40, s[16:19], s37 offen  lds
  s_add_u32 m0, s36, 41984
  s_mov_b32 s37, 0x290000
  buffer_load_dwordx4 v41, s[16:19], s37 offen  lds
  s_add_u32 m0, s36, 43008
  s_mov_b32 s37, 0x2a0000
  buffer_load_dwordx4 v40, s[16:19], s37 offen  lds
  s_add_u32 m0, s36, 44032
  s_mov_b32 s37, 0x2b0000
  buffer_load_dwordx4 v41, s[16:19], s37 offen  lds
  s_waitcnt vmcnt(24) lgkmcnt(0)
  s_barrier
  ds_read_b64_tr_b16 v[192:193], v45 offset:57344
  ds_read_b64_tr_b16 v[194:195], v45 offset:57600
  ds_read_b64_tr_b16 v[196:197], v45 offset:61440
  ds_read_b64_tr_b16 v[198:199], v45 offset:61696
  ds_read_b64_tr_b16 v[200:201], v45 offset:57352
  ds_read_b64_tr_b16 v[202:203], v45 offset:57608
  ds_read_b64_tr_b16 v[204:205], v45 offset:61448
  ds_read_b64_tr_b16 v[206:207], v45 offset:61704
  s_add_u32 m0, s36, 49152
  s_mov_b32 s37, 0x280000
  buffer_load_dwordx4 v40, s[20:23], s37 offen  lds
  s_add_u32 m0, s36, 50176
  s_mov_b32 s37, 0x290000
  buffer_load_dwordx4 v41, s[20:23], s37 offen  lds
  s_add_u32 m0, s36, 51200
  s_mov_b32 s37, 0x2a0000
  buffer_load_dwordx4 v40, s[20:23], s37 offen  lds
  s_add_u32 m0, s36, 52224
  s_mov_b32 s37, 0x2b0000
  buffer_load_dwordx4 v41, s[20:23], s37 offen  lds
  s_waitcnt vmcnt(24) lgkmcnt(0)
  s_barrier
  ds_read_b64_tr_b16 a[128:129], v43 offset:0
  ds_read_b64_tr_b16 a[130:131], v43 offset:512
  ds_read_b64_tr_b16 a[132:133], v43 offset:4096
  ds_read_b64_tr_b16 a[134:135], v43 offset:4608
  ds_read_b64_tr_b16 a[136:137], v44 offset:0
  ds_read_b64_tr_b16 a[138:139], v44 offset:512
  ds_read_b64_tr_b16 a[140:141], v44 offset:4096
  ds_read_b64_tr_b16 a[142:143], v44 offset:4608
  s_add_u32 m0, s36, 57344
  s_mov_b32 s37, 0x12200
  buffer_load_dwordx4 v42, s[24:27], s37 offen  lds
  s_add_u32 m0, s36, 58368
  s_mov_b32 s37, 0x14600
  buffer_load_dwordx4 v42, s[24:27], s37 offen  lds
  s_add_u32 m0, s36, 59392
  s_mov_b32 s37, 0x16a00
  buffer_load_dwordx4 v42, s[24:27], s37 offen  lds
  s_add_u32 m0, s36, 60416
  s_mov_b32 s37, 0x18e00
  buffer_load_dwordx4 v42, s[24:27], s37 offen  lds
  s_waitcnt vmcnt(24) lgkmcnt(0)
  s_barrier
  ds_read_b64_tr_b16 a[144:145], v43 offset:8192
  ds_read_b64_tr_b16 a[146:147], v43 offset:8704
  ds_read_b64_tr_b16 a[148:149], v43 offset:12288
  ds_read_b64_tr_b16 a[150:151], v43 offset:12800
  ds_read_b64_tr_b16 a[152:153], v44 offset:8192
  ds_read_b64_tr_b16 a[154:155], v44 offset:8704
  ds_read_b64_tr_b16 a[156:157], v44 offset:12288
  ds_read_b64_tr_b16 a[158:159], v44 offset:12800
  s_add_u32 m0, s36, 0
  s_mov_b32 s37, 0x300000
  buffer_load_dwordx4 v40, s[16:19], s37 offen  lds
  s_add_u32 m0, s36, 1024
  s_mov_b32 s37, 0x310000
  buffer_load_dwordx4 v41, s[16:19], s37 offen  lds
  s_add_u32 m0, s36, 2048
  s_mov_b32 s37, 0x320000
  buffer_load_dwordx4 v40, s[16:19], s37 offen  lds
  s_add_u32 m0, s36, 3072
  s_mov_b32 s37, 0x330000
  buffer_load_dwordx4 v41, s[16:19], s37 offen  lds
  s_waitcnt vmcnt(24) lgkmcnt(0)
  s_barrier
  ds_read_b64_tr_b16 a[160:161], v43 offset:16384
  ds_read_b64_tr_b16 a[162:163], v43 offset:16896
  ds_read_b64_tr_b16 a[164:165], v43 offset:20480
  ds_read_b64_tr_b16 a[166:167], v43 offset:20992
  ds_read_b64_tr_b16 a[168:169], v44 offset:16384
  ds_read_b64_tr_b16 a[170:171], v44 offset:16896
  ds_read_b64_tr_b16 a[172:173], v44 offset:20480
  ds_read_b64_tr_b16 a[174:175], v44 offset:20992
  s_add_u32 m0, s36, 8192
  s_mov_b32 s37, 0x300000
  buffer_load_dwordx4 v40, s[20:23], s37 offen  lds
  s_add_u32 m0, s36, 9216
  s_mov_b32 s37, 0x310000
  buffer_load_dwordx4 v41, s[20:23], s37 offen  lds
  s_add_u32 m0, s36, 10240
  s_mov_b32 s37, 0x320000
  buffer_load_dwordx4 v40, s[20:23], s37 offen  lds
  s_add_u32 m0, s36, 11264
  s_mov_b32 s37, 0x330000
  buffer_load_dwordx4 v41, s[20:23], s37 offen  lds
  s_waitcnt vmcnt(24) lgkmcnt(0)
  s_barrier
  ds_read_b64_tr_b16 v[208:209], v45 offset:24576
  ds_read_b64_tr_b16 v[210:211], v45 offset:24832
  ds_read_b64_tr_b16 v[212:213], v45 offset:28672
  ds_read_b64_tr_b16 v[214:215], v45 offset:28928
  ds_read_b64_tr_b16 v[216:217], v45 offset:24584
  ds_read_b64_tr_b16 v[218:219], v45 offset:24840
  ds_read_b64_tr_b16 v[220:221], v45 offset:28680
  ds_read_b64_tr_b16 v[222:223], v45 offset:28936
  s_add_u32 m0, s36, 16384
  s_mov_b32 s37, 0x380000
  buffer_load_dwordx4 v40, s[16:19], s37 offen  lds
  s_add_u32 m0, s36, 17408
  s_mov_b32 s37, 0x390000
  buffer_load_dwordx4 v41, s[16:19], s37 offen  lds
  s_add_u32 m0, s36, 18432
  s_mov_b32 s37, 0x3a0000
  buffer_load_dwordx4 v40, s[16:19], s37 offen  lds
  s_add_u32 m0, s36, 19456
  s_mov_b32 s37, 0x3b0000
  buffer_load_dwordx4 v41, s[16:19], s37 offen  lds
  s_waitcnt vmcnt(24) lgkmcnt(0)
  s_barrier
  ds_read_b64_tr_b16 a[176:177], v43 offset:32768
  ds_read_b64_tr_b16 a[178:179], v43 offset:33280
  ds_read_b64_tr_b16 a[180:181], v43 offset:36864
  ds_read_b64_tr_b16 a[182:183], v43 offset:37376
  ds_read_b64_tr_b16 a[184:185], v44 offset:32768
  ds_read_b64_tr_b16 a[186:187], v44 offset:33280
  ds_read_b64_tr_b16 a[188:189], v44 offset:36864
  ds_read_b64_tr_b16 a[190:191], v44 offset:37376
  s_add_u32 m0, s36, 24576
  s_mov_b32 s37, 0x300
  buffer_load_dwordx4 v42, s[24:27], s37 offen  lds
  s_add_u32 m0, s36, 25600
  s_mov_b32 s37, 0x2700
  buffer_load_dwordx4 v42, s[24:27], s37 offen  lds
  s_add_u32 m0, s36, 26624
  s_mov_b32 s37, 0x4b00
  buffer_load_dwordx4 v42, s[24:27], s37 offen  lds
  s_add_u32 m0, s36, 27648
  s_mov_b32 s37, 0x6f00
  buffer_load_dwordx4 v42, s[24:27], s37 offen  lds
  s_waitcnt vmcnt(24) lgkmcnt(0)
  s_barrier
  ds_read_b64_tr_b16 a[208:209], v43 offset:40960
  ds_read_b64_tr_b16 a[210:211], v43 offset:41472
  ds_read_b64_tr_b16 a[212:213], v43 offset:45056
  ds_read_b64_tr_b16 a[214:215], v43 offset:45568
  ds_read_b64_tr_b16 a[216:217], v44 offset:40960
  ds_read_b64_tr_b16 a[218:219], v44 offset:41472
  ds_read_b64_tr_b16 a[220:221], v44 offset:45056
  ds_read_b64_tr_b16 a[222:223], v44 offset:45568
  s_add_u32 m0, s36, 32768
  s_mov_b32 s37, 0x380000
  buffer_load_dwordx4 v40, s[20:23], s37 offen  lds
  s_add_u32 m0, s36, 33792
  s_mov_b32 s37, 0x390000
  buffer_load_dwordx4 v41, s[20:23], s37 offen  lds
  s_add_u32 m0, s36, 34816
  s_mov_b32 s37, 0x3a0000
  buffer_load_dwordx4 v40, s[20:23], s37 offen  lds
  s_add_u32 m0, s36, 35840
  s_mov_b32 s37, 0x3b0000
  buffer_load_dwordx4 v41, s[20:23], s37 offen  lds
  s_waitcnt vmcnt(24) lgkmcnt(0)
  s_barrier
  ds_read_b64_tr_b16 a[224:225], v43 offset:49152
  ds_read_b64_tr_b16 a[226:227], v43 offset:49664
  ds_read_b64_tr_b16 a[228:229], v43 offset:53248
  ds_read_b64_tr_b16 a[230:231], v43 offset:53760
  ds_read_b64_tr_b16 a[232:233], v44 offset:49152
  ds_read_b64_tr_b16 a[234:235], v44 offset:49664
  ds_read_b64_tr_b16 a[236:237], v44 offset:53248
  ds_read_b64_tr_b16 a[238:239], v44 offset:53760
  s_add_u32 m0, s36, 40960
  s_mov_b32 s37, 0x400000
  buffer_load_dwordx4 v40, s[16:19], s37 offen  lds
  s_add_u32 m0, s36, 41984
  s_mov_b32 s37, 0x410000
  buffer_load_dwordx4 v41, s[16:19], s37 offen  lds
  s_add_u32 m0, s36, 43008
  s_mov_b32 s37, 0x420000
  buffer_load_dwordx4 v40, s[16:19], s37 offen  lds
  s_add_u32 m0, s36, 44032
  s_mov_b32 s37, 0x430000
  buffer_load_dwordx4 v41, s[16:19], s37 offen  lds
  s_waitcnt vmcnt(24) lgkmcnt(0)
  s_barrier
  ds_read_b64_tr_b16 v[224:225], v45 offset:57344
  ds_read_b64_tr_b16 v[226:227], v45 offset:57600
  ds_read_b64_tr_b16 v[228:229], v45 offset:61440
  ds_read_b64_tr_b16 v[230:231], v45 offset:61696
  ds_read_b64_tr_b16 v[232:233], v45 offset:57352
  ds_read_b64_tr_b16 v[234:235], v45 offset:57608
  ds_read_b64_tr_b16 v[236:237], v45 offset:61448
  ds_read_b64_tr_b16 v[238:239], v45 offset:61704
  s_add_u32 m0, s36, 49152
  s_mov_b32 s37, 0x400000
  buffer_load_dwordx4 v40, s[20:23], s37 offen  lds
  s_add_u32 m0, s36, 50176
  s_mov_b32 s37, 0x410000
  buffer_load_dwordx4 v41, s[20:23], s37 offen  lds
  s_add_u32 m0, s36, 51200
  s_mov_b32 s37, 0x420000
  buffer_load_dwordx4 v40, s[20:23], s37 offen  lds
  s_add_u32 m0, s36, 52224
  s_mov_b32 s37, 0x430000
  buffer_load_dwordx4 v41, s[20:23], s37 offen  lds
  s_waitcnt vmcnt(24) lgkmcnt(0)
  s_barrier
  ds_read_b64_tr_b16 a[240:241], v43 offset:0
  ds_read_b64_tr_b16 a[242:243], v43 offset:512
  ds_read_b64_tr_b16 a[244:245], v43 offset:4096
  ds_read_b64_tr_b16 a[246:247], v43 offset:4608
  ds_read_b64_tr_b16 a[248:249], v44 offset:0
  ds_read_b64_tr_b16 a[250:251], v44 offset:512
  ds_read_b64_tr_b16 a[252:253], v44 offset:4096
  ds_read_b64_tr_b16 a[254:255], v44 offset:4608
  s_add_u32 m0, s36, 57344
  s_mov_b32 s37, 0x80000
  buffer_load_dwordx4 v40, s[12:15], s37 offen  lds
  s_add_u32 m0, s36, 58368
  s_mov_b32 s37, 0x90000
  buffer_load_dwordx4 v41, s[12:15], s37 offen  lds
  s_add_u32 m0, s36, 59392
  s_mov_b32 s37, 0xa0000
  buffer_load_dwordx4 v40, s[12:15], s37 offen  lds
  s_add_u32 m0, s36, 60416
  s_mov_b32 s37, 0xb0000
  buffer_load_dwordx4 v41, s[12:15], s37 offen  lds
  s_waitcnt vmcnt(24) lgkmcnt(0)
  s_barrier
  ds_read_b64_tr_b16 v[80:81], v43 offset:8192
  ds_read_b64_tr_b16 v[82:83], v43 offset:8704
  ds_read_b64_tr_b16 v[84:85], v43 offset:12288
  ds_read_b64_tr_b16 v[86:87], v43 offset:12800
  ds_read_b64_tr_b16 v[88:89], v44 offset:8192
  ds_read_b64_tr_b16 v[90:91], v44 offset:8704
  ds_read_b64_tr_b16 v[92:93], v44 offset:12288
  ds_read_b64_tr_b16 v[94:95], v44 offset:12800
  s_add_u32 m0, s36, 0
  s_mov_b32 s37, 0x180000
  buffer_load_dwordx4 v40, s[12:15], s37 offen  lds
  s_add_u32 m0, s36, 1024
  s_mov_b32 s37, 0x190000
  buffer_load_dwordx4 v41, s[12:15], s37 offen  lds
  s_add_u32 m0, s36, 2048
  s_mov_b32 s37, 0x1a0000
  buffer_load_dwordx4 v40, s[12:15], s37 offen  lds
  s_add_u32 m0, s36, 3072
  s_mov_b32 s37, 0x1b0000
  buffer_load_dwordx4 v41, s[12:15], s37 offen  lds
  s_waitcnt vmcnt(24) lgkmcnt(0)
  s_barrier
  ds_read_b64_tr_b16 v[112:113], v43 offset:16384
  ds_read_b64_tr_b16 v[114:115], v43 offset:16896
  ds_read_b64_tr_b16 v[116:117], v43 offset:20480
  ds_read_b64_tr_b16 v[118:119], v43 offset:20992
  ds_read_b64_tr_b16 v[120:121], v44 offset:16384
  ds_read_b64_tr_b16 v[122:123], v44 offset:16896
  ds_read_b64_tr_b16 v[124:125], v44 offset:20480
  ds_read_b64_tr_b16 v[126:127], v44 offset:20992
  s_add_u32 m0, s36, 8192
  s_mov_b32 s37, 0x280000
  buffer_load_dwordx4 v40, s[12:15], s37 offen  lds
  s_add_u32 m0, s36, 9216
  s_mov_b32 s37, 0x290000
  buffer_load_dwordx4 v41, s[12:15], s37 offen  lds
  s_add_u32 m0, s36, 10240
  s_mov_b32 s37, 0x2a0000
  buffer_load_dwordx4 v40, s[12:15], s37 offen  lds
  s_add_u32 m0, s36, 11264
  s_mov_b32 s37, 0x2b0000
  buffer_load_dwordx4 v41, s[12:15], s37 offen  lds
  s_waitcnt vmcnt(24) lgkmcnt(0)
  s_barrier
  ds_read_b64_tr_b16 v[240:241], v45 offset:24576
  ds_read_b64_tr_b16 v[242:243], v45 offset:24832
  ds_read_b64_tr_b16 v[244:245], v45 offset:28672
  ds_read_b64_tr_b16 v[246:247], v45 offset:28928
  ds_read_b64_tr_b16 v[248:249], v45 offset:24584
  ds_read_b64_tr_b16 v[250:251], v45 offset:24840
  ds_read_b64_tr_b16 v[252:253], v45 offset:28680
  ds_read_b64_tr_b16 v[254:255], v45 offset:28936
  s_add_u32 m0, s36, 16384
  s_mov_b32 s37, 0x380000
  buffer_load_dwordx4 v40, s[12:15], s37 offen  lds
  s_add_u32 m0, s36, 17408
  s_mov_b32 s37, 0x390000
  buffer_load_dwordx4 v41, s[12:15], s37 offen  lds
  s_add_u32 m0, s36, 18432
  s_mov_b32 s37, 0x3a0000
  buffer_load_dwordx4 v40, s[12:15], s37 offen  lds
  s_add_u32 m0, s36, 19456
  s_mov_b32 s37, 0x3b0000
  buffer_load_dwordx4 v41, s[12:15], s37 offen  lds
  s_waitcnt vmcnt(24) lgkmcnt(0)
  s_barrier
  ds_read_b64_tr_b16 v[128:129], v43 offset:32768
  ds_read_b64_tr_b16 v[130:131], v43 offset:33280
  ds_read_b64_tr_b16 v[132:133], v43 offset:36864
  ds_read_b64_tr_b16 v[134:135], v43 offset:37376
  ds_read_b64_tr_b16 v[136:137], v44 offset:32768
  ds_read_b64_tr_b16 v[138:139], v44 offset:33280
  ds_read_b64_tr_b16 v[140:141], v44 offset:36864
  ds_read_b64_tr_b16 v[142:143], v44 offset:37376
  s_add_u32 m0, s36, 24576
  s_mov_b32 s37, 0x0
  buffer_load_dwordx4 v40, s[12:15], s37 offen  lds
  s_add_u32 m0, s36, 25600
  s_mov_b32 s37, 0x10000
  buffer_load_dwordx4 v41, s[12:15], s37 offen  lds
  s_add_u32 m0, s36, 26624
  s_mov_b32 s37, 0x20000
  buffer_load_dwordx4 v40, s[12:15], s37 offen  lds
  s_add_u32 m0, s36, 27648
  s_mov_b32 s37, 0x30000
  buffer_load_dwordx4 v41, s[12:15], s37 offen  lds
  s_waitcnt vmcnt(24) lgkmcnt(0)
  s_barrier
  ds_read_b64_tr_b16 v[144:145], v43 offset:40960
  ds_read_b64_tr_b16 v[146:147], v43 offset:41472
  ds_read_b64_tr_b16 v[148:149], v43 offset:45056
  ds_read_b64_tr_b16 v[150:151], v43 offset:45568
  ds_read_b64_tr_b16 v[152:153], v44 offset:40960
  ds_read_b64_tr_b16 v[154:155], v44 offset:41472
  ds_read_b64_tr_b16 v[156:157], v44 offset:45056
  ds_read_b64_tr_b16 v[158:159], v44 offset:45568
  s_add_u32 m0, s36, 32768
  s_mov_b32 s37, 0x100000
  buffer_load_dwordx4 v40, s[12:15], s37 offen  lds
  s_add_u32 m0, s36, 33792
  s_mov_b32 s37, 0x110000
  buffer_load_dwordx4 v41, s[12:15], s37 offen  lds
  s_add_u32 m0, s36, 34816
  s_mov_b32 s37, 0x120000
  buffer_load_dwordx4 v40, s[12:15], s37 offen  lds
  s_add_u32 m0, s36, 35840
  s_mov_b32 s37, 0x130000
  buffer_load_dwordx4 v41, s[12:15], s37 offen  lds
  s_waitcnt vmcnt(24) lgkmcnt(0)
  s_barrier
  ds_read_b64_tr_b16 v[160:161], v43 offset:49152
  ds_read_b64_tr_b16 v[162:163], v43 offset:49664
  ds_read_b64_tr_b16 v[164:165], v43 offset:53248
  ds_read_b64_tr_b16 v[166:167], v43 offset:53760
  ds_read_b64_tr_b16 v[168:169], v44 offset:49152
  ds_read_b64_tr_b16 v[170:171], v44 offset:49664
  ds_read_b64_tr_b16 v[172:173], v44 offset:53248
  ds_read_b64_tr_b16 v[174:175], v44 offset:53760
  s_add_u32 m0, s36, 40960
  s_mov_b32 s37, 0x200000
  buffer_load_dwordx4 v40, s[12:15], s37 offen  lds
  s_add_u32 m0, s36, 41984
  s_mov_b32 s37, 0x210000
  buffer_load_dwordx4 v41, s[12:15], s37 offen  lds
  s_add_u32 m0, s36, 43008
  s_mov_b32 s37, 0x220000
  buffer_load_dwordx4 v40, s[12:15], s37 offen  lds
  s_add_u32 m0, s36, 44032
  s_mov_b32 s37, 0x230000
  buffer_load_dwordx4 v41, s[12:15], s37 offen  lds
  s_waitcnt vmcnt(24) lgkmcnt(0)
  s_barrier
  ds_read_b64_tr_b16 a[32:33], v43 offset:57344
  ds_read_b64_tr_b16 a[34:35], v43 offset:57856
  ds_read_b64_tr_b16 a[36:37], v43 offset:61440
  ds_read_b64_tr_b16 a[38:39], v43 offset:61952
  ds_read_b64_tr_b16 a[40:41], v44 offset:57344
  ds_read_b64_tr_b16 a[42:43], v44 offset:57856
  ds_read_b64_tr_b16 a[44:45], v44 offset:61440
  ds_read_b64_tr_b16 a[46:47], v44 offset:61952
  s_add_u32 m0, s36, 49152
  s_mov_b32 s37, 0x300000
  buffer_load_dwordx4 v40, s[12:15], s37 offen  lds
  s_add_u32 m0, s36, 50176
  s_mov_b32 s37, 0x310000
  buffer_load_dwordx4 v41, s[12:15], s37 offen  lds
  s_add_u32 m0, s36, 51200
  s_mov_b32 s37, 0x320000
  buffer_load_dwordx4 v40, s[12:15], s37 offen  lds
  s_add_u32 m0, s36, 52224
  s_mov_b32 s37, 0x330000
  buffer_load_dwordx4 v41, s[12:15], s37 offen  lds
  s_waitcnt vmcnt(24) lgkmcnt(0)
  s_barrier
  ds_read_b64_tr_b16 a[112:113], v43 offset:0
  ds_read_b64_tr_b16 a[114:115], v43 offset:512
  ds_read_b64_tr_b16 a[116:117], v43 offset:4096
  ds_read_b64_tr_b16 a[118:119], v43 offset:4608
  ds_read_b64_tr_b16 a[120:121], v44 offset:0
  ds_read_b64_tr_b16 a[122:123], v44 offset:512
  ds_read_b64_tr_b16 a[124:125], v44 offset:4096
  ds_read_b64_tr_b16 a[126:127], v44 offset:4608
  s_add_u32 m0, s36, 57344
  s_mov_b32 s37, 0x400000
  buffer_load_dwordx4 v40, s[12:15], s37 offen  lds
  s_add_u32 m0, s36, 58368
  s_mov_b32 s37, 0x410000
  buffer_load_dwordx4 v41, s[12:15], s37 offen  lds
  s_add_u32 m0, s36, 59392
  s_mov_b32 s37, 0x420000
  buffer_load_dwordx4 v40, s[12:15], s37 offen  lds
  s_add_u32 m0, s36, 60416
  s_mov_b32 s37, 0x430000
  buffer_load_dwordx4 v41, s[12:15], s37 offen  lds
  s_waitcnt vmcnt(24) lgkmcnt(0)
  s_barrier
  ds_read_b64_tr_b16 a[192:193], v43 offset:8192
  ds_read_b64_tr_b16 a[194:195], v43 offset:8704
  ds_read_b64_tr_b16 a[196:197], v43 offset:12288
  ds_read_b64_tr_b16 a[198:199], v43 offset:12800
  ds_read_b64_tr_b16 a[200:201], v44 offset:8192
  ds_read_b64_tr_b16 a[202:203], v44 offset:8704
  ds_read_b64_tr_b16 a[204:205], v44 offset:12288
  ds_read_b64_tr_b16 a[206:207], v44 offset:12800
  s_add_u32 m0, s36, 0
  s_mov_b32 s37, 0x0
  buffer_load_dwordx4 v42, s[24:27], s37 offen  lds
  s_add_u32 m0, s36, 1024
  s_mov_b32 s37, 0x2400
  buffer_load_dwordx4 v42, s[24:27], s37 offen  lds
  s_add_u32 m0, s36, 2048
  s_mov_b32 s37, 0x4800
  buffer_load_dwordx4 v42, s[24:27], s37 offen  lds
  s_add_u32 m0, s36, 3072
  s_mov_b32 s37, 0x6c00
  buffer_load_dwordx4 v42, s[24:27], s37 offen  lds
  s_waitcnt vmcnt(24) lgkmcnt(0)
  s_barrier
  ds_read_b64_tr_b16 v[96:97], v43 offset:16384
  ds_read_b64_tr_b16 v[98:99], v43 offset:16896
  ds_read_b64_tr_b16 v[100:101], v43 offset:20480
  ds_read_b64_tr_b16 v[102:103], v43 offset:20992
  ds_read_b64_tr_b16 v[104:105], v44 offset:16384
  ds_read_b64_tr_b16 v[106:107], v44 offset:16896
  ds_read_b64_tr_b16 v[108:109], v44 offset:20480
  ds_read_b64_tr_b16 v[110:111], v44 offset:20992
  s_add_u32 m0, s36, 8192
  s_mov_b32 s37, 0x12000
  buffer_load_dwordx4 v42, s[24:27], s37 offen  lds
  s_add_u32 m0, s36, 9216
  s_mov_b32 s37, 0x14400
  buffer_load_dwordx4 v42, s[24:27], s37 offen  lds
  s_add_u32 m0, s36, 10240
  s_mov_b32 s37, 0x16800
  buffer_load_dwordx4 v42, s[24:27], s37 offen  lds
  s_add_u32 m0, s36, 11264
  s_mov_b32 s37, 0x18c00
  buffer_load_dwordx4 v42, s[24:27], s37 offen  lds
  v_mov_b32 v16, 1
  buffer_load_dword v17, off, s[8:11], 0 offset:64 sc1
  buffer_load_dword v18, off, s[8:11], 0 offset:192 sc1
  s_waitcnt vmcnt(26) lgkmcnt(0)
  s_barrier
  ds_read_b64_tr_b16 v[56:57], v43 offset:24576
  ds_read_b64_tr_b16 v[58:59], v43 offset:25088
  ds_read_b64_tr_b16 v[60:61], v43 offset:28672
  ds_read_b64_tr_b16 v[62:63], v43 offset:29184
  ds_read_b64_tr_b16 v[64:65], v44 offset:24576
  ds_read_b64_tr_b16 v[66:67], v44 offset:25088
  ds_read_b64_tr_b16 v[68:69], v44 offset:28672
  ds_read_b64_tr_b16 v[70:71], v44 offset:29184
  s_add_u32 m0, s36, 16384
  s_mov_b32 s37, 0x12300
  buffer_load_dwordx4 v42, s[24:27], s37 offen  lds
  s_add_u32 m0, s36, 17408
  s_mov_b32 s37, 0x14700
  buffer_load_dwordx4 v42, s[24:27], s37 offen  lds
  s_add_u32 m0, s36, 18432
  s_mov_b32 s37, 0x16b00
  buffer_load_dwordx4 v42, s[24:27], s37 offen  lds
  s_add_u32 m0, s36, 19456
  s_mov_b32 s37, 0x18f00
  buffer_load_dwordx4 v42, s[24:27], s37 offen  lds
  s_waitcnt vmcnt(26) lgkmcnt(0)
  s_barrier
  ds_write_b128 v46, v[56:59] offset:24576
  ds_write_b128 v46, v[60:63] offset:25600
  ds_write_b128 v46, v[64:67] offset:26624
  ds_write_b128 v46, v[68:71] offset:27648
  ds_read_b64_tr_b16 v[56:57], v43 offset:32768
  ds_read_b64_tr_b16 v[58:59], v43 offset:33280
  ds_read_b64_tr_b16 v[60:61], v43 offset:36864
  ds_read_b64_tr_b16 v[62:63], v43 offset:37376
  ds_read_b64_tr_b16 v[64:65], v44 offset:32768
  ds_read_b64_tr_b16 v[66:67], v44 offset:33280
  ds_read_b64_tr_b16 v[68:69], v44 offset:36864
  ds_read_b64_tr_b16 v[70:71], v44 offset:37376
  s_waitcnt vmcnt(22) lgkmcnt(0)
  s_barrier
  ds_write_b128 v46, v[56:59] offset:32768
  ds_write_b128 v46, v[60:63] offset:33792
  ds_write_b128 v46, v[64:67] offset:34816
  ds_write_b128 v46, v[68:71] offset:35840
  ds_read_b64_tr_b16 v[56:57], v43 offset:40960
  ds_read_b64_tr_b16 v[58:59], v43 offset:41472
  ds_read_b64_tr_b16 v[60:61], v43 offset:45056
  ds_read_b64_tr_b16 v[62:63], v43 offset:45568
  ds_read_b64_tr_b16 v[64:65], v44 offset:40960
  ds_read_b64_tr_b16 v[66:67], v44 offset:41472
  ds_read_b64_tr_b16 v[68:69], v44 offset:45056
  ds_read_b64_tr_b16 v[70:71], v44 offset:45568
  s_waitcnt vmcnt(18) lgkmcnt(0)
  s_barrier
  ds_write_b128 v46, v[56:59] offset:40960
  ds_write_b128 v46, v[60:63] offset:41984
  ds_write_b128 v46, v[64:67] offset:43008
  ds_write_b128 v46, v[68:71] offset:44032
  ds_read_b64_tr_b16 v[56:57], v43 offset:49152
  ds_read_b64_tr_b16 v[58:59], v43 offset:49664
  ds_read_b64_tr_b16 v[60:61], v43 offset:53248
  ds_read_b64_tr_b16 v[62:63], v43 offset:53760
  ds_read_b64_tr_b16 v[64:65], v44 offset:49152
  ds_read_b64_tr_b16 v[66:67], v44 offset:49664
  ds_read_b64_tr_b16 v[68:69], v44 offset:53248
  ds_read_b64_tr_b16 v[70:71], v44 offset:53760
  v_lshlrev_b32 v20, 2, v0
  s_sub_u32 s37, s51, 9216
  buffer_load_dword v6, v20, s[4:7], s55 offen sc1
  buffer_load_dword v6, v8, s[4:7], s37 offen sc1
  buffer_atomic_add v16, v50, s[8:11], 0 offen offset:96
  s_waitcnt vmcnt(17) lgkmcnt(0)
  s_barrier
  ds_write_b128 v46, v[56:59] offset:49152
  ds_write_b128 v46, v[60:63] offset:50176
  ds_write_b128 v46, v[64:67] offset:51200
  ds_write_b128 v46, v[68:71] offset:52224
  ds_read_b64_tr_b16 v[56:57], v43 offset:57344
  ds_read_b64_tr_b16 v[58:59], v43 offset:57856
  ds_read_b64_tr_b16 v[60:61], v43 offset:61440
  ds_read_b64_tr_b16 v[62:63], v43 offset:61952
  ds_read_b64_tr_b16 v[64:65], v44 offset:57344
  ds_read_b64_tr_b16 v[66:67], v44 offset:57856
  ds_read_b64_tr_b16 v[68:69], v44 offset:61440
  ds_read_b64_tr_b16 v[70:71], v44 offset:61952
  s_waitcnt vmcnt(13) lgkmcnt(0)
  s_barrier
  ds_write_b128 v46, v[56:59] offset:57344
  ds_write_b128 v46, v[60:63] offset:58368
  ds_write_b128 v46, v[64:67] offset:59392
  ds_write_b128 v46, v[68:71] offset:60416
  ds_read_b64_tr_b16 v[56:57], v45 offset:0
  ds_read_b64_tr_b16 v[58:59], v45 offset:256
  ds_read_b64_tr_b16 v[60:61], v45 offset:4096
  ds_read_b64_tr_b16 v[62:63], v45 offset:4352
  ds_read_b64_tr_b16 v[64:65], v45 offset:8
  ds_read_b64_tr_b16 v[66:67], v45 offset:264
  ds_read_b64_tr_b16 v[68:69], v45 offset:4104
  ds_read_b64_tr_b16 v[70:71], v45 offset:4360
  s_waitcnt vmcnt(9) lgkmcnt(0)
  s_barrier
  ds_write_b128 v46, v[56:59] offset:0
  ds_write_b128 v46, v[60:63] offset:1024
  ds_write_b128 v46, v[64:67] offset:2048
  ds_write_b128 v46, v[68:71] offset:3072
  ds_read_b64_tr_b16 v[56:57], v45 offset:8192
  ds_read_b64_tr_b16 v[58:59], v45 offset:8448
  ds_read_b64_tr_b16 v[60:61], v45 offset:12288
  ds_read_b64_tr_b16 v[62:63], v45 offset:12544
  ds_read_b64_tr_b16 v[64:65], v45 offset:8200
  ds_read_b64_tr_b16 v[66:67], v45 offset:8456
  ds_read_b64_tr_b16 v[68:69], v45 offset:12296
  ds_read_b64_tr_b16 v[70:71], v45 offset:12552
  s_waitcnt vmcnt(3) lgkmcnt(0)
  s_barrier
  ds_write_b128 v46, v[56:59] offset:8192
  ds_write_b128 v46, v[60:63] offset:9216
  ds_write_b128 v46, v[64:67] offset:10240
  ds_write_b128 v46, v[68:71] offset:11264
  ds_read_b64_tr_b16 v[56:57], v45 offset:16384
  ds_read_b64_tr_b16 v[58:59], v45 offset:16640
  ds_read_b64_tr_b16 v[60:61], v45 offset:20480
  ds_read_b64_tr_b16 v[62:63], v45 offset:20736
  ds_read_b64_tr_b16 v[64:65], v45 offset:16392
  ds_read_b64_tr_b16 v[66:67], v45 offset:16648
  ds_read_b64_tr_b16 v[68:69], v45 offset:20488
  ds_read_b64_tr_b16 v[70:71], v45 offset:20744
  buffer_load_dwordx2 v[20:21], off, s[4:7], s58 sc1
  s_waitcnt lgkmcnt(0)
  s_barrier
  ds_write_b128 v46, v[56:59] offset:16384
  ds_write_b128 v46, v[60:63] offset:17408
  ds_write_b128 v46, v[64:67] offset:18432
  ds_write_b128 v46, v[68:71] offset:19456
  s_mov_b32 s20, s4
  s_mov_b32 s21, s5
  s_and_b32 s22, s46, 0x10000000
  s_mov_b32 s23, 0x20000
  v_readfirstlane_b32 s37, v17
  v_readfirstlane_b32 s33, v18
  s_cmp_ge_u32 s37, 6
  s_cbranch_scc0 L_c_spin
  s_and_b32 s37, s33, 0xffff
  s_cmp_ge_u32 s37, 32
  s_cbranch_scc1 L_c_kv1
L_c_spin:
  v_mov_b32 v18, 64
L_c_init:
  buffer_load_dword v19, v18, s[8:11], 0 offen sc1
  s_sub_u32 s31, s31, 1
  s_cbranch_scc1 L_exit
  s_waitcnt vmcnt(0)
  v_readfirstlane_b32 s33, v19
  s_nop 0
  s_cmp_ge_u32 s33, 6
  s_cbranch_scc1 L_c_init_ok
  s_sleep 2
  s_branch L_c_init
L_c_init_ok:
  v_mov_b32 v18, 192
L_c_bar:
  buffer_load_dword v19, v18, s[8:11], 0 offen sc1
  s_sub_u32 s31, s31, 1
  s_cbranch_scc1 L_exit
  s_waitcnt vmcnt(0)
  v_readfirstlane_b32 s33, v19
  s_nop 0
  s_and_b32 s37, s33, 0xffff
  s_cmp_ge_u32 s37, 32
  s_cbranch_scc1 L_c_bar_ok
  s_sleep 2
  s_branch L_c_bar
L_c_bar_ok:
L_c_kv0:
  buffer_load_dwordx2 v[20:21], off, s[4:7], s58 sc1
  s_sub_u32 s31, s31, 1
  s_cbranch_scc1 L_exit
L_c_kv1:
  s_lshr_b32 s32, s33, 16
  s_waitcnt vmcnt(0)
  v_cmp_eq_u32 vcc, 0, v20
  s_cbranch_vccnz L_c_kv0
  v_readfirstlane_b32 s76, v21
  s_add_u32 s58, s58, 4
  v_mov_b64 v[16:17], 0
  v_mov_b64 v[18:19], 0
  v_mov_b64 v[20:21], 0
  v_mov_b64 v[22:23], 0
  v_mov_b64 v[24:25], 0
  v_mov_b64 v[26:27], 0
  v_mov_b64 v[28:29], 0
  v_mov_b64 v[30:31], 0
  s_cmp_lg_u32 s32, 0
  s_cbranch_scc1 L_c_slow
  s_cmp_eq_u32 s30, 0
  s_cbranch_scc1 L_cf0_entry
  s_cmp_eq_u32 s30, 1
  s_cbranch_scc1 L_cf1_entry
  s_cmp_eq_u32 s30, 2
  s_cbranch_scc1 L_cf2_entry
  s_branch L_cf3_entry
L_c_slow:
  s_cmp_eq_u32 s30, 0
  s_cbranch_scc1 L_cs0_entry
  s_cmp_eq_u32 s30, 1
  s_cbranch_scc1 L_cs1_entry
  s_cmp_eq_u32 s30, 2
  s_cbranch_scc1 L_cs2_entry
  s_branch L_cs3_entry
.p2align 6
L_cf0_top:
  s_waitcnt vmcnt(0)
L_cf0_h1m:
  v_bitop3_b32 v12, v16, v20, s35 bitop3:0x7e
  v_and_b32 v12, 1, v12
  v_cmp_ne_u32 vcc, 0, v12
  v_mfma_f32_16x16x32_bf16 v[40:43], v[44:47], v[16:19], 0
  v_mfma_f32_16x16x32_bf16 v[40:43], v[44:47], v[20:23], v[40:43]
  s_cbranch_vccnz L_cf0_ru
  buffer_store_dword v73, v74, s[4:7], s3 offen
  s_add_u32 s35, s35, 1
  s_cmp_eq_u32 s35, 63
  s_nop 3
  v_add_f32_dpp v40, v40, v40 row_ror:8 row_mask:0xf bank_mask:0xf
  v_add_f32_dpp v41, v41, v41 row_ror:8 row_mask:0xf bank_mask:0xf
  v_add_f32_dpp v42, v42, v42 row_ror:8 row_mask:0xf bank_mask:0xf
  v_add_f32_dpp v43, v43, v43 row_ror:8 row_mask:0xf bank_mask:0xf
  v_add_f32_dpp v40, v40, v40 row_ror:4 row_mask:0xf bank_mask:0xf
  v_add_f32_dpp v41, v41, v41 row_ror:4 row_mask:0xf bank_mask:0xf
  v_add_f32_dpp v42, v42, v42 row_ror:4 row_mask:0xf bank_mask:0xf
  v_add_f32_dpp v43, v43, v43 row_ror:4 row_mask:0xf bank_mask:0xf
  v_cvt_pk_bf16_f32 v12, v40, v41
  v_cvt_pk_bf16_f32 v13, v42, v43
  buffer_store_dwordx2 v[12:13], v5, s[4:7], s49 offen
  buffer_load_dword v75, v72, s[4:7], s71 offen sc1
  s_cbranch_scc1 L_cf0_done
  s_nop 8
  buffer_load_dword v76, v72, s[4:7], s71 offen sc1
  s_nop 9
  buffer_load_dword v77, v72, s[4:7], s71 offen sc1
  s_nop 9
  buffer_load_dword v78, v72, s[4:7], s71 offen sc1
  s_nop 9
  buffer_load_dword v79, v72, s[4:7], s71 offen sc1
  s_waitcnt vmcnt(4)
  v_cmp_gt_i32 vcc, v73, v75
  s_cbranch_vccnz L_cf0_fl
L_cf0_fld:
  s_barrier
L_cf0_h2:
  buffer_load_dwordx4 v[40:43], v0, s[4:7], s48 offen offset:0
  v_mov_b64 v[16:17], 0
  v_mov_b64 v[18:19], 0
  v_mov_b64 v[20:21], 0
  v_mov_b64 v[22:23], 0
  s_nop 3
  buffer_load_dwordx4 v[52:55], v0, s[4:7], s48 offen offset:1024
  s_nop 7
  buffer_load_dwordx4 v[72:75], v0, s[4:7], s48 offen offset:2048
  s_nop 7
  buffer_load_dwordx4 v[76:79], v0, s[4:7], s48 offen offset:3072
  s_nop 7
  buffer_load_dwordx4 v[48:51], v0, s[4:7], s74 offen offset:0 sc1
  s_waitcnt vmcnt(4) lgkmcnt(0)
  v_smfmac_f32_16x16x64_bf16 v[16:19], v[40:43], v[56:63], v1
  buffer_load_dwordx4 v[44:47], v0, s[4:7], s75 offen offset:0
  ds_read_b128 v[56:59], v2 offset:36864
  v_max_u32 v11, v40, v42
  v_smfmac_f32_16x16x64_bf16 v[20:23], v[40:43], v[64:71], v1
  ds_read_b128 v[60:63], v2 offset:37888
  v_smfmac_f32_16x16x64_bf16 v[24:27], v[40:43], a[0:7], v1
  ds_read_b128 v[64:67], v2 offset:38912
  v_smfmac_f32_16x16x64_bf16 v[28:31], v[40:43], a[8:15], v1
  ds_read_b128 v[68:71], v2 offset:39936
  s_waitcnt vmcnt(4)
  v_smfmac_f32_16x16x64_bf16 v[16:19], v[52:55], a[32:39], v1
  v_max3_u32 v11, v11, v52, v54
  v_smfmac_f32_16x16x64_bf16 v[20:23], v[52:55], a[40:47], v1
  ds_write_b128 v0, v[40:43] offset:0
  v_smfmac_f32_16x16x64_bf16 v[24:27], v[52:55], a[48:55], v1
  buffer_load_dwordx4 v[32:35], v0, s[4:7], s55 offen offset:2048 sc1
  v_smfmac_f32_16x16x64_bf16 v[28:31], v[52:55], a[56:63], v1
  s_waitcnt vmcnt(4) lgkmcnt(3)
  v_smfmac_f32_16x16x64_bf16 v[16:19], v[72:75], v[56:63], v1
  ds_read_b128 v[56:59], v2 offset:61440
  v_max3_u32 v11, v11, v72, v74
  s_waitcnt lgkmcnt(2)
  v_smfmac_f32_16x16x64_bf16 v[20:23], v[72:75], v[64:71], v1
  ds_read_b128 v[60:63], v2 offset:62464
  v_smfmac_f32_16x16x64_bf16 v[24:27], v[72:75], a[80:87], v1
  ds_read_b128 v[64:67], v2 offset:63488
  v_smfmac_f32_16x16x64_bf16 v[28:31], v[72:75], a[88:95], v1
  ds_read_b128 v[68:71], v2 offset:64512
  s_waitcnt vmcnt(3)
  v_smfmac_f32_16x16x64_bf16 v[16:19], v[76:79], a[112:119], v1
  buffer_load_dwordx4 v[72:75], v0, s[4:7], s55 offen offset:0 sc1
  v_max3_u32 v11, v11, v76, v78
  v_smfmac_f32_16x16x64_bf16 v[20:23], v[76:79], a[120:127], v1
  v_smfmac_f32_16x16x64_bf16 v[24:27], v[76:79], a[128:135], v1
  v_smfmac_f32_16x16x64_bf16 v[28:31], v[76:79], a[136:143], v1
  s_waitcnt vmcnt(3)
  ds_write_b128 v0, v[48:51] offset:4096
  s_waitcnt vmcnt(2) lgkmcnt(3)
  v_smfmac_f32_16x16x64_bf16 v[16:19], v[44:47], v[56:63], v1
  ds_read_b128 v[56:59], v2 offset:45056
  buffer_load_dwordx4 v[76:79], v0, s[4:7], s55 offen offset:1024 sc1
  v_max3_u32 v11, v11, v44, v46
  s_waitcnt lgkmcnt(2)
  v_smfmac_f32_16x16x64_bf16 v[20:23], v[44:47], v[64:71], v1
  ds_read_b128 v[60:63], v2 offset:46080
  ds_read_b128 v[64:67], v2 offset:47104
  v_max3_u32 v11, v11, v48, v50
  v_smfmac_f32_16x16x64_bf16 v[24:27], v[44:47], v[144:151], v1
  ds_read_b128 v[68:71], v2 offset:48128
  v_cmp_eq_u32 vcc, -1, v11
  v_smfmac_f32_16x16x64_bf16 v[28:31], v[44:47], v[152:159], v1
  v_lshlrev_b32 v6, 3, v0
  v_smfmac_f32_16x16x64_bf16 v[24:27], v[48:51], a[160:167], v1
  s_cbranch_vccnz L_cf0_h2q
  buffer_load_dwordx4 v[36:39], v0, s[4:7], s55 offen offset:3072 sc1
  v_smfmac_f32_16x16x64_bf16 v[28:31], v[48:51], a[168:175], v1
  s_waitcnt lgkmcnt(4)
  s_barrier
  ds_read_b128 v[40:43], v0 offset:5120
  s_waitcnt lgkmcnt(3)
  v_smfmac_f32_16x16x64_bf16 v[16:19], v[48:51], v[56:63], v1
  ds_read_b128 v[52:55], v0 offset:6144
  ds_read_b128 v[56:59], v2 offset:53248
  s_waitcnt lgkmcnt(3)
  v_smfmac_f32_16x16x64_bf16 v[20:23], v[48:51], v[64:71], v1
  ds_read_b128 v[60:63], v2 offset:54272
  ds_read_b128 v[64:67], v2 offset:55296
  s_waitcnt lgkmcnt(4)
  v_smfmac_f32_16x16x64_bf16 v[16:19], v[40:43], a[192:199], v1
  ds_read_b128 v[48:51], v0 offset:7168
  ds_read_b128 v[68:71], v2 offset:56320
  s_add_u32 s55, s55, s56
  v_smfmac_f32_16x16x64_bf16 v[20:23], v[40:43], a[200:207], v1
  v_smfmac_f32_16x16x64_bf16 v[24:27], v[40:43], a[208:215], v1
  v_smfmac_f32_16x16x64_bf16 v[28:31], v[40:43], a[216:223], v1
  s_mov_b32 exec_hi, 0
  buffer_load_dword v6, v6, s[4:7], s55 offen sc1
  s_mov_b32 exec_hi, -1
  s_waitcnt lgkmcnt(3)
  v_smfmac_f32_16x16x64_bf16 v[16:19], v[52:55], v[56:63], v1
  buffer_load_dword v6, v8, s[4:7], s51 offen sc1
  s_waitcnt lgkmcnt(0)
  v_smfmac_f32_16x16x64_bf16 v[20:23], v[52:55], v[64:71], v1
  v_smfmac_f32_16x16x64_bf16 v[16:19], v[48:51], v[96:103], v1
  v_smfmac_f32_16x16x64_bf16 v[20:23], v[48:51], v[104:111], v1
  ds_read_b128 v[64:67], v0 offset:15360
  v_smfmac_f32_16x16x64_bf16 v[24:27], v[52:55], a[240:247], v1
  ds_read_b128 v[68:71], v0 offset:15360
  v_add_f32 v16, v16, v18
  v_smfmac_f32_16x16x64_bf16 v[24:27], v[48:51], v[112:119], v1
  s_nop 0
  s_nop 0
  v_add_f32 v17, v17, v19
  v_smfmac_f32_16x16x64_bf16 v[28:31], v[52:55], a[248:255], v1
  s_mov_b64 vcc, s[72:73]
  v_cvt_pk_bf16_f32 v57, v16, v17
  v_smfmac_f32_16x16x64_bf16 v[28:31], v[48:51], v[120:127], v1
  v_add_f32 v24, v24, v26
  v_add_f32 v25, v25, v27
  v_cvt_pk_bf16_f32 v56, v24, v25
  ds_write_b64 v7, v[56:57] offset:8192
  v_pk_add_f32 v[20:21], v[20:21], v[22:23]
  s_nop 0
  v_pk_add_f32 v[28:29], v[28:29], v[30:31]
  v_cvt_pk_bf16_f32 v59, v20, v21
  v_cvt_pk_bf16_f32 v58, v28, v29
  ds_write_b64 v7, v[58:59] offset:8704
  ds_read_b64_tr_b16 v[60:61], v8 offset:8192
  ds_read_b64_tr_b16 v[62:63], v8 offset:8704
  s_waitcnt lgkmcnt(5)
  v_smfmac_f32_16x16x64_bf16 v[64:67], v[44:47], v[160:167], v1
  buffer_store_dwordx2 v[12:13], v5, s[4:7], s57 offen sc1
  s_waitcnt lgkmcnt(4)
  v_smfmac_f32_16x16x64_bf16 v[68:71], v[44:47], v[168:175], v1
  ds_read_b128 v[44:47], v0 offset:0
  v_lshrrev_b32 v59, 2, v0
  v_smfmac_f32_16x16x64_bf16 v[64:67], v[40:43], a[224:231], v1
  v_mov_b32 v31, 0x3f803f80
  v_smfmac_f32_16x16x64_bf16 v[68:71], v[40:43], a[232:239], v1
  ds_read_b128 v[40:43], v0 offset:1024
  v_smfmac_f32_16x16x64_bf16 v[64:67], v[52:55], v[80:87], v1
  s_waitcnt vmcnt(5) lgkmcnt(2)
  v_mfma_f32_16x16x32_bf16 v[16:19], v[72:75], v[60:63], 0
  v_mov_b32 v30, 0x3f803f80
  s_waitcnt vmcnt(4)
  v_mfma_f32_16x16x32_bf16 v[20:23], v[76:79], v[60:63], 0
  v_mov_b32 v29, 0x3f803f80
  v_mfma_f32_16x16x32_bf16 v[24:27], v[60:63], v[60:63], 0
  v_mov_b32 v28, 0x3f803f80
  v_smfmac_f32_16x16x64_bf16 v[68:71], v[52:55], v[88:95], v1
  ds_read_b128 v[52:55], v0 offset:2048
  v_cndmask_b32_dpp v16, v20, v16, vcc quad_perm:[2,3,0,1] row_mask:0xf bank_mask:0xf
  v_cndmask_b32_dpp v17, v21, v17, vcc quad_perm:[2,3,0,1] row_mask:0xf bank_mask:0xf
  v_cndmask_b32_dpp v18, v22, v18, vcc quad_perm:[2,3,0,1] row_mask:0xf bank_mask:0xf
  v_cndmask_b32_dpp v19, v23, v19, vcc quad_perm:[2,3,0,1] row_mask:0xf bank_mask:0xf
  v_cndmask_b32_dpp v24, v25, v24, vcc quad_perm:[2,3,0,1] row_mask:0xf bank_mask:0xf
  v_smfmac_f32_16x16x64_bf16 v[64:67], v[48:51], v[128:135], v1
  ds_write_b128 v0, v[16:19] offset:8192
  ds_write_b32 v59, v24 offset:12288
  v_smfmac_f32_16x16x64_bf16 v[68:71], v[48:51], v[136:143], v1
  ds_read_b128 v[48:51], v0 offset:3072
  s_waitcnt lgkmcnt(5)
  v_smfmac_f32_16x16x64_bf16 v[64:67], v[44:47], a[16:23], v1
  v_smfmac_f32_16x16x64_bf16 v[68:71], v[44:47], a[24:31], v1
  ds_read_b128 v[44:47], v0 offset:4096
  s_waitcnt lgkmcnt(5)
  v_smfmac_f32_16x16x64_bf16 v[64:67], v[40:43], a[64:71], v1
  v_smfmac_f32_16x16x64_bf16 v[68:71], v[40:43], a[72:79], v1
  s_waitcnt lgkmcnt(2)
  s_barrier
  ds_read_b128 v[20:23], v0 offset:9216
  ds_read_b128 v[72:75], v0 offset:10240
  v_smfmac_f32_16x16x64_bf16 v[64:67], v[52:55], a[96:103], v1
  ds_read_b128 v[76:79], v0 offset:11264
  v_smfmac_f32_16x16x64_bf16 v[68:71], v[52:55], a[104:111], v1
  ds_read2st64_b32 v[26:27], v59 offset0:49 offset1:50
  s_waitcnt lgkmcnt(5)
  v_smfmac_f32_16x16x64_bf16 v[64:67], v[48:51], a[144:151], v1
  ds_read_b32 v25, v59 offset:13056
  v_smfmac_f32_16x16x64_bf16 v[68:71], v[48:51], a[152:159], v1
  ds_read_b128 v[60:63], v2 offset:5120
  s_waitcnt lgkmcnt(6)
  v_smfmac_f32_16x16x64_bf16 v[64:67], v[44:47], a[176:183], v1
  ds_read_b128 v[56:59], v2 offset:4096
  v_smfmac_f32_16x16x64_bf16 v[68:71], v[44:47], a[184:191], v1
  ds_read_b128 v[40:43], v2 offset:12288
  s_waitcnt lgkmcnt(7)
  v_add_f32 v16, v16, v20
  v_add_f32 v17, v17, v21
  v_add_f32 v18, v18, v22
  v_add_f32 v19, v19, v23
  s_waitcnt lgkmcnt(5)
  v_pk_add_f32 v[72:73], v[72:73], v[76:77]
  v_pk_add_f32 v[74:75], v[74:75], v[78:79]
  s_waitcnt lgkmcnt(3)
  v_pk_add_f32 v[24:25], v[24:25], v[26:27]
  v_pk_add_f32 v[16:17], v[16:17], v[72:73]
  v_pk_add_f32 v[18:19], v[18:19], v[74:75]
  v_add_f32 v24, v24, v25
  v_max3_f32 v72, v16, v17, v18
  v_max3_f32 v72, v72, v19, v24
  v_pk_add_f32 v[64:65], v[64:65], v[66:67]
  v_pk_add_f32 v[68:69], v[68:69], v[70:71]
  v_max_f32_dpp v72, v72, v72 quad_perm:[2,3,0,1] row_mask:0xf bank_mask:0xf
  v_mov_b32 v73, v72
  v_cvt_pk_bf16_f32 v70, v64, v65
  v_cvt_pk_bf16_f32 v71, v68, v69
  v_permlane16_swap_b32 v73, v72
  v_max_f32 v72, v72, v73
  v_mov_b32 v73, v72
  v_mov_b32 v27, 0
  v_mov_b32 v68, 0
  v_permlane32_swap_b32 v73, v72
  v_max_f32 v72, v72, v73
  v_mul_f32 v72, s70, v72
  v_fma_f32 v16, v16, s70, -v72
  v_fma_f32 v17, v17, s70, -v72
  v_fma_f32 v18, v18, s70, -v72
  v_fma_f32 v19, v19, s70, -v72
  v_fma_f32 v24, v24, s70, -v72
  v_exp_f32 v16, v16
  v_exp_f32 v17, v17
  v_exp_f32 v18, v18
  v_exp_f32 v19, v19
  v_cvt_pk_bf16_f32 v20, v16, v17
  v_cvt_pk_bf16_f32 v21, v18, v19
  v_exp_f32 v24, v24
  v_mov_b32_dpp v22, v20 quad_perm:[2,3,0,1] row_mask:0xf bank_mask:0xf
  v_mov_b32_dpp v23, v21 quad_perm:[2,3,0,1] row_mask:0xf bank_mask:0xf
  v_mov_b32_dpp v25, v24 quad_perm:[2,3,0,1] row_mask:0xf bank_mask:0xf
  v_cvt_pk_bf16_f32 v26, v24, v25
  v_mfma_f32_16x16x32_bf16 v[16:19], v[28:31], v[20:23], 0
  ds_read_b128 v[48:51], v2 offset:14336
  v_mov_b32 v69, v26
  v_mfma_f32_16x16x32_bf16 v[72:75], v[32:35], v[20:23], 0
  ds_read_b128 v[52:55], v2 offset:15360
  v_mov_b64 v[32:33], 0
  v_mfma_f32_16x16x16_bf16 v[16:19], v[28:29], v[26:27], v[16:19]
  ds_read_b128 v[44:47], v2 offset:13312
  v_mov_b64 v[34:35], 0
  s_waitcnt vmcnt(3)
  v_mfma_f32_16x16x32_bf16 v[76:79], v[36:39], v[20:23], 0
  ds_read_b128 v[64:67], v2 offset:6144
  v_mfma_f32_16x16x16_bf16 v[72:75], v[70:71], v[26:27], v[72:75]
  v_rcp_f32 v24, v16
  v_mfma_f32_16x16x16_bf16 v[76:79], v[70:71], v[68:69], v[76:79]
  ds_read_b128 v[68:71], v2 offset:7168
  s_mov_b64 exec, s[72:73]
  s_nop 1
  v_pk_mul_f32 v[72:73], v[72:73], v[24:25] op_sel_hi:[1,0]
  v_pk_mul_f32 v[74:75], v[74:75], v[24:25] op_sel_hi:[1,0]
  v_cvt_pk_bf16_f32 v36, v72, v73
  v_cvt_pk_bf16_f32 v37, v74, v75
  v_pk_mul_f32 v[76:77], v[76:77], v[24:25] op_sel_hi:[1,0]
  v_pk_mul_f32 v[78:79], v[78:79], v[24:25] op_sel_hi:[1,0]
  v_cvt_pk_bf16_f32 v38, v76, v77
  v_cvt_pk_bf16_f32 v39, v78, v79
  ds_write_b128 v9, v[36:39] offset:13312
  s_mov_b64 exec, -1
  v_mfma_f32_16x16x16_bf16 v[16:19], v[32:33], v[32:33], 0
  v_mfma_f32_16x16x16_bf16 v[20:23], v[32:33], v[32:33], 0
  v_mfma_f32_16x16x16_bf16 v[24:27], v[32:33], v[32:33], 0
  v_mfma_f32_16x16x16_bf16 v[28:31], v[32:33], v[32:33], 0
  s_waitcnt lgkmcnt(0)
  s_barrier
  ds_read_b128 v[72:75], v0 offset:13312
  ds_read_b128 v[76:79], v0 offset:14336
  s_waitcnt lgkmcnt(1)
  v_smfmac_f32_16x16x64_bf16 v[16:19], v[72:75], v[56:63], v1
  v_mov_b64 v[56:57], 0
  v_smfmac_f32_16x16x64_bf16 v[20:23], v[72:75], v[64:71], v1
  v_mov_b64 v[58:59], 0
  s_waitcnt lgkmcnt(0)
  v_smfmac_f32_16x16x64_bf16 v[16:19], v[76:79], v[40:47], v1
  ds_read_b128 v[40:43], v2 offset:0
  v_mov_b64 v[60:61], 0
  v_smfmac_f32_16x16x64_bf16 v[20:23], v[76:79], v[48:55], v1
  ds_read_b128 v[44:47], v2 offset:1024
  ds_read_b128 v[48:51], v2 offset:2048
  v_mov_b64 v[62:63], 0
  v_smfmac_f32_16x16x64_bf16 v[24:27], v[72:75], v[176:183], v1
  ds_read_b128 v[52:55], v2 offset:3072
  v_add_f32 v16, v16, v18
  v_add_f32 v17, v17, v19
  v_smfmac_f32_16x16x64_bf16 v[28:31], v[72:75], v[184:191], v1
  ds_read_b128 v[64:67], v0 offset:15360
  v_cvt_pk_bf16_f32 v38, v16, v17
  v_bfi_b32 v38, v10, s35, v38
  v_smfmac_f32_16x16x64_bf16 v[24:27], v[76:79], v[192:199], v1
  ds_read_b128 v[68:71], v0 offset:15360
  v_add_f32 v20, v20, v22
  v_add_f32 v21, v21, v23
  v_smfmac_f32_16x16x64_bf16 v[28:31], v[76:79], v[200:207], v1
  v_cvt_pk_bf16_f32 v39, v20, v21
  s_waitcnt lgkmcnt(4)
  v_smfmac_f32_16x16x64_bf16 v[32:35], v[72:75], v[40:47], v1
  ds_read_b128 v[40:43], v2 offset:20480
  buffer_store_dwordx2 v[38:39], v3, s[4:7], s40 offen
  v_add_f32 v24, v24, v26
  v_add_f32 v25, v25, v27
  s_waitcnt lgkmcnt(3)
  v_smfmac_f32_16x16x64_bf16 v[32:35], v[76:79], v[48:55], v1
  ds_read_b128 v[44:47], v2 offset:21504
  v_cvt_pk_bf16_f32 v36, v24, v25
  v_bfi_b32 v36, v10, s35, v36
  v_smfmac_f32_16x16x64_bf16 v[56:59], v[72:75], v[208:215], v1
  ds_read_b128 v[48:51], v2 offset:22528
  v_add_f32 v28, v28, v30
  v_add_f32 v29, v29, v31
  v_smfmac_f32_16x16x64_bf16 v[60:63], v[72:75], v[216:223], v1
  ds_read_b128 v[52:55], v2 offset:23552
  v_cvt_pk_bf16_f32 v37, v28, v29
  v_add_f32 v32, v32, v34
  v_smfmac_f32_16x16x64_bf16 v[56:59], v[76:79], v[224:231], v1
  buffer_store_dwordx2 v[36:37], v3, s[4:7], s41 offen
  v_add_f32 v33, v33, v35
  v_cvt_pk_bf16_f32 v34, v32, v33
  v_smfmac_f32_16x16x64_bf16 v[60:63], v[76:79], v[232:239], v1
  v_bfi_b32 v34, v10, s35, v34
  s_waitcnt lgkmcnt(5)
  v_smfmac_f32_16x16x64_bf16 v[64:67], v[72:75], v[240:247], v1
  buffer_store_dword v34, v4, s[4:7], s40 offen
  v_add_f32 v56, v56, v58
  v_add_f32 v57, v57, v59
  s_waitcnt lgkmcnt(4)
  v_smfmac_f32_16x16x64_bf16 v[68:71], v[72:75], v[248:255], v1
  v_cvt_pk_bf16_f32 v38, v56, v57
  v_bfi_b32 v38, v10, s35, v38
  s_waitcnt lgkmcnt(2)
  v_smfmac_f32_16x16x64_bf16 v[64:67], v[76:79], v[40:47], v1
  v_add_f32 v60, v60, v62
  s_waitcnt lgkmcnt(0)
  v_smfmac_f32_16x16x64_bf16 v[68:71], v[76:79], v[48:55], v1
  v_add_f32 v61, v61, v63
  v_cvt_pk_bf16_f32 v39, v60, v61
  buffer_store_dwordx2 v[38:39], v3, s[4:7], s42 offen
  v_pk_add_f32 v[64:65], v[64:65], v[66:67]
  v_cvt_pk_bf16_f32 v36, v64, v65
  v_bfi_b32 v36, v10, s35, v36
  v_pk_add_f32 v[68:69], v[68:69], v[70:71]
  v_cvt_pk_bf16_f32 v37, v68, v69
  buffer_store_dwordx2 v[36:37], v3, s[4:7], s43 offen
  buffer_load_dwordx4 v[16:19], v0, s[4:7], s44 offen sc1
  buffer_load_dwordx4 v[20:23], v0, s[4:7], s44 offen offset:1024 sc1
  v_mov_b32 v40, 0x3f80
  v_cndmask_b32 v40, v40, 1.0, s[60:61]
  v_cndmask_b32 v46, 0, v40, s[66:67]
  v_cndmask_b32 v47, 0, v40, s[68:69]
  v_cndmask_b32 v44, 0, v40, s[62:63]
  v_cndmask_b32 v45, 0, v40, s[64:65]
  v_cmp_gt_u32 vcc, 64, v0
  v_lshlrev_b32 v74, 4, v0
  v_mov_b32 v73, s35
  v_cndmask_b32 v74, 0x40000000, v74, vcc
  v_bfe_u32 v72, v0, 2, 7
  ds_read_b128 v[56:59], v2 offset:28672
  ds_read_b128 v[60:63], v2 offset:29696
  ds_read_b128 v[64:67], v2 offset:30720
  ds_read_b128 v[68:71], v2 offset:31744
  v_mov_b64 v[24:25], 0
  v_mov_b64 v[26:27], 0
  v_mov_b64 v[28:29], 0
  v_mov_b64 v[30:31], 0
  s_add_u32 s57, s57, s77
  s_add_u32 s48, s48, 9216
  s_add_u32 s51, s51, 9216
  s_add_u32 s49, s53, s48
  s_add_u32 s74, s74, 9216
  s_add_u32 s75, s75, 9216
  s_mov_b32 s77, 9216
  s_branch L_cf0_top
L_cf0_h2q:
L_cf0_h2r:
  buffer_load_dwordx4 v[40:43], v0, s[4:7], s48 offen offset:0 sc1
  buffer_load_dwordx4 v[52:55], v0, s[4:7], s48 offen offset:1024 sc1
  buffer_load_dwordx4 v[72:75], v0, s[4:7], s48 offen offset:2048 sc1
  buffer_load_dwordx4 v[76:79], v0, s[4:7], s48 offen offset:3072 sc1
  buffer_load_dwordx4 v[44:47], v0, s[4:7], s75 offen offset:0 sc1
  s_nop 3
L_cf0_entry:
  ds_read_b128 v[56:59], v2 offset:28672
  ds_read_b128 v[60:63], v2 offset:29696
  ds_read_b128 v[64:67], v2 offset:30720
  ds_read_b128 v[68:71], v2 offset:31744
  s_sub_u32 s31, s31, 1
  s_cbranch_scc1 L_exit
  v_mov_b64 v[16:17], 0
  v_mov_b64 v[18:19], 0
  v_mov_b64 v[20:21], 0
  v_mov_b64 v[22:23], 0
  v_mov_b64 v[24:25], 0
  v_mov_b64 v[26:27], 0
  v_mov_b64 v[28:29], 0
  v_mov_b64 v[30:31], 0
  s_branch L_cf0_h2
L_cf0_fl:
L_cf0_fl1:
  buffer_load_dword v75, v72, s[4:7], s71 offen sc1
  s_waitcnt vmcnt(4)
  v_cmp_gt_i32 vcc, v73, v76
  s_cbranch_vccz L_cf0_fld
  buffer_load_dword v76, v72, s[4:7], s71 offen sc1
  s_waitcnt vmcnt(4)
  v_cmp_gt_i32 vcc, v73, v77
  s_cbranch_vccz L_cf0_fld
  buffer_load_dword v77, v72, s[4:7], s71 offen sc1
  s_waitcnt vmcnt(4)
  v_cmp_gt_i32 vcc, v73, v78
  s_cbranch_vccz L_cf0_fld
  buffer_load_dword v78, v72, s[4:7], s71 offen sc1
  s_waitcnt vmcnt(4)
  v_cmp_gt_i32 vcc, v73, v79
  s_cbranch_vccz L_cf0_fld
  buffer_load_dword v79, v72, s[4:7], s71 offen sc1
  s_waitcnt vmcnt(4)
  v_cmp_gt_i32 vcc, v73, v75
  s_cbranch_vccz L_cf0_fld
  s_sub_u32 s31, s31, 1
  s_cbranch_scc1 L_exit
  s_branch L_cf0_fl1
L_cf0_ru:
  buffer_load_dwordx4 v[16:19], v0, s[4:7], s44 offen sc1
  buffer_load_dwordx4 v[20:23], v0, s[4:7], s44 offen offset:1024 sc1
  s_sub_u32 s31, s31, 1
  s_cbranch_scc1 L_exit
  s_waitcnt vmcnt(0)
  s_branch L_cf0_h1m
L_cf0_done:
  buffer_store_dwordx2 v[12:13], v5, s[4:7], s57 offen sc1
  s_branch L_exit
.p2align 6
L_cf1_top:
  s_waitcnt vmcnt(2)
L_cf1_h1m:
  v_mfma_f32_16x16x32_bf16 v[40:43], v[44:47], v[24:27], 0
  v_bitop3_b32 v12, v24, v28, s35 bitop3:0x7e
  v_and_b32 v12, 1, v12
  v_mfma_f32_16x16x32_bf16 v[40:43], v[44:47], v[28:31], v[40:43]
  v_cmp_ne_u32 vcc, 0, v12
  s_cbranch_vccnz L_cf1_ru
  s_nop 4
  v_add_f32_dpp v40, v40, v40 row_ror:8 row_mask:0xf bank_mask:0xf
  v_add_f32_dpp v41, v41, v41 row_ror:8 row_mask:0xf bank_mask:0xf
  v_add_f32_dpp v42, v42, v42 row_ror:8 row_mask:0xf bank_mask:0xf
  v_add_f32_dpp v43, v43, v43 row_ror:8 row_mask:0xf bank_mask:0xf
  v_add_f32_dpp v40, v40, v40 row_ror:4 row_mask:0xf bank_mask:0xf
  v_add_f32_dpp v41, v41, v41 row_ror:4 row_mask:0xf bank_mask:0xf
  v_add_f32_dpp v42, v42, v42 row_ror:4 row_mask:0xf bank_mask:0xf
  v_add_f32_dpp v43, v43, v43 row_ror:4 row_mask:0xf bank_mask:0xf
  v_cvt_pk_bf16_f32 v12, v40, v41
  v_cvt_pk_bf16_f32 v13, v42, v43
  buffer_store_dwordx2 v[12:13], v5, s[4:7], s49 offen
  s_waitcnt vmcnt(1)
L_cf1_h1x:
  v_mfma_f32_16x16x32_bf16 v[40:43], v[44:47], v[16:19], 0
  v_bitop3_b32 v14, v16, v20, s35 bitop3:0x7e
  v_and_b32 v14, 1, v14
  v_mfma_f32_16x16x32_bf16 v[40:43], v[44:47], v[20:23], v[40:43]
  v_cmp_ne_u32 vcc, 0, v14
  s_nop 0
  s_and_b64 vcc, vcc, s[46:47]
  s_cbranch_scc1 L_cf1_rx
  s_add_u32 s35, s35, 1
  s_cmp_eq_u32 s35, 63
  s_nop 0
  v_add_f32_dpp v40, v40, v40 row_ror:8 row_mask:0xf bank_mask:0xf
  v_add_f32_dpp v41, v41, v41 row_ror:8 row_mask:0xf bank_mask:0xf
  v_add_f32_dpp v42, v42, v42 row_ror:8 row_mask:0xf bank_mask:0xf
  v_add_f32_dpp v43, v43, v43 row_ror:8 row_mask:0xf bank_mask:0xf
  v_add_f32_dpp v40, v40, v40 row_ror:4 row_mask:0xf bank_mask:0xf
  v_add_f32_dpp v41, v41, v41 row_ror:4 row_mask:0xf bank_mask:0xf
  v_add_f32_dpp v42, v42, v42 row_ror:4 row_mask:0xf bank_mask:0xf
  v_add_f32_dpp v43, v43, v43 row_ror:4 row_mask:0xf bank_mask:0xf
  v_cvt_pk_bf16_f32 v14, v40, v41
  v_cvt_pk_bf16_f32 v15, v42, v43
  buffer_store_dwordx2 v[14:15], v5, s[20:23], s50 offen
  s_cbranch_scc1 L_cf1_done
  s_barrier
L_cf1_h2:
  buffer_load_dwordx4 v[40:43], v0, s[4:7], s48 offen offset:0
  v_mov_b64 v[24:25], 0
  v_mov_b64 v[26:27], 0
  v_mov_b64 v[28:29], 0
  v_mov_b64 v[30:31], 0
  v_mov_b64 v[16:17], 0
  v_mov_b64 v[18:19], 0
  v_mov_b64 v[20:21], 0
  v_mov_b64 v[22:23], 0
  buffer_load_dwordx4 v[52:55], v0, s[4:7], s48 offen offset:1024
  s_nop 7
  buffer_load_dwordx4 v[72:75], v0, s[4:7], s48 offen offset:2048
  s_nop 7
  buffer_load_dwordx4 v[76:79], v0, s[4:7], s48 offen offset:3072
  s_nop 7
  buffer_load_dwordx4 v[48:51], v0, s[4:7], s74 offen offset:0 sc1
  s_waitcnt vmcnt(4) lgkmcnt(0)
  v_smfmac_f32_16x16x64_bf16 v[16:19], v[40:43], v[56:63], v1
  buffer_load_dwordx4 v[44:47], v0, s[4:7], s75 offen offset:0
  ds_read_b128 v[56:59], v2 offset:32768
  v_max_u32 v11, v40, v42
  v_smfmac_f32_16x16x64_bf16 v[20:23], v[40:43], v[64:71], v1
  ds_read_b128 v[60:63], v2 offset:33792
  v_smfmac_f32_16x16x64_bf16 v[24:27], v[40:43], a[0:7], v1
  ds_read_b128 v[64:67], v2 offset:34816
  v_smfmac_f32_16x16x64_bf16 v[28:31], v[40:43], a[8:15], v1
  ds_read_b128 v[68:71], v2 offset:35840
  s_waitcnt vmcnt(4)
  v_smfmac_f32_16x16x64_bf16 v[16:19], v[52:55], a[32:39], v1
  v_max3_u32 v11, v11, v52, v54
  v_smfmac_f32_16x16x64_bf16 v[20:23], v[52:55], a[40:47], v1
  v_smfmac_f32_16x16x64_bf16 v[24:27], v[52:55], a[48:55], v1
  ds_write_b128 v0, v[52:55] offset:1024
  v_smfmac_f32_16x16x64_bf16 v[28:31], v[52:55], a[56:63], v1
  buffer_load_dwordx4 v[32:35], v0, s[4:7], s55 offen offset:2048 sc1
  s_waitcnt vmcnt(4) lgkmcnt(3)
  v_smfmac_f32_16x16x64_bf16 v[16:19], v[72:75], v[56:63], v1
  ds_read_b128 v[56:59], v2 offset:57344
  v_max3_u32 v11, v11, v72, v74
  s_waitcnt lgkmcnt(2)
  v_smfmac_f32_16x16x64_bf16 v[20:23], v[72:75], v[64:71], v1
  ds_read_b128 v[60:63], v2 offset:58368
  v_smfmac_f32_16x16x64_bf16 v[24:27], v[72:75], a[80:87], v1
  ds_read_b128 v[64:67], v2 offset:59392
  v_smfmac_f32_16x16x64_bf16 v[28:31], v[72:75], a[88:95], v1
  ds_read_b128 v[68:71], v2 offset:60416
  s_waitcnt vmcnt(3)
  v_smfmac_f32_16x16x64_bf16 v[16:19], v[76:79], a[112:119], v1
  v_max3_u32 v11, v11, v76, v78
  v_smfmac_f32_16x16x64_bf16 v[20:23], v[76:79], a[120:127], v1
  buffer_load_dwordx4 v[72:75], v0, s[4:7], s55 offen offset:0 sc1
  v_smfmac_f32_16x16x64_bf16 v[24:27], v[76:79], a[128:135], v1
  v_smfmac_f32_16x16x64_bf16 v[28:31], v[76:79], a[136:143], v1
  s_waitcnt vmcnt(3)
  ds_write_b128 v0, v[48:51] offset:5120
  s_waitcnt vmcnt(2) lgkmcnt(3)
  v_smfmac_f32_16x16x64_bf16 v[16:19], v[44:47], v[56:63], v1
  ds_read_b128 v[56:59], v2 offset:40960
  v_max3_u32 v11, v11, v44, v46
  s_waitcnt lgkmcnt(2)
  v_smfmac_f32_16x16x64_bf16 v[20:23], v[44:47], v[64:71], v1
  ds_read_b128 v[60:63], v2 offset:41984
  buffer_load_dwordx4 v[76:79], v0, s[4:7], s55 offen offset:1024 sc1
  v_max3_u32 v11, v11, v48, v50
  v_smfmac_f32_16x16x64_bf16 v[24:27], v[44:47], v[144:151], v1
  ds_read_b128 v[64:67], v2 offset:43008
  v_cmp_eq_u32 vcc, -1, v11
  v_smfmac_f32_16x16x64_bf16 v[28:31], v[44:47], v[152:159], v1
  ds_read_b128 v[68:71], v2 offset:44032
  v_lshlrev_b32 v6, 3, v0
  v_smfmac_f32_16x16x64_bf16 v[24:27], v[48:51], a[208:215], v1
  s_cbranch_vccnz L_cf1_h2q
  v_smfmac_f32_16x16x64_bf16 v[28:31], v[48:51], a[216:223], v1
  s_waitcnt lgkmcnt(4)
  s_barrier
  ds_read_b128 v[40:43], v0 offset:4096
  buffer_load_dwordx4 v[36:39], v0, s[4:7], s55 offen offset:3072 sc1
  v_smfmac_f32_16x16x64_bf16 v[16:19], v[48:51], a[192:199], v1
  ds_read_b128 v[52:55], v0 offset:7168
  v_smfmac_f32_16x16x64_bf16 v[20:23], v[48:51], a[200:207], v1
  s_waitcnt lgkmcnt(1)
  v_smfmac_f32_16x16x64_bf16 v[16:19], v[40:43], v[56:63], v1
  ds_read_b128 v[48:51], v0 offset:6144
  ds_read_b128 v[56:59], v2 offset:49152
  s_add_u32 s55, s55, s56
  v_smfmac_f32_16x16x64_bf16 v[20:23], v[40:43], v[64:71], v1
  ds_read_b128 v[60:63], v2 offset:50176
  ds_read_b128 v[64:67], v2 offset:51200
  v_smfmac_f32_16x16x64_bf16 v[24:27], v[40:43], a[160:167], v1
  ds_read_b128 v[68:71], v2 offset:52224
  buffer_store_dwordx2 v[14:15], v5, s[20:23], s59 offen sc1
  v_smfmac_f32_16x16x64_bf16 v[28:31], v[40:43], a[168:175], v1
  s_waitcnt lgkmcnt(5)
  v_smfmac_f32_16x16x64_bf16 v[16:19], v[52:55], v[96:103], v1
  v_smfmac_f32_16x16x64_bf16 v[20:23], v[52:55], v[104:111], v1
  s_mov_b32 exec_hi, 0
  buffer_load_dword v6, v6, s[4:7], s55 offen sc1
  s_mov_b32 exec_hi, -1
  s_waitcnt lgkmcnt(2)
  v_smfmac_f32_16x16x64_bf16 v[16:19], v[48:51], v[56:63], v1
  s_waitcnt lgkmcnt(0)
  v_smfmac_f32_16x16x64_bf16 v[20:23], v[48:51], v[64:71], v1
  ds_read_b128 v[64:67], v0 offset:15360
  v_smfmac_f32_16x16x64_bf16 v[24:27], v[52:55], v[112:119], v1
  ds_read_b128 v[68:71], v0 offset:15360
  v_add_f32 v16, v16, v18
  v_smfmac_f32_16x16x64_bf16 v[24:27], v[48:51], a[240:247], v1
  s_nop 0
  s_nop 0
  v_add_f32 v17, v17, v19
  v_smfmac_f32_16x16x64_bf16 v[28:31], v[52:55], v[120:127], v1
  s_mov_b64 vcc, s[72:73]
  v_cvt_pk_bf16_f32 v57, v16, v17
  v_smfmac_f32_16x16x64_bf16 v[28:31], v[48:51], a[248:255], v1
  v_add_f32 v24, v24, v26
  v_add_f32 v25, v25, v27
  v_cvt_pk_bf16_f32 v56, v24, v25
  ds_write_b64 v7, v[56:57] offset:9216
  v_pk_add_f32 v[20:21], v[20:21], v[22:23]
  s_nop 0
  v_pk_add_f32 v[28:29], v[28:29], v[30:31]
  v_cvt_pk_bf16_f32 v59, v20, v21
  v_cvt_pk_bf16_f32 v58, v28, v29
  ds_write_b64 v7, v[58:59] offset:9728
  ds_read_b64_tr_b16 v[60:61], v8 offset:9216
  ds_read_b64_tr_b16 v[62:63], v8 offset:9728
  s_waitcnt lgkmcnt(5)
  v_smfmac_f32_16x16x64_bf16 v[64:67], v[44:47], v[160:167], v1
  s_waitcnt lgkmcnt(4)
  v_smfmac_f32_16x16x64_bf16 v[68:71], v[44:47], v[168:175], v1
  buffer_store_dwordx2 v[12:13], v5, s[4:7], s57 offen sc1
  ds_read_b128 v[44:47], v0 offset:0
  v_lshrrev_b32 v59, 2, v0
  v_smfmac_f32_16x16x64_bf16 v[64:67], v[40:43], a[176:183], v1
  v_mov_b32 v31, 0x3f803f80
  v_smfmac_f32_16x16x64_bf16 v[68:71], v[40:43], a[184:191], v1
  ds_read_b128 v[40:43], v0 offset:1024
  v_smfmac_f32_16x16x64_bf16 v[64:67], v[52:55], v[128:135], v1
  s_waitcnt vmcnt(5) lgkmcnt(2)
  v_mfma_f32_16x16x32_bf16 v[16:19], v[72:75], v[60:63], 0
  v_mov_b32 v30, 0x3f803f80
  s_waitcnt vmcnt(4)
  v_mfma_f32_16x16x32_bf16 v[20:23], v[76:79], v[60:63], 0
  v_mov_b32 v29, 0x3f803f80
  v_mfma_f32_16x16x32_bf16 v[24:27], v[60:63], v[60:63], 0
  v_mov_b32 v28, 0x3f803f80
  v_smfmac_f32_16x16x64_bf16 v[68:71], v[52:55], v[136:143], v1
  ds_read_b128 v[52:55], v0 offset:2048
  v_cndmask_b32_dpp v16, v20, v16, vcc quad_perm:[2,3,0,1] row_mask:0xf bank_mask:0xf
  v_cndmask_b32_dpp v17, v21, v17, vcc quad_perm:[2,3,0,1] row_mask:0xf bank_mask:0xf
  v_cndmask_b32_dpp v18, v22, v18, vcc quad_perm:[2,3,0,1] row_mask:0xf bank_mask:0xf
  v_cndmask_b32_dpp v19, v23, v19, vcc quad_perm:[2,3,0,1] row_mask:0xf bank_mask:0xf
  v_cndmask_b32_dpp v24, v25, v24, vcc quad_perm:[2,3,0,1] row_mask:0xf bank_mask:0xf
  v_smfmac_f32_16x16x64_bf16 v[64:67], v[48:51], v[80:87], v1
  ds_write_b128 v0, v[16:19] offset:9216
  ds_write_b32 v59, v24 offset:12544
  v_smfmac_f32_16x16x64_bf16 v[68:71], v[48:51], v[88:95], v1
  ds_read_b128 v[48:51], v0 offset:3072
  s_waitcnt lgkmcnt(5)
  v_smfmac_f32_16x16x64_bf16 v[64:67], v[44:47], a[16:23], v1
  v_smfmac_f32_16x16x64_bf16 v[68:71], v[44:47], a[24:31], v1
  ds_read_b128 v[44:47], v0 offset:5120
  s_waitcnt lgkmcnt(5)
  v_smfmac_f32_16x16x64_bf16 v[64:67], v[40:43], a[64:71], v1
  v_smfmac_f32_16x16x64_bf16 v[68:71], v[40:43], a[72:79], v1
  s_waitcnt lgkmcnt(2)
  s_barrier
  ds_read_b128 v[20:23], v0 offset:8192
  ds_read_b128 v[72:75], v0 offset:11264
  v_smfmac_f32_16x16x64_bf16 v[64:67], v[52:55], a[96:103], v1
  ds_read_b128 v[76:79], v0 offset:10240
  v_smfmac_f32_16x16x64_bf16 v[68:71], v[52:55], a[104:111], v1
  ds_read2st64_b32 v[26:27], v59 offset0:48 offset1:51
  s_waitcnt lgkmcnt(5)
  v_smfmac_f32_16x16x64_bf16 v[64:67], v[48:51], a[144:151], v1
  ds_read_b32 v25, v59 offset:12800
  v_smfmac_f32_16x16x64_bf16 v[68:71], v[48:51], a[152:159], v1
  ds_read_b128 v[60:63], v2 offset:1024
  s_waitcnt lgkmcnt(6)
  v_smfmac_f32_16x16x64_bf16 v[64:67], v[44:47], a[224:231], v1
  ds_read_b128 v[56:59], v2 offset:0
  v_smfmac_f32_16x16x64_bf16 v[68:71], v[44:47], a[232:239], v1
  ds_read_b128 v[40:43], v2 offset:8192
  s_waitcnt lgkmcnt(7)
  v_add_f32 v16, v16, v20
  v_add_f32 v17, v17, v21
  v_add_f32 v18, v18, v22
  v_add_f32 v19, v19, v23
  s_waitcnt lgkmcnt(5)
  v_pk_add_f32 v[72:73], v[72:73], v[76:77]
  v_pk_add_f32 v[74:75], v[74:75], v[78:79]
  s_waitcnt lgkmcnt(3)
  v_pk_add_f32 v[24:25], v[24:25], v[26:27]
  v_pk_add_f32 v[16:17], v[16:17], v[72:73]
  v_pk_add_f32 v[18:19], v[18:19], v[74:75]
  v_add_f32 v24, v24, v25
  v_max3_f32 v72, v16, v17, v18
  v_max3_f32 v72, v72, v19, v24
  v_pk_add_f32 v[64:65], v[64:65], v[66:67]
  v_pk_add_f32 v[68:69], v[68:69], v[70:71]
  v_max_f32_dpp v72, v72, v72 quad_perm:[2,3,0,1] row_mask:0xf bank_mask:0xf
  v_mov_b32 v73, v72
  v_cvt_pk_bf16_f32 v70, v64, v65
  v_cvt_pk_bf16_f32 v71, v68, v69
  v_permlane16_swap_b32 v73, v72
  v_max_f32 v72, v72, v73
  v_mov_b32 v73, v72
  v_mov_b32 v27, 0
  v_mov_b32 v68, 0
  v_permlane32_swap_b32 v73, v72
  v_max_f32 v72, v72, v73
  v_mul_f32 v72, s70, v72
  v_fma_f32 v16, v16, s70, -v72
  v_fma_f32 v17, v17, s70, -v72
  v_fma_f32 v18, v18, s70, -v72
  v_fma_f32 v19, v19, s70, -v72
  v_fma_f32 v24, v24, s70, -v72
  v_exp_f32 v16, v16
  v_exp_f32 v17, v17
  v_exp_f32 v18, v18
  v_exp_f32 v19, v19
  v_cvt_pk_bf16_f32 v20, v16, v17
  v_cvt_pk_bf16_f32 v21, v18, v19
  v_exp_f32 v24, v24
  v_mov_b32_dpp v22, v20 quad_perm:[2,3,0,1] row_mask:0xf bank_mask:0xf
  v_mov_b32_dpp v23, v21 quad_perm:[2,3,0,1] row_mask:0xf bank_mask:0xf
  v_mov_b32_dpp v25, v24 quad_perm:[2,3,0,1] row_mask:0xf bank_mask:0xf
  v_cvt_pk_bf16_f32 v26, v24, v25
  v_mfma_f32_16x16x32_bf16 v[16:19], v[28:31], v[20:23], 0
  ds_read_b128 v[48:51], v2 offset:10240
  v_mov_b32 v69, v26
  v_mfma_f32_16x16x32_bf16 v[72:75], v[32:35], v[20:23], 0
  ds_read_b128 v[52:55], v2 offset:11264
  v_mov_b64 v[32:33], 0
  v_mfma_f32_16x16x16_bf16 v[16:19], v[28:29], v[26:27], v[16:19]
  ds_read_b128 v[44:47], v2 offset:9216
  v_mov_b64 v[34:35], 0
  s_waitcnt vmcnt(3)
  v_mfma_f32_16x16x32_bf16 v[76:79], v[36:39], v[20:23], 0
  ds_read_b128 v[64:67], v2 offset:2048
  v_mfma_f32_16x16x16_bf16 v[72:75], v[70:71], v[26:27], v[72:75]
  v_rcp_f32 v24, v16
  v_mfma_f32_16x16x16_bf16 v[76:79], v[70:71], v[68:69], v[76:79]
  ds_read_b128 v[68:71], v2 offset:3072
  s_mov_b64 exec, s[72:73]
  s_nop 1
  v_pk_mul_f32 v[72:73], v[72:73], v[24:25] op_sel_hi:[1,0]
  v_pk_mul_f32 v[74:75], v[74:75], v[24:25] op_sel_hi:[1,0]
  v_cvt_pk_bf16_f32 v36, v72, v73
  v_cvt_pk_bf16_f32 v37, v74, v75
  v_pk_mul_f32 v[76:77], v[76:77], v[24:25] op_sel_hi:[1,0]
  v_pk_mul_f32 v[78:79], v[78:79], v[24:25] op_sel_hi:[1,0]
  v_cvt_pk_bf16_f32 v38, v76, v77
  v_cvt_pk_bf16_f32 v39, v78, v79
  ds_write_b128 v9, v[36:39] offset:13824
  s_mov_b64 exec, -1
  v_mfma_f32_16x16x16_bf16 v[16:19], v[32:33], v[32:33], 0
  v_mfma_f32_16x16x16_bf16 v[20:23], v[32:33], v[32:33], 0
  v_mfma_f32_16x16x16_bf16 v[24:27], v[32:33], v[32:33], 0
  v_mfma_f32_16x16x16_bf16 v[28:31], v[32:33], v[32:33], 0
  s_waitcnt lgkmcnt(0)
  s_barrier
  ds_read_b128 v[72:75], v0 offset:13312
  ds_read_b128 v[76:79], v0 offset:14336
  s_waitcnt lgkmcnt(1)
  v_smfmac_f32_16x16x64_bf16 v[16:19], v[72:75], v[56:63], v1
  v_mov_b64 v[56:57], 0
  v_smfmac_f32_16x16x64_bf16 v[20:23], v[72:75], v[64:71], v1
  v_mov_b64 v[58:59], 0
  s_waitcnt lgkmcnt(0)
  v_smfmac_f32_16x16x64_bf16 v[16:19], v[76:79], v[40:47], v1
  ds_read_b128 v[40:43], v2 offset:61440
  v_mov_b64 v[60:61], 0
  v_smfmac_f32_16x16x64_bf16 v[20:23], v[76:79], v[48:55], v1
  ds_read_b128 v[44:47], v2 offset:62464
  ds_read_b128 v[48:51], v2 offset:63488
  v_mov_b64 v[62:63], 0
  v_smfmac_f32_16x16x64_bf16 v[24:27], v[72:75], v[176:183], v1
  ds_read_b128 v[52:55], v2 offset:64512
  v_add_f32 v16, v16, v18
  v_add_f32 v17, v17, v19
  v_smfmac_f32_16x16x64_bf16 v[28:31], v[72:75], v[184:191], v1
  ds_read_b128 v[64:67], v0 offset:15360
  v_cvt_pk_bf16_f32 v38, v16, v17
  v_bfi_b32 v38, v10, s35, v38
  v_smfmac_f32_16x16x64_bf16 v[24:27], v[76:79], v[192:199], v1
  ds_read_b128 v[68:71], v0 offset:15360
  v_add_f32 v20, v20, v22
  v_add_f32 v21, v21, v23
  v_smfmac_f32_16x16x64_bf16 v[28:31], v[76:79], v[200:207], v1
  v_cvt_pk_bf16_f32 v39, v20, v21
  s_waitcnt lgkmcnt(4)
  v_smfmac_f32_16x16x64_bf16 v[32:35], v[72:75], v[40:47], v1
  ds_read_b128 v[40:43], v2 offset:16384
  buffer_store_dwordx2 v[38:39], v3, s[4:7], s40 offen
  v_add_f32 v24, v24, v26
  v_add_f32 v25, v25, v27
  s_waitcnt lgkmcnt(3)
  v_smfmac_f32_16x16x64_bf16 v[32:35], v[76:79], v[48:55], v1
  ds_read_b128 v[44:47], v2 offset:17408
  v_cvt_pk_bf16_f32 v36, v24, v25
  v_bfi_b32 v36, v10, s35, v36
  v_smfmac_f32_16x16x64_bf16 v[56:59], v[72:75], v[208:215], v1
  ds_read_b128 v[48:51], v2 offset:18432
  v_add_f32 v28, v28, v30
  v_add_f32 v29, v29, v31
  v_smfmac_f32_16x16x64_bf16 v[60:63], v[72:75], v[216:223], v1
  ds_read_b128 v[52:55], v2 offset:19456
  v_cvt_pk_bf16_f32 v37, v28, v29
  v_add_f32 v32, v32, v34
  v_smfmac_f32_16x16x64_bf16 v[56:59], v[76:79], v[224:231], v1
  buffer_store_dwordx2 v[36:37], v3, s[4:7], s41 offen
  v_add_f32 v33, v33, v35
  v_cvt_pk_bf16_f32 v34, v32, v33
  v_smfmac_f32_16x16x64_bf16 v[60:63], v[76:79], v[232:239], v1
  v_bfi_b32 v34, v10, s35, v34
  s_waitcnt lgkmcnt(5)
  v_smfmac_f32_16x16x64_bf16 v[64:67], v[72:75], v[240:247], v1
  buffer_store_dword v34, v4, s[4:7], s40 offen
  v_add_f32 v56, v56, v58
  v_add_f32 v57, v57, v59
  s_waitcnt lgkmcnt(4)
  v_smfmac_f32_16x16x64_bf16 v[68:71], v[72:75], v[248:255], v1
  v_cvt_pk_bf16_f32 v38, v56, v57
  v_bfi_b32 v38, v10, s35, v38
  s_waitcnt lgkmcnt(2)
  v_smfmac_f32_16x16x64_bf16 v[64:67], v[76:79], v[40:47], v1
  v_add_f32 v60, v60, v62
  s_waitcnt lgkmcnt(0)
  v_smfmac_f32_16x16x64_bf16 v[68:71], v[76:79], v[48:55], v1
  v_add_f32 v61, v61, v63
  v_cvt_pk_bf16_f32 v39, v60, v61
  buffer_store_dwordx2 v[38:39], v3, s[4:7], s42 offen
  v_pk_add_f32 v[64:65], v[64:65], v[66:67]
  v_cvt_pk_bf16_f32 v36, v64, v65
  v_bfi_b32 v36, v10, s35, v36
  v_pk_add_f32 v[68:69], v[68:69], v[70:71]
  v_cvt_pk_bf16_f32 v37, v68, v69
  buffer_store_dwordx2 v[36:37], v3, s[4:7], s43 offen
  v_mov_b32 v40, 0x3f80
  v_cndmask_b32 v40, v40, 1.0, s[60:61]
  v_cndmask_b32 v46, 0, v40, s[66:67]
  v_cndmask_b32 v47, 0, v40, s[68:69]
  v_cndmask_b32 v44, 0, v40, s[62:63]
  v_cndmask_b32 v45, 0, v40, s[64:65]
  ds_read_b128 v[56:59], v2 offset:24576
  ds_read_b128 v[60:63], v2 offset:25600
  ds_read_b128 v[64:67], v2 offset:26624
  ds_read_b128 v[68:71], v2 offset:27648
  s_add_u32 s57, s57, s77
  s_add_u32 s48, s48, 9216
  s_add_u32 s59, s59, s77
  s_add_u32 s50, s54, s48
  s_add_u32 s49, s53, s48
  s_add_u32 s74, s74, 9216
  s_add_u32 s75, s75, 9216
  s_mov_b32 s77, 9216
  s_nop 11
  buffer_load_dwordx4 v[24:27], v0, s[4:7], s44 offen sc1
  buffer_load_dwordx4 v[28:31], v0, s[4:7], s44 offen offset:1024 sc1
  s_nop 14
  buffer_load_dwordx4 v[16:19], v0, s[20:23], s45 offen sc1
  buffer_load_dwordx4 v[20:23], v0, s[20:23], s45 offen offset:1024 sc1
  s_branch L_cf1_top
L_cf1_h2q:
L_cf1_h2r:
  buffer_load_dwordx4 v[40:43], v0, s[4:7], s48 offen offset:0 sc1
  buffer_load_dwordx4 v[52:55], v0, s[4:7], s48 offen offset:1024 sc1
  buffer_load_dwordx4 v[72:75], v0, s[4:7], s48 offen offset:2048 sc1
  buffer_load_dwordx4 v[76:79], v0, s[4:7], s48 offen offset:3072 sc1
  buffer_load_dwordx4 v[44:47], v0, s[4:7], s75 offen offset:0 sc1
  s_nop 3
L_cf1_entry:
  ds_read_b128 v[56:59], v2 offset:24576
  ds_read_b128 v[60:63], v2 offset:25600
  ds_read_b128 v[64:67], v2 offset:26624
  ds_read_b128 v[68:71], v2 offset:27648
  s_sub_u32 s31, s31, 1
  s_cbranch_scc1 L_exit
  v_mov_b64 v[16:17], 0
  v_mov_b64 v[18:19], 0
  v_mov_b64 v[20:21], 0
  v_mov_b64 v[22:23], 0
  v_mov_b64 v[24:25], 0
  v_mov_b64 v[26:27], 0
  v_mov_b64 v[28:29], 0
  v_mov_b64 v[30:31], 0
  s_branch L_cf1_h2
L_cf1_ru:
  buffer_load_dwordx4 v[24:27], v0, s[4:7], s44 offen sc1
  buffer_load_dwordx4 v[28:31], v0, s[4:7], s44 offen offset:1024 sc1
  buffer_load_dwordx4 v[16:19], v0, s[20:23], s45 offen sc1
  buffer_load_dwordx4 v[20:23], v0, s[20:23], s45 offen offset:1024 sc1
  s_sub_u32 s31, s31, 1
  s_cbranch_scc1 L_exit
  s_waitcnt vmcnt(0)
  s_branch L_cf1_h1m
L_cf1_rx:
  buffer_load_dwordx4 v[16:19], v0, s[4:7], s45 offen sc1
  buffer_load_dwordx4 v[20:23], v0, s[4:7], s45 offen offset:1024 sc1
  s_sub_u32 s31, s31, 1
  s_cbranch_scc1 L_exit
  s_waitcnt vmcnt(0)
  s_branch L_cf1_h1x
L_cf1_done:
  buffer_store_dwordx2 v[12:13], v5, s[4:7], s57 offen sc1
  buffer_store_dwordx2 v[14:15], v5, s[20:23], s59 offen sc1
  s_branch L_exit
.p2align 6
L_cf2_top:
  s_waitcnt vmcnt(0)
L_cf2_h1m:
  v_mfma_f32_16x16x32_bf16 v[40:43], v[44:47], v[24:27], 0
  v_bitop3_b32 v12, v24, v28, s35 bitop3:0x7e
  v_and_b32 v12, 1, v12
  v_mfma_f32_16x16x32_bf16 v[40:43], v[44:47], v[28:31], v[40:43]
  v_cmp_ne_u32 vcc, 0, v12
  s_cbranch_vccnz L_cf2_ru
  s_add_u32 s35, s35, 1
  s_cmp_eq_u32 s35, 63
  s_nop 2
  v_add_f32_dpp v40, v40, v40 row_ror:8 row_mask:0xf bank_mask:0xf
  v_add_f32_dpp v41, v41, v41 row_ror:8 row_mask:0xf bank_mask:0xf
  v_add_f32_dpp v42, v42, v42 row_ror:8 row_mask:0xf bank_mask:0xf
  v_add_f32_dpp v43, v43, v43 row_ror:8 row_mask:0xf bank_mask:0xf
  v_add_f32_dpp v40, v40, v40 row_ror:4 row_mask:0xf bank_mask:0xf
  v_add_f32_dpp v41, v41, v41 row_ror:4 row_mask:0xf bank_mask:0xf
  v_add_f32_dpp v42, v42, v42 row_ror:4 row_mask:0xf bank_mask:0xf
  v_add_f32_dpp v43, v43, v43 row_ror:4 row_mask:0xf bank_mask:0xf
  v_cvt_pk_bf16_f32 v12, v40, v41
  v_cvt_pk_bf16_f32 v13, v42, v43
  buffer_store_dwordx2 v[12:13], v5, s[4:7], s49 offen
  s_cbranch_scc1 L_cf2_done
  s_barrier
L_cf2_h2:
  buffer_load_dwordx4 v[40:43], v0, s[4:7], s48 offen offset:0
  v_mov_b64 v[24:25], 0
  v_mov_b64 v[26:27], 0
  v_mov_b64 v[28:29], 0
  v_mov_b64 v[30:31], 0
  s_nop 3
  buffer_load_dwordx4 v[52:55], v0, s[4:7], s48 offen offset:1024
  s_nop 7
  buffer_load_dwordx4 v[72:75], v0, s[4:7], s48 offen offset:2048
  s_nop 7
  buffer_load_dwordx4 v[76:79], v0, s[4:7], s48 offen offset:3072
  s_nop 7
  buffer_load_dwordx4 v[48:51], v0, s[4:7], s74 offen offset:0 sc1
  s_waitcnt vmcnt(4) lgkmcnt(0)
  v_smfmac_f32_16x16x64_bf16 v[16:19], v[40:43], v[56:63], v1
  buffer_load_dwordx4 v[44:47], v0, s[4:7], s75 offen offset:0
  ds_read_b128 v[56:59], v2 offset:36864
  v_max_u32 v11, v40, v42
  v_smfmac_f32_16x16x64_bf16 v[20:23], v[40:43], v[64:71], v1
  ds_read_b128 v[60:63], v2 offset:37888
  v_smfmac_f32_16x16x64_bf16 v[24:27], v[40:43], a[0:7], v1
  ds_read_b128 v[64:67], v2 offset:38912
  v_smfmac_f32_16x16x64_bf16 v[28:31], v[40:43], a[8:15], v1
  ds_read_b128 v[68:71], v2 offset:39936
  s_waitcnt vmcnt(4)
  v_smfmac_f32_16x16x64_bf16 v[16:19], v[52:55], a[32:39], v1
  v_max3_u32 v11, v11, v52, v54
  v_smfmac_f32_16x16x64_bf16 v[20:23], v[52:55], a[40:47], v1
  v_smfmac_f32_16x16x64_bf16 v[24:27], v[52:55], a[48:55], v1
  v_smfmac_f32_16x16x64_bf16 v[28:31], v[52:55], a[56:63], v1
  s_waitcnt vmcnt(3) lgkmcnt(2)
  v_smfmac_f32_16x16x64_bf16 v[16:19], v[72:75], v[56:63], v1
  ds_read_b128 v[56:59], v2 offset:61440
  buffer_load_dwordx4 v[32:35], v0, s[4:7], s55 offen offset:2048 sc1
  v_max3_u32 v11, v11, v72, v74
  s_waitcnt lgkmcnt(1)
  v_smfmac_f32_16x16x64_bf16 v[20:23], v[72:75], v[64:71], v1
  ds_write_b128 v0, v[72:75] offset:2048
  ds_read_b128 v[60:63], v2 offset:62464
  v_smfmac_f32_16x16x64_bf16 v[24:27], v[72:75], a[80:87], v1
  ds_read_b128 v[64:67], v2 offset:63488
  v_smfmac_f32_16x16x64_bf16 v[28:31], v[72:75], a[88:95], v1
  ds_read_b128 v[68:71], v2 offset:64512
  s_waitcnt vmcnt(3)
  v_smfmac_f32_16x16x64_bf16 v[16:19], v[76:79], a[112:119], v1
  v_max3_u32 v11, v11, v76, v78
  v_smfmac_f32_16x16x64_bf16 v[20:23], v[76:79], a[120:127], v1
  v_smfmac_f32_16x16x64_bf16 v[24:27], v[76:79], a[128:135], v1
  buffer_load_dwordx4 v[72:75], v0, s[4:7], s55 offen offset:0 sc1
  v_smfmac_f32_16x16x64_bf16 v[28:31], v[76:79], a[136:143], v1
  s_waitcnt vmcnt(3)
  ds_write_b128 v0, v[48:51] offset:6144
  s_waitcnt vmcnt(2) lgkmcnt(3)
  v_smfmac_f32_16x16x64_bf16 v[16:19], v[44:47], v[56:63], v1
  ds_read_b128 v[56:59], v2 offset:53248
  v_max3_u32 v11, v11, v44, v46
  s_waitcnt lgkmcnt(2)
  v_smfmac_f32_16x16x64_bf16 v[20:23], v[44:47], v[64:71], v1
  ds_read_b128 v[60:63], v2 offset:54272
  ds_read_b128 v[64:67], v2 offset:55296
  v_max3_u32 v11, v11, v48, v50
  v_smfmac_f32_16x16x64_bf16 v[24:27], v[44:47], v[144:151], v1
  ds_read_b128 v[68:71], v2 offset:56320
  buffer_load_dwordx4 v[76:79], v0, s[4:7], s55 offen offset:1024 sc1
  v_cmp_eq_u32 vcc, -1, v11
  v_smfmac_f32_16x16x64_bf16 v[28:31], v[44:47], v[152:159], v1
  v_lshlrev_b32 v6, 3, v0
  v_smfmac_f32_16x16x64_bf16 v[24:27], v[48:51], a[240:247], v1
  s_cbranch_vccnz L_cf2_h2q
  v_smfmac_f32_16x16x64_bf16 v[28:31], v[48:51], a[248:255], v1
  s_waitcnt lgkmcnt(4)
  s_barrier
  ds_read_b128 v[40:43], v0 offset:7168
  s_waitcnt lgkmcnt(3)
  v_smfmac_f32_16x16x64_bf16 v[16:19], v[48:51], v[56:63], v1
  ds_read_b128 v[52:55], v0 offset:4096
  ds_read_b128 v[56:59], v2 offset:45056
  buffer_load_dwordx4 v[36:39], v0, s[4:7], s55 offen offset:3072 sc1
  s_waitcnt lgkmcnt(3)
  v_smfmac_f32_16x16x64_bf16 v[20:23], v[48:51], v[64:71], v1
  ds_read_b128 v[60:63], v2 offset:46080
  ds_read_b128 v[64:67], v2 offset:47104
  s_waitcnt lgkmcnt(4)
  v_smfmac_f32_16x16x64_bf16 v[16:19], v[40:43], v[96:103], v1
  ds_read_b128 v[48:51], v0 offset:5120
  ds_read_b128 v[68:71], v2 offset:48128
  s_add_u32 s55, s55, s56
  v_smfmac_f32_16x16x64_bf16 v[20:23], v[40:43], v[104:111], v1
  v_smfmac_f32_16x16x64_bf16 v[24:27], v[40:43], v[112:119], v1
  v_smfmac_f32_16x16x64_bf16 v[28:31], v[40:43], v[120:127], v1
  s_waitcnt lgkmcnt(3)
  v_smfmac_f32_16x16x64_bf16 v[16:19], v[52:55], v[56:63], v1
  s_waitcnt lgkmcnt(0)
  v_smfmac_f32_16x16x64_bf16 v[20:23], v[52:55], v[64:71], v1
  v_smfmac_f32_16x16x64_bf16 v[16:19], v[48:51], a[192:199], v1
  v_smfmac_f32_16x16x64_bf16 v[20:23], v[48:51], a[200:207], v1
  ds_read_b128 v[64:67], v0 offset:15360
  s_mov_b32 exec_hi, 0
  buffer_load_dword v6, v6, s[4:7], s55 offen sc1
  s_mov_b32 exec_hi, -1
  v_smfmac_f32_16x16x64_bf16 v[24:27], v[52:55], a[160:167], v1
  ds_read_b128 v[68:71], v0 offset:15360
  v_add_f32 v16, v16, v18
  v_smfmac_f32_16x16x64_bf16 v[24:27], v[48:51], a[208:215], v1
  s_nop 0
  s_nop 0
  v_add_f32 v17, v17, v19
  v_smfmac_f32_16x16x64_bf16 v[28:31], v[52:55], a[168:175], v1
  s_mov_b64 vcc, s[72:73]
  v_cvt_pk_bf16_f32 v57, v16, v17
  v_smfmac_f32_16x16x64_bf16 v[28:31], v[48:51], a[216:223], v1
  v_add_f32 v24, v24, v26
  v_add_f32 v25, v25, v27
  v_cvt_pk_bf16_f32 v56, v24, v25
  ds_write_b64 v7, v[56:57] offset:10240
  v_pk_add_f32 v[20:21], v[20:21], v[22:23]
  s_nop 0
  v_pk_add_f32 v[28:29], v[28:29], v[30:31]
  v_cvt_pk_bf16_f32 v59, v20, v21
  v_cvt_pk_bf16_f32 v58, v28, v29
  ds_write_b64 v7, v[58:59] offset:10752
  ds_read_b64_tr_b16 v[60:61], v8 offset:10240
  ds_read_b64_tr_b16 v[62:63], v8 offset:10752
  s_waitcnt lgkmcnt(5)
  v_smfmac_f32_16x16x64_bf16 v[64:67], v[44:47], v[160:167], v1
  s_waitcnt lgkmcnt(4)
  v_smfmac_f32_16x16x64_bf16 v[68:71], v[44:47], v[168:175], v1
  ds_read_b128 v[44:47], v0 offset:0
  v_lshrrev_b32 v59, 2, v0
  v_smfmac_f32_16x16x64_bf16 v[64:67], v[40:43], v[128:135], v1
  buffer_store_dwordx2 v[12:13], v5, s[4:7], s57 offen sc1
  v_mov_b32 v31, 0x3f803f80
  v_smfmac_f32_16x16x64_bf16 v[68:71], v[40:43], v[136:143], v1
  ds_read_b128 v[40:43], v0 offset:1024
  v_smfmac_f32_16x16x64_bf16 v[64:67], v[52:55], a[176:183], v1
  s_waitcnt vmcnt(4) lgkmcnt(2)
  v_mfma_f32_16x16x32_bf16 v[16:19], v[72:75], v[60:63], 0
  v_mov_b32 v30, 0x3f803f80
  s_waitcnt vmcnt(3)
  v_mfma_f32_16x16x32_bf16 v[20:23], v[76:79], v[60:63], 0
  v_mov_b32 v29, 0x3f803f80
  v_mfma_f32_16x16x32_bf16 v[24:27], v[60:63], v[60:63], 0
  v_mov_b32 v28, 0x3f803f80
  v_smfmac_f32_16x16x64_bf16 v[68:71], v[52:55], a[184:191], v1
  ds_read_b128 v[52:55], v0 offset:2048
  v_cndmask_b32_dpp v16, v20, v16, vcc quad_perm:[2,3,0,1] row_mask:0xf bank_mask:0xf
  v_cndmask_b32_dpp v17, v21, v17, vcc quad_perm:[2,3,0,1] row_mask:0xf bank_mask:0xf
  v_cndmask_b32_dpp v18, v22, v18, vcc quad_perm:[2,3,0,1] row_mask:0xf bank_mask:0xf
  v_cndmask_b32_dpp v19, v23, v19, vcc quad_perm:[2,3,0,1] row_mask:0xf bank_mask:0xf
  v_cndmask_b32_dpp v24, v25, v24, vcc quad_perm:[2,3,0,1] row_mask:0xf bank_mask:0xf
  v_smfmac_f32_16x16x64_bf16 v[64:67], v[48:51], a[224:231], v1
  ds_write_b128 v0, v[16:19] offset:10240
  ds_write_b32 v59, v24 offset:12800
  v_smfmac_f32_16x16x64_bf16 v[68:71], v[48:51], a[232:239], v1
  ds_read_b128 v[48:51], v0 offset:3072
  s_waitcnt lgkmcnt(5)
  v_smfmac_f32_16x16x64_bf16 v[64:67], v[44:47], a[16:23], v1
  v_smfmac_f32_16x16x64_bf16 v[68:71], v[44:47], a[24:31], v1
  ds_read_b128 v[44:47], v0 offset:6144
  s_waitcnt lgkmcnt(5)
  v_smfmac_f32_16x16x64_bf16 v[64:67], v[40:43], a[64:71], v1
  v_smfmac_f32_16x16x64_bf16 v[68:71], v[40:43], a[72:79], v1
  s_waitcnt lgkmcnt(2)
  s_barrier
  ds_read_b128 v[20:23], v0 offset:11264
  ds_read_b128 v[72:75], v0 offset:8192
  v_smfmac_f32_16x16x64_bf16 v[64:67], v[52:55], a[96:103], v1
  ds_read_b128 v[76:79], v0 offset:9216
  v_smfmac_f32_16x16x64_bf16 v[68:71], v[52:55], a[104:111], v1
  ds_read2st64_b32 v[26:27], v59 offset0:51 offset1:48
  s_waitcnt lgkmcnt(5)
  v_smfmac_f32_16x16x64_bf16 v[64:67], v[48:51], a[144:151], v1
  ds_read_b32 v25, v59 offset:12544
  v_smfmac_f32_16x16x64_bf16 v[68:71], v[48:51], a[152:159], v1
  ds_read_b128 v[60:63], v2 offset:5120
  s_waitcnt lgkmcnt(6)
  v_smfmac_f32_16x16x64_bf16 v[64:67], v[44:47], v[80:87], v1
  ds_read_b128 v[56:59], v2 offset:4096
  v_smfmac_f32_16x16x64_bf16 v[68:71], v[44:47], v[88:95], v1
  ds_read_b128 v[40:43], v2 offset:12288
  s_waitcnt lgkmcnt(7)
  v_add_f32 v16, v16, v20
  v_add_f32 v17, v17, v21
  v_add_f32 v18, v18, v22
  v_add_f32 v19, v19, v23
  s_waitcnt lgkmcnt(5)
  v_pk_add_f32 v[72:73], v[72:73], v[76:77]
  v_pk_add_f32 v[74:75], v[74:75], v[78:79]
  s_waitcnt lgkmcnt(3)
  v_pk_add_f32 v[24:25], v[24:25], v[26:27]
  v_pk_add_f32 v[16:17], v[16:17], v[72:73]
  v_pk_add_f32 v[18:19], v[18:19], v[74:75]
  v_add_f32 v24, v24, v25
  v_max3_f32 v72, v16, v17, v18
  v_max3_f32 v72, v72, v19, v24
  v_pk_add_f32 v[64:65], v[64:65], v[66:67]
  v_pk_add_f32 v[68:69], v[68:69], v[70:71]
  v_max_f32_dpp v72, v72, v72 quad_perm:[2,3,0,1] row_mask:0xf bank_mask:0xf
  v_mov_b32 v73, v72
  v_cvt_pk_bf16_f32 v70, v64, v65
  v_cvt_pk_bf16_f32 v71, v68, v69
  v_permlane16_swap_b32 v73, v72
  v_max_f32 v72, v72, v73
  v_mov_b32 v73, v72
  v_mov_b32 v27, 0
  v_mov_b32 v68, 0
  v_permlane32_swap_b32 v73, v72
  v_max_f32 v72, v72, v73
  v_mul_f32 v72, s70, v72
  v_fma_f32 v16, v16, s70, -v72
  v_fma_f32 v17, v17, s70, -v72
  v_fma_f32 v18, v18, s70, -v72
  v_fma_f32 v19, v19, s70, -v72
  v_fma_f32 v24, v24, s70, -v72
  v_exp_f32 v16, v16
  v_exp_f32 v17, v17
  v_exp_f32 v18, v18
  v_exp_f32 v19, v19
  v_cvt_pk_bf16_f32 v20, v16, v17
  v_cvt_pk_bf16_f32 v21, v18, v19
  v_exp_f32 v24, v24
  v_mov_b32_dpp v22, v20 quad_perm:[2,3,0,1] row_mask:0xf bank_mask:0xf
  v_mov_b32_dpp v23, v21 quad_perm:[2,3,0,1] row_mask:0xf bank_mask:0xf
  v_mov_b32_dpp v25, v24 quad_perm:[2,3,0,1] row_mask:0xf bank_mask:0xf
  v_cvt_pk_bf16_f32 v26, v24, v25
  v_mfma_f32_16x16x32_bf16 v[16:19], v[28:31], v[20:23], 0
  ds_read_b128 v[48:51], v2 offset:14336
  v_mov_b32 v69, v26
  v_mfma_f32_16x16x32_bf16 v[72:75], v[32:35], v[20:23], 0
  ds_read_b128 v[52:55], v2 offset:15360
  v_mov_b64 v[32:33], 0
  v_mfma_f32_16x16x16_bf16 v[16:19], v[28:29], v[26:27], v[16:19]
  ds_read_b128 v[44:47], v2 offset:13312
  v_mov_b64 v[34:35], 0
  s_waitcnt vmcnt(2)
  v_mfma_f32_16x16x32_bf16 v[76:79], v[36:39], v[20:23], 0
  ds_read_b128 v[64:67], v2 offset:6144
  v_mfma_f32_16x16x16_bf16 v[72:75], v[70:71], v[26:27], v[72:75]
  v_rcp_f32 v24, v16
  v_mfma_f32_16x16x16_bf16 v[76:79], v[70:71], v[68:69], v[76:79]
  ds_read_b128 v[68:71], v2 offset:7168
  s_mov_b64 exec, s[72:73]
  s_nop 1
  v_pk_mul_f32 v[72:73], v[72:73], v[24:25] op_sel_hi:[1,0]
  v_pk_mul_f32 v[74:75], v[74:75], v[24:25] op_sel_hi:[1,0]
  v_cvt_pk_bf16_f32 v36, v72, v73
  v_cvt_pk_bf16_f32 v37, v74, v75
  v_pk_mul_f32 v[76:77], v[76:77], v[24:25] op_sel_hi:[1,0]
  v_pk_mul_f32 v[78:79], v[78:79], v[24:25] op_sel_hi:[1,0]
  v_cvt_pk_bf16_f32 v38, v76, v77
  v_cvt_pk_bf16_f32 v39, v78, v79
  ds_write_b128 v9, v[36:39] offset:14336
  s_mov_b64 exec, -1
  v_mfma_f32_16x16x16_bf16 v[16:19], v[32:33], v[32:33], 0
  v_mfma_f32_16x16x16_bf16 v[20:23], v[32:33], v[32:33], 0
  v_mfma_f32_16x16x16_bf16 v[24:27], v[32:33], v[32:33], 0
  v_mfma_f32_16x16x16_bf16 v[28:31], v[32:33], v[32:33], 0
  s_waitcnt lgkmcnt(0)
  s_barrier
  ds_read_b128 v[72:75], v0 offset:13312
  ds_read_b128 v[76:79], v0 offset:14336
  s_waitcnt lgkmcnt(1)
  v_smfmac_f32_16x16x64_bf16 v[16:19], v[72:75], v[56:63], v1
  v_mov_b64 v[56:57], 0
  v_smfmac_f32_16x16x64_bf16 v[20:23], v[72:75], v[64:71], v1
  v_mov_b64 v[58:59], 0
  s_waitcnt lgkmcnt(0)
  v_smfmac_f32_16x16x64_bf16 v[16:19], v[76:79], v[40:47], v1
  ds_read_b128 v[40:43], v2 offset:0
  v_mov_b64 v[60:61], 0
  v_smfmac_f32_16x16x64_bf16 v[20:23], v[76:79], v[48:55], v1
  ds_read_b128 v[44:47], v2 offset:1024
  ds_read_b128 v[48:51], v2 offset:2048
  v_mov_b64 v[62:63], 0
  v_smfmac_f32_16x16x64_bf16 v[24:27], v[72:75], v[176:183], v1
  ds_read_b128 v[52:55], v2 offset:3072
  v_add_f32 v16, v16, v18
  v_add_f32 v17, v17, v19
  v_smfmac_f32_16x16x64_bf16 v[28:31], v[72:75], v[184:191], v1
  ds_read_b128 v[64:67], v0 offset:15360
  v_cvt_pk_bf16_f32 v38, v16, v17
  v_bfi_b32 v38, v10, s35, v38
  v_smfmac_f32_16x16x64_bf16 v[24:27], v[76:79], v[192:199], v1
  ds_read_b128 v[68:71], v0 offset:15360
  v_add_f32 v20, v20, v22
  v_add_f32 v21, v21, v23
  v_smfmac_f32_16x16x64_bf16 v[28:31], v[76:79], v[200:207], v1
  v_cvt_pk_bf16_f32 v39, v20, v21
  s_waitcnt lgkmcnt(4)
  v_smfmac_f32_16x16x64_bf16 v[32:35], v[72:75], v[40:47], v1
  ds_read_b128 v[40:43], v2 offset:20480
  buffer_store_dwordx2 v[38:39], v3, s[4:7], s40 offen
  v_add_f32 v24, v24, v26
  v_add_f32 v25, v25, v27
  s_waitcnt lgkmcnt(3)
  v_smfmac_f32_16x16x64_bf16 v[32:35], v[76:79], v[48:55], v1
  ds_read_b128 v[44:47], v2 offset:21504
  v_cvt_pk_bf16_f32 v36, v24, v25
  v_bfi_b32 v36, v10, s35, v36
  v_smfmac_f32_16x16x64_bf16 v[56:59], v[72:75], v[208:215], v1
  ds_read_b128 v[48:51], v2 offset:22528
  v_add_f32 v28, v28, v30
  v_add_f32 v29, v29, v31
  v_smfmac_f32_16x16x64_bf16 v[60:63], v[72:75], v[216:223], v1
  ds_read_b128 v[52:55], v2 offset:23552
  v_cvt_pk_bf16_f32 v37, v28, v29
  v_add_f32 v32, v32, v34
  v_smfmac_f32_16x16x64_bf16 v[56:59], v[76:79], v[224:231], v1
  buffer_store_dwordx2 v[36:37], v3, s[4:7], s41 offen
  v_add_f32 v33, v33, v35
  v_cvt_pk_bf16_f32 v34, v32, v33
  v_smfmac_f32_16x16x64_bf16 v[60:63], v[76:79], v[232:239], v1
  v_bfi_b32 v34, v10, s35, v34
  s_waitcnt lgkmcnt(5)
  v_smfmac_f32_16x16x64_bf16 v[64:67], v[72:75], v[240:247], v1
  buffer_store_dword v34, v4, s[4:7], s40 offen
  v_add_f32 v56, v56, v58
  v_add_f32 v57, v57, v59
  s_waitcnt lgkmcnt(4)
  v_smfmac_f32_16x16x64_bf16 v[68:71], v[72:75], v[248:255], v1
  v_cvt_pk_bf16_f32 v38, v56, v57
  v_bfi_b32 v38, v10, s35, v38
  s_waitcnt lgkmcnt(2)
  v_smfmac_f32_16x16x64_bf16 v[64:67], v[76:79], v[40:47], v1
  v_add_f32 v60, v60, v62
  s_waitcnt lgkmcnt(0)
  v_smfmac_f32_16x16x64_bf16 v[68:71], v[76:79], v[48:55], v1
  v_add_f32 v61, v61, v63
  v_cvt_pk_bf16_f32 v39, v60, v61
  buffer_store_dwordx2 v[38:39], v3, s[4:7], s42 offen
  v_pk_add_f32 v[64:65], v[64:65], v[66:67]
  v_cvt_pk_bf16_f32 v36, v64, v65
  v_bfi_b32 v36, v10, s35, v36
  v_pk_add_f32 v[68:69], v[68:69], v[70:71]
  v_cvt_pk_bf16_f32 v37, v68, v69
  buffer_store_dwordx2 v[36:37], v3, s[4:7], s43 offen
  v_mov_b32 v40, 0x3f80
  v_cndmask_b32 v40, v40, 1.0, s[60:61]
  v_cndmask_b32 v46, 0, v40, s[66:67]
  v_cndmask_b32 v47, 0, v40, s[68:69]
  v_cndmask_b32 v44, 0, v40, s[62:63]
  v_cndmask_b32 v45, 0, v40, s[64:65]
  ds_read_b128 v[56:59], v2 offset:28672
  ds_read_b128 v[60:63], v2 offset:29696
  ds_read_b128 v[64:67], v2 offset:30720
  ds_read_b128 v[68:71], v2 offset:31744
  v_mov_b64 v[16:17], 0
  v_mov_b64 v[18:19], 0
  v_mov_b64 v[20:21], 0
  v_mov_b64 v[22:23], 0
  s_add_u32 s57, s57, s77
  s_add_u32 s48, s48, 9216
  s_add_u32 s49, s53, s48
  s_add_u32 s74, s74, 9216
  s_add_u32 s75, s75, 9216
  s_mov_b32 s77, 9216
  s_nop 15
  s_nop 15
  s_nop 15
  buffer_load_dwordx4 v[24:27], v0, s[4:7], s44 offen sc1
  buffer_load_dwordx4 v[28:31], v0, s[4:7], s44 offen offset:1024 sc1
  s_branch L_cf2_top
L_cf2_h2q:
L_cf2_h2r:
  buffer_load_dwordx4 v[40:43], v0, s[4:7], s48 offen offset:0 sc1
  buffer_load_dwordx4 v[52:55], v0, s[4:7], s48 offen offset:1024 sc1
  buffer_load_dwordx4 v[72:75], v0, s[4:7], s48 offen offset:2048 sc1
  buffer_load_dwordx4 v[76:79], v0, s[4:7], s48 offen offset:3072 sc1
  buffer_load_dwordx4 v[44:47], v0, s[4:7], s75 offen offset:0 sc1
  s_nop 3
L_cf2_entry:
  ds_read_b128 v[56:59], v2 offset:28672
  ds_read_b128 v[60:63], v2 offset:29696
  ds_read_b128 v[64:67], v2 offset:30720
  ds_read_b128 v[68:71], v2 offset:31744
  s_sub_u32 s31, s31, 1
  s_cbranch_scc1 L_exit
  v_mov_b64 v[16:17], 0
  v_mov_b64 v[18:19], 0
  v_mov_b64 v[20:21], 0
  v_mov_b64 v[22:23], 0
  v_mov_b64 v[24:25], 0
  v_mov_b64 v[26:27], 0
  v_mov_b64 v[28:29], 0
  v_mov_b64 v[30:31], 0
  s_branch L_cf2_h2
L_cf2_ru:
  buffer_load_dwordx4 v[24:27], v0, s[4:7], s44 offen sc1
  buffer_load_dwordx4 v[28:31], v0, s[4:7], s44 offen offset:1024 sc1
  s_sub_u32 s31, s31, 1
  s_cbranch_scc1 L_exit
  s_waitcnt vmcnt(0)
  s_branch L_cf2_h1m
L_cf2_done:
  buffer_store_dwordx2 v[12:13], v5, s[4:7], s57 offen sc1
  s_branch L_exit
.p2align 6
L_cf3_top:
  s_waitcnt vmcnt(0)
L_cf3_h1m:
  v_mfma_f32_16x16x32_bf16 v[40:43], v[44:47], v[24:27], 0
  v_bitop3_b32 v12, v24, v28, s35 bitop3:0x7e
  v_and_b32 v12, 1, v12
  v_mfma_f32_16x16x32_bf16 v[40:43], v[44:47], v[28:31], v[40:43]
  v_cmp_ne_u32 vcc, 0, v12
  s_cbranch_vccnz L_cf3_ru
  s_add_u32 s35, s35, 1
  s_add_u32 s58, s58, 4
  v_readfirstlane_b32 s76, v6
  s_cmp_eq_u32 s35, 63
  s_nop 0
  v_add_f32_dpp v40, v40, v40 row_ror:8 row_mask:0xf bank_mask:0xf
  v_add_f32_dpp v41, v41, v41 row_ror:8 row_mask:0xf bank_mask:0xf
  v_add_f32_dpp v42, v42, v42 row_ror:8 row_mask:0xf bank_mask:0xf
  v_add_f32_dpp v43, v43, v43 row_ror:8 row_mask:0xf bank_mask:0xf
  v_add_f32_dpp v40, v40, v40 row_ror:4 row_mask:0xf bank_mask:0xf
  v_add_f32_dpp v41, v41, v41 row_ror:4 row_mask:0xf bank_mask:0xf
  v_add_f32_dpp v42, v42, v42 row_ror:4 row_mask:0xf bank_mask:0xf
  v_add_f32_dpp v43, v43, v43 row_ror:4 row_mask:0xf bank_mask:0xf
  v_cvt_pk_bf16_f32 v12, v40, v41
  v_cvt_pk_bf16_f32 v13, v42, v43
  buffer_store_dwordx2 v[12:13], v5, s[4:7], s49 offen
  s_cbranch_scc1 L_cf3_done
  s_barrier
L_cf3_h2:
  buffer_load_dwordx4 v[40:43], v0, s[4:7], s48 offen offset:0
  v_mov_b64 v[24:25], 0
  v_mov_b64 v[26:27], 0
  v_mov_b64 v[28:29], 0
  v_mov_b64 v[30:31], 0
  s_nop 3
  buffer_load_dwordx4 v[52:55], v0, s[4:7], s48 offen offset:1024
  s_nop 7
  buffer_load_dwordx4 v[72:75], v0, s[4:7], s48 offen offset:2048
  s_nop 7
  buffer_load_dwordx4 v[76:79], v0, s[4:7], s48 offen offset:3072
  s_nop 7
  buffer_load_dwordx4 v[48:51], v0, s[4:7], s74 offen offset:0 sc1
  s_waitcnt vmcnt(4) lgkmcnt(0)
  v_smfmac_f32_16x16x64_bf16 v[16:19], v[40:43], v[56:63], v1
  buffer_load_dwordx4 v[44:47], v0, s[4:7], s75 offen offset:0
  ds_read_b128 v[56:59], v2 offset:32768
  v_max_u32 v11, v40, v42
  v_smfmac_f32_16x16x64_bf16 v[20:23], v[40:43], v[64:71], v1
  ds_read_b128 v[60:63], v2 offset:33792
  v_smfmac_f32_16x16x64_bf16 v[24:27], v[40:43], a[0:7], v1
  ds_read_b128 v[64:67], v2 offset:34816
  v_smfmac_f32_16x16x64_bf16 v[28:31], v[40:43], a[8:15], v1
  ds_read_b128 v[68:71], v2 offset:35840
  s_waitcnt vmcnt(4)
  v_smfmac_f32_16x16x64_bf16 v[16:19], v[52:55], a[32:39], v1
  v_max3_u32 v11, v11, v52, v54
  v_smfmac_f32_16x16x64_bf16 v[20:23], v[52:55], a[40:47], v1
  v_smfmac_f32_16x16x64_bf16 v[24:27], v[52:55], a[48:55], v1
  v_smfmac_f32_16x16x64_bf16 v[28:31], v[52:55], a[56:63], v1
  s_waitcnt vmcnt(3) lgkmcnt(2)
  v_smfmac_f32_16x16x64_bf16 v[16:19], v[72:75], v[56:63], v1
  ds_read_b128 v[56:59], v2 offset:57344
  v_max3_u32 v11, v11, v72, v74
  s_waitcnt lgkmcnt(1)
  v_smfmac_f32_16x16x64_bf16 v[20:23], v[72:75], v[64:71], v1
  ds_read_b128 v[60:63], v2 offset:58368
  buffer_load_dwordx4 v[32:35], v0, s[4:7], s55 offen offset:2048 sc1
  s_cmp_eq_u32 s76, 0
  s_cbranch_scc1 L_cf3_kvwait
L_cf3_kvok:
  v_smfmac_f32_16x16x64_bf16 v[24:27], v[72:75], a[80:87], v1
  ds_read_b128 v[64:67], v2 offset:59392
  v_smfmac_f32_16x16x64_bf16 v[28:31], v[72:75], a[88:95], v1
  ds_read_b128 v[68:71], v2 offset:60416
  s_waitcnt vmcnt(3)
  v_smfmac_f32_16x16x64_bf16 v[16:19], v[76:79], a[112:119], v1
  v_max3_u32 v11, v11, v76, v78
  v_smfmac_f32_16x16x64_bf16 v[20:23], v[76:79], a[120:127], v1
  ds_write_b128 v0, v[76:79] offset:3072
  v_smfmac_f32_16x16x64_bf16 v[24:27], v[76:79], a[128:135], v1
  v_smfmac_f32_16x16x64_bf16 v[28:31], v[76:79], a[136:143], v1
  s_waitcnt vmcnt(2)
  ds_write_b128 v0, v[48:51] offset:7168
  buffer_load_dwordx4 v[72:75], v0, s[4:7], s55 offen offset:0 sc1
  s_waitcnt vmcnt(2) lgkmcnt(4)
  v_smfmac_f32_16x16x64_bf16 v[16:19], v[44:47], v[56:63], v1
  ds_read_b128 v[56:59], v2 offset:49152
  v_max3_u32 v11, v11, v44, v46
  s_waitcnt lgkmcnt(3)
  v_smfmac_f32_16x16x64_bf16 v[20:23], v[44:47], v[64:71], v1
  ds_read_b128 v[60:63], v2 offset:50176
  v_max3_u32 v11, v11, v48, v50
  v_smfmac_f32_16x16x64_bf16 v[24:27], v[44:47], v[144:151], v1
  ds_read_b128 v[64:67], v2 offset:51200
  v_cmp_eq_u32 vcc, -1, v11
  v_smfmac_f32_16x16x64_bf16 v[28:31], v[44:47], v[152:159], v1
  ds_read_b128 v[68:71], v2 offset:52224
  buffer_load_dwordx4 v[76:79], v0, s[4:7], s55 offen offset:1024 sc1
  v_lshlrev_b32 v6, 3, v0
  v_smfmac_f32_16x16x64_bf16 v[24:27], v[48:51], v[112:119], v1
  s_cbranch_vccnz L_cf3_h2q
  v_smfmac_f32_16x16x64_bf16 v[28:31], v[48:51], v[120:127], v1
  s_waitcnt lgkmcnt(4)
  s_barrier
  ds_read_b128 v[40:43], v0 offset:6144
  v_smfmac_f32_16x16x64_bf16 v[16:19], v[48:51], v[96:103], v1
  ds_read_b128 v[52:55], v0 offset:5120
  v_smfmac_f32_16x16x64_bf16 v[20:23], v[48:51], v[104:111], v1
  buffer_load_dwordx4 v[36:39], v0, s[4:7], s55 offen offset:3072 sc1
  s_waitcnt lgkmcnt(1)
  v_smfmac_f32_16x16x64_bf16 v[16:19], v[40:43], v[56:63], v1
  ds_read_b128 v[48:51], v0 offset:4096
  ds_read_b128 v[56:59], v2 offset:40960
  s_add_u32 s55, s55, s56
  v_smfmac_f32_16x16x64_bf16 v[20:23], v[40:43], v[64:71], v1
  ds_read_b128 v[60:63], v2 offset:41984
  ds_read_b128 v[64:67], v2 offset:43008
  s_mov_b32 exec_hi, 0
  buffer_load_dword v6, v6, s[4:7], s55 offen sc1
  s_mov_b32 exec_hi, -1
  v_smfmac_f32_16x16x64_bf16 v[24:27], v[40:43], a[240:247], v1
  ds_read_b128 v[68:71], v2 offset:44032
  buffer_load_dword v6, off, s[4:7], s58 offset:4 sc1
  v_smfmac_f32_16x16x64_bf16 v[28:31], v[40:43], a[248:255], v1
  s_waitcnt lgkmcnt(5)
  v_smfmac_f32_16x16x64_bf16 v[16:19], v[52:55], a[192:199], v1
  v_smfmac_f32_16x16x64_bf16 v[20:23], v[52:55], a[200:207], v1
  s_waitcnt lgkmcnt(2)
  v_smfmac_f32_16x16x64_bf16 v[16:19], v[48:51], v[56:63], v1
  s_waitcnt lgkmcnt(0)
  v_smfmac_f32_16x16x64_bf16 v[20:23], v[48:51], v[64:71], v1
  ds_read_b128 v[64:67], v0 offset:15360
  v_smfmac_f32_16x16x64_bf16 v[24:27], v[52:55], a[208:215], v1
  ds_read_b128 v[68:71], v0 offset:15360
  v_add_f32 v16, v16, v18
  v_smfmac_f32_16x16x64_bf16 v[24:27], v[48:51], a[160:167], v1
  s_nop 0
  s_nop 0
  v_add_f32 v17, v17, v19
  v_smfmac_f32_16x16x64_bf16 v[28:31], v[52:55], a[216:223], v1
  s_mov_b64 vcc, s[72:73]
  v_cvt_pk_bf16_f32 v57, v16, v17
  v_smfmac_f32_16x16x64_bf16 v[28:31], v[48:51], a[168:175], v1
  v_add_f32 v24, v24, v26
  v_add_f32 v25, v25, v27
  v_cvt_pk_bf16_f32 v56, v24, v25
  ds_write_b64 v7, v[56:57] offset:11264
  v_pk_add_f32 v[20:21], v[20:21], v[22:23]
  s_nop 0
  v_pk_add_f32 v[28:29], v[28:29], v[30:31]
  v_cvt_pk_bf16_f32 v59, v20, v21
  v_cvt_pk_bf16_f32 v58, v28, v29
  ds_write_b64 v7, v[58:59] offset:11776
  ds_read_b64_tr_b16 v[60:61], v8 offset:11264
  ds_read_b64_tr_b16 v[62:63], v8 offset:11776
  s_waitcnt lgkmcnt(5)
  v_smfmac_f32_16x16x64_bf16 v[64:67], v[44:47], v[160:167], v1
  s_waitcnt lgkmcnt(4)
  v_smfmac_f32_16x16x64_bf16 v[68:71], v[44:47], v[168:175], v1
  ds_read_b128 v[44:47], v0 offset:0
  v_lshrrev_b32 v59, 2, v0
  v_smfmac_f32_16x16x64_bf16 v[64:67], v[40:43], v[80:87], v1
  v_mov_b32 v31, 0x3f803f80
  v_smfmac_f32_16x16x64_bf16 v[68:71], v[40:43], v[88:95], v1
  buffer_store_dwordx2 v[12:13], v5, s[4:7], s57 offen sc1
  ds_read_b128 v[40:43], v0 offset:1024
  v_smfmac_f32_16x16x64_bf16 v[64:67], v[52:55], a[224:231], v1
  s_waitcnt vmcnt(5) lgkmcnt(2)
  v_mfma_f32_16x16x32_bf16 v[16:19], v[72:75], v[60:63], 0
  v_mov_b32 v30, 0x3f803f80
  s_waitcnt vmcnt(4)
  v_mfma_f32_16x16x32_bf16 v[20:23], v[76:79], v[60:63], 0
  v_mov_b32 v29, 0x3f803f80
  v_mfma_f32_16x16x32_bf16 v[24:27], v[60:63], v[60:63], 0
  v_mov_b32 v28, 0x3f803f80
  v_smfmac_f32_16x16x64_bf16 v[68:71], v[52:55], a[232:239], v1
  ds_read_b128 v[52:55], v0 offset:2048
  v_cndmask_b32_dpp v16, v20, v16, vcc quad_perm:[2,3,0,1] row_mask:0xf bank_mask:0xf
  v_cndmask_b32_dpp v17, v21, v17, vcc quad_perm:[2,3,0,1] row_mask:0xf bank_mask:0xf
  v_cndmask_b32_dpp v18, v22, v18, vcc quad_perm:[2,3,0,1] row_mask:0xf bank_mask:0xf
  v_cndmask_b32_dpp v19, v23, v19, vcc quad_perm:[2,3,0,1] row_mask:0xf bank_mask:0xf
  v_cndmask_b32_dpp v24, v25, v24, vcc quad_perm:[2,3,0,1] row_mask:0xf bank_mask:0xf
  v_smfmac_f32_16x16x64_bf16 v[64:67], v[48:51], a[176:183], v1
  ds_write_b128 v0, v[16:19] offset:11264
  ds_write_b32 v59, v24 offset:13056
  v_smfmac_f32_16x16x64_bf16 v[68:71], v[48:51], a[184:191], v1
  ds_read_b128 v[48:51], v0 offset:3072
  s_waitcnt lgkmcnt(5)
  v_smfmac_f32_16x16x64_bf16 v[64:67], v[44:47], a[16:23], v1
  v_smfmac_f32_16x16x64_bf16 v[68:71], v[44:47], a[24:31], v1
  ds_read_b128 v[44:47], v0 offset:7168
  s_waitcnt lgkmcnt(5)
  v_smfmac_f32_16x16x64_bf16 v[64:67], v[40:43], a[64:71], v1
  v_smfmac_f32_16x16x64_bf16 v[68:71], v[40:43], a[72:79], v1
  s_waitcnt lgkmcnt(2)
  s_barrier
  ds_read_b128 v[20:23], v0 offset:10240
  ds_read_b128 v[72:75], v0 offset:9216
  v_smfmac_f32_16x16x64_bf16 v[64:67], v[52:55], a[96:103], v1
  ds_read_b128 v[76:79], v0 offset:8192
  v_smfmac_f32_16x16x64_bf16 v[68:71], v[52:55], a[104:111], v1
  ds_read2st64_b32 v[26:27], v59 offset0:50 offset1:49
  s_waitcnt lgkmcnt(5)
  v_smfmac_f32_16x16x64_bf16 v[64:67], v[48:51], a[144:151], v1
  ds_read_b32 v25, v59 offset:12288
  v_smfmac_f32_16x16x64_bf16 v[68:71], v[48:51], a[152:159], v1
  ds_read_b128 v[60:63], v2 offset:1024
  s_waitcnt lgkmcnt(6)
  v_smfmac_f32_16x16x64_bf16 v[64:67], v[44:47], v[128:135], v1
  ds_read_b128 v[56:59], v2 offset:0
  v_smfmac_f32_16x16x64_bf16 v[68:71], v[44:47], v[136:143], v1
  ds_read_b128 v[40:43], v2 offset:8192
  s_waitcnt lgkmcnt(7)
  v_add_f32 v16, v16, v20
  v_add_f32 v17, v17, v21
  v_add_f32 v18, v18, v22
  v_add_f32 v19, v19, v23
  s_waitcnt lgkmcnt(5)
  v_pk_add_f32 v[72:73], v[72:73], v[76:77]
  v_pk_add_f32 v[74:75], v[74:75], v[78:79]
  s_waitcnt lgkmcnt(3)
  v_pk_add_f32 v[24:25], v[24:25], v[26:27]
  v_pk_add_f32 v[16:17], v[16:17], v[72:73]
  v_pk_add_f32 v[18:19], v[18:19], v[74:75]
  v_add_f32 v24, v24, v25
  v_max3_f32 v72, v16, v17, v18
  v_max3_f32 v72, v72, v19, v24
  v_pk_add_f32 v[64:65], v[64:65], v[66:67]
  v_pk_add_f32 v[68:69], v[68:69], v[70:71]
  v_max_f32_dpp v72, v72, v72 quad_perm:[2,3,0,1] row_mask:0xf bank_mask:0xf
  v_mov_b32 v73, v72
  v_cvt_pk_bf16_f32 v70, v64, v65
  v_cvt_pk_bf16_f32 v71, v68, v69
  v_permlane16_swap_b32 v73, v72
  v_max_f32 v72, v72, v73
  v_mov_b32 v73, v72
  v_mov_b32 v27, 0
  v_mov_b32 v68, 0
  v_permlane32_swap_b32 v73, v72
  v_max_f32 v72, v72, v73
  v_mul_f32 v72, s70, v72
  v_fma_f32 v16, v16, s70, -v72
  v_fma_f32 v17, v17, s70, -v72
  v_fma_f32 v18, v18, s70, -v72
  v_fma_f32 v19, v19, s70, -v72
  v_fma_f32 v24, v24, s70, -v72
  v_exp_f32 v16, v16
  v_exp_f32 v17, v17
  v_exp_f32 v18, v18
  v_exp_f32 v19, v19
  v_cvt_pk_bf16_f32 v20, v16, v17
  v_cvt_pk_bf16_f32 v21, v18, v19
  v_exp_f32 v24, v24
  v_mov_b32_dpp v22, v20 quad_perm:[2,3,0,1] row_mask:0xf bank_mask:0xf
  v_mov_b32_dpp v23, v21 quad_perm:[2,3,0,1] row_mask:0xf bank_mask:0xf
  v_mov_b32_dpp v25, v24 quad_perm:[2,3,0,1] row_mask:0xf bank_mask:0xf
  v_cvt_pk_bf16_f32 v26, v24, v25
  v_mfma_f32_16x16x32_bf16 v[16:19], v[28:31], v[20:23], 0
  ds_read_b128 v[48:51], v2 offset:10240
  v_mov_b32 v69, v26
  v_mfma_f32_16x16x32_bf16 v[72:75], v[32:35], v[20:23], 0
  ds_read_b128 v[52:55], v2 offset:11264
  v_mov_b64 v[32:33], 0
  v_mfma_f32_16x16x16_bf16 v[16:19], v[28:29], v[26:27], v[16:19]
  ds_read_b128 v[44:47], v2 offset:9216
  v_mov_b64 v[34:35], 0
  s_waitcnt vmcnt(3)
  v_mfma_f32_16x16x32_bf16 v[76:79], v[36:39], v[20:23], 0
  ds_read_b128 v[64:67], v2 offset:2048
  v_mfma_f32_16x16x16_bf16 v[72:75], v[70:71], v[26:27], v[72:75]
  v_rcp_f32 v24, v16
  v_mfma_f32_16x16x16_bf16 v[76:79], v[70:71], v[68:69], v[76:79]
  ds_read_b128 v[68:71], v2 offset:3072
  s_mov_b64 exec, s[72:73]
  s_nop 1
  v_pk_mul_f32 v[72:73], v[72:73], v[24:25] op_sel_hi:[1,0]
  v_pk_mul_f32 v[74:75], v[74:75], v[24:25] op_sel_hi:[1,0]
  v_cvt_pk_bf16_f32 v36, v72, v73
  v_cvt_pk_bf16_f32 v37, v74, v75
  v_pk_mul_f32 v[76:77], v[76:77], v[24:25] op_sel_hi:[1,0]
  v_pk_mul_f32 v[78:79], v[78:79], v[24:25] op_sel_hi:[1,0]
  v_cvt_pk_bf16_f32 v38, v76, v77
  v_cvt_pk_bf16_f32 v39, v78, v79
  ds_write_b128 v9, v[36:39] offset:14848
  s_mov_b64 exec, -1
  v_mfma_f32_16x16x16_bf16 v[16:19], v[32:33], v[32:33], 0
  v_mfma_f32_16x16x16_bf16 v[20:23], v[32:33], v[32:33], 0
  v_mfma_f32_16x16x16_bf16 v[24:27], v[32:33], v[32:33], 0
  v_mfma_f32_16x16x16_bf16 v[28:31], v[32:33], v[32:33], 0
  s_waitcnt lgkmcnt(0)
  s_barrier
  ds_read_b128 v[72:75], v0 offset:13312
  ds_read_b128 v[76:79], v0 offset:14336
  s_waitcnt lgkmcnt(1)
  v_smfmac_f32_16x16x64_bf16 v[16:19], v[72:75], v[56:63], v1
  v_mov_b64 v[56:57], 0
  v_smfmac_f32_16x16x64_bf16 v[20:23], v[72:75], v[64:71], v1
  v_mov_b64 v[58:59], 0
  s_waitcnt lgkmcnt(0)
  v_smfmac_f32_16x16x64_bf16 v[16:19], v[76:79], v[40:47], v1
  ds_read_b128 v[40:43], v2 offset:61440
  v_mov_b64 v[60:61], 0
  v_smfmac_f32_16x16x64_bf16 v[20:23], v[76:79], v[48:55], v1
  ds_read_b128 v[44:47], v2 offset:62464
  ds_read_b128 v[48:51], v2 offset:63488
  v_mov_b64 v[62:63], 0
  v_smfmac_f32_16x16x64_bf16 v[24:27], v[72:75], v[176:183], v1
  ds_read_b128 v[52:55], v2 offset:64512
  v_add_f32 v16, v16, v18
  v_add_f32 v17, v17, v19
  v_smfmac_f32_16x16x64_bf16 v[28:31], v[72:75], v[184:191], v1
  ds_read_b128 v[64:67], v0 offset:15360
  v_cvt_pk_bf16_f32 v38, v16, v17
  v_bfi_b32 v38, v10, s35, v38
  v_smfmac_f32_16x16x64_bf16 v[24:27], v[76:79], v[192:199], v1
  ds_read_b128 v[68:71], v0 offset:15360
  v_add_f32 v20, v20, v22
  v_add_f32 v21, v21, v23
  v_smfmac_f32_16x16x64_bf16 v[28:31], v[76:79], v[200:207], v1
  v_cvt_pk_bf16_f32 v39, v20, v21
  s_waitcnt lgkmcnt(4)
  v_smfmac_f32_16x16x64_bf16 v[32:35], v[72:75], v[40:47], v1
  ds_read_b128 v[40:43], v2 offset:16384
  buffer_store_dwordx2 v[38:39], v3, s[4:7], s40 offen
  v_add_f32 v24, v24, v26
  v_add_f32 v25, v25, v27
  s_waitcnt lgkmcnt(3)
  v_smfmac_f32_16x16x64_bf16 v[32:35], v[76:79], v[48:55], v1
  ds_read_b128 v[44:47], v2 offset:17408
  v_cvt_pk_bf16_f32 v36, v24, v25
  v_bfi_b32 v36, v10, s35, v36
  v_smfmac_f32_16x16x64_bf16 v[56:59], v[72:75], v[208:215], v1
  ds_read_b128 v[48:51], v2 offset:18432
  v_add_f32 v28, v28, v30
  v_add_f32 v29, v29, v31
  v_smfmac_f32_16x16x64_bf16 v[60:63], v[72:75], v[216:223], v1
  ds_read_b128 v[52:55], v2 offset:19456
  v_cvt_pk_bf16_f32 v37, v28, v29
  v_add_f32 v32, v32, v34
  v_smfmac_f32_16x16x64_bf16 v[56:59], v[76:79], v[224:231], v1
  buffer_store_dwordx2 v[36:37], v3, s[4:7], s41 offen
  v_add_f32 v33, v33, v35
  v_cvt_pk_bf16_f32 v34, v32, v33
  v_smfmac_f32_16x16x64_bf16 v[60:63], v[76:79], v[232:239], v1
  v_bfi_b32 v34, v10, s35, v34
  s_waitcnt lgkmcnt(5)
  v_smfmac_f32_16x16x64_bf16 v[64:67], v[72:75], v[240:247], v1
  buffer_store_dword v34, v4, s[4:7], s40 offen
  v_add_f32 v56, v56, v58
  v_add_f32 v57, v57, v59
  s_waitcnt lgkmcnt(4)
  v_smfmac_f32_16x16x64_bf16 v[68:71], v[72:75], v[248:255], v1
  v_cvt_pk_bf16_f32 v38, v56, v57
  v_bfi_b32 v38, v10, s35, v38
  s_waitcnt lgkmcnt(2)
  v_smfmac_f32_16x16x64_bf16 v[64:67], v[76:79], v[40:47], v1
  v_add_f32 v60, v60, v62
  s_waitcnt lgkmcnt(0)
  v_smfmac_f32_16x16x64_bf16 v[68:71], v[76:79], v[48:55], v1
  v_add_f32 v61, v61, v63
  v_cvt_pk_bf16_f32 v39, v60, v61
  buffer_store_dwordx2 v[38:39], v3, s[4:7], s42 offen
  v_pk_add_f32 v[64:65], v[64:65], v[66:67]
  v_cvt_pk_bf16_f32 v36, v64, v65
  v_bfi_b32 v36, v10, s35, v36
  v_pk_add_f32 v[68:69], v[68:69], v[70:71]
  v_cvt_pk_bf16_f32 v37, v68, v69
  buffer_store_dwordx2 v[36:37], v3, s[4:7], s43 offen
  v_mov_b32 v40, 0x3f80
  v_cndmask_b32 v40, v40, 1.0, s[60:61]
  v_cndmask_b32 v46, 0, v40, s[66:67]
  v_cndmask_b32 v47, 0, v40, s[68:69]
  v_cndmask_b32 v44, 0, v40, s[62:63]
  v_cndmask_b32 v45, 0, v40, s[64:65]
  ds_read_b128 v[56:59], v2 offset:24576
  ds_read_b128 v[60:63], v2 offset:25600
  ds_read_b128 v[64:67], v2 offset:26624
  ds_read_b128 v[68:71], v2 offset:27648
  v_mov_b64 v[16:17], 0
  v_mov_b64 v[18:19], 0
  v_mov_b64 v[20:21], 0
  v_mov_b64 v[22:23], 0
  s_add_u32 s57, s57, s77
  s_add_u32 s48, s48, 9216
  s_add_u32 s49, s53, s48
  s_add_u32 s74, s74, 9216
  s_add_u32 s75, s75, 9216
  s_mov_b32 s77, 9216
  s_nop 15
  s_nop 15
  s_nop 15
  s_nop 7
  buffer_load_dwordx4 v[24:27], v0, s[4:7], s44 offen sc1
  buffer_load_dwordx4 v[28:31], v0, s[4:7], s44 offen offset:1024 sc1
  s_branch L_cf3_top
L_cf3_h2q:
L_cf3_h2r:
  buffer_load_dwordx4 v[40:43], v0, s[4:7], s48 offen offset:0 sc1
  buffer_load_dwordx4 v[52:55], v0, s[4:7], s48 offen offset:1024 sc1
  buffer_load_dwordx4 v[72:75], v0, s[4:7], s48 offen offset:2048 sc1
  buffer_load_dwordx4 v[76:79], v0, s[4:7], s48 offen offset:3072 sc1
  buffer_load_dwordx4 v[44:47], v0, s[4:7], s75 offen offset:0 sc1
  s_nop 3
L_cf3_entry:
  ds_read_b128 v[56:59], v2 offset:24576
  ds_read_b128 v[60:63], v2 offset:25600
  ds_read_b128 v[64:67], v2 offset:26624
  ds_read_b128 v[68:71], v2 offset:27648
  s_sub_u32 s31, s31, 1
  s_cbranch_scc1 L_exit
  v_mov_b64 v[16:17], 0
  v_mov_b64 v[18:19], 0
  v_mov_b64 v[20:21], 0
  v_mov_b64 v[22:23], 0
  v_mov_b64 v[24:25], 0
  v_mov_b64 v[26:27], 0
  v_mov_b64 v[28:29], 0
  v_mov_b64 v[30:31], 0
  s_branch L_cf3_h2
L_cf3_ru:
  buffer_load_dwordx4 v[24:27], v0, s[4:7], s44 offen sc1
  buffer_load_dwordx4 v[28:31], v0, s[4:7], s44 offen offset:1024 sc1
  s_sub_u32 s31, s31, 1
  s_cbranch_scc1 L_exit
  s_waitcnt vmcnt(0)
  s_branch L_cf3_h1m
L_cf3_kvwait:
  buffer_load_dword v6, off, s[4:7], s58 sc1
  s_sub_u32 s31, s31, 1
  s_cbranch_scc1 L_exit
  s_waitcnt vmcnt(0)
  v_cmp_eq_u32 vcc, 0, v6
  s_cbranch_vccnz L_cf3_kvwait
  s_branch L_cf3_kvok
L_cf3_done:
  buffer_store_dwordx2 v[12:13], v5, s[4:7], s57 offen sc1
  s_branch L_exit
.p2align 6
L_cs0_top:
  s_waitcnt vmcnt(0)
L_cs0_h1m:
  v_bitop3_b32 v12, v16, v20, s35 bitop3:0x7e
  v_and_b32 v12, 1, v12
  v_cmp_ne_u32 vcc, 0, v12
  v_mfma_f32_16x16x32_bf16 v[40:43], v[44:47], v[16:19], 0
  v_mfma_f32_16x16x32_bf16 v[40:43], v[44:47], v[20:23], v[40:43]
  s_cbranch_vccnz L_cs0_ru
  buffer_store_dword v73, v74, s[4:7], s3 offen sc1
  s_add_u32 s35, s35, 1
  s_cmp_eq_u32 s35, 63
  s_nop 3
  v_add_f32_dpp v40, v40, v40 row_ror:8 row_mask:0xf bank_mask:0xf
  v_add_f32_dpp v41, v41, v41 row_ror:8 row_mask:0xf bank_mask:0xf
  v_add_f32_dpp v42, v42, v42 row_ror:8 row_mask:0xf bank_mask:0xf
  v_add_f32_dpp v43, v43, v43 row_ror:8 row_mask:0xf bank_mask:0xf
  v_add_f32_dpp v40, v40, v40 row_ror:4 row_mask:0xf bank_mask:0xf
  v_add_f32_dpp v41, v41, v41 row_ror:4 row_mask:0xf bank_mask:0xf
  v_add_f32_dpp v42, v42, v42 row_ror:4 row_mask:0xf bank_mask:0xf
  v_add_f32_dpp v43, v43, v43 row_ror:4 row_mask:0xf bank_mask:0xf
  v_cvt_pk_bf16_f32 v12, v40, v41
  v_cvt_pk_bf16_f32 v13, v42, v43
  buffer_store_dwordx2 v[12:13], v5, s[4:7], s49 offen sc1
  buffer_load_dword v75, v72, s[4:7], s71 offen sc1
  s_cbranch_scc1 L_cs0_done
  s_nop 8
  buffer_load_dword v76, v72, s[4:7], s71 offen sc1
  s_nop 9
  buffer_load_dword v77, v72, s[4:7], s71 offen sc1
  s_nop 9
  buffer_load_dword v78, v72, s[4:7], s71 offen sc1
  s_nop 9
  buffer_load_dword v79, v72, s[4:7], s71 offen sc1
  s_waitcnt vmcnt(4)
  v_cmp_gt_i32 vcc, v73, v75
  s_cbranch_vccnz L_cs0_fl
L_cs0_fld:
  s_barrier
L_cs0_h2:
  buffer_load_dwordx4 v[40:43], v0, s[4:7], s48 offen offset:0
  v_mov_b64 v[16:17], 0
  v_mov_b64 v[18:19], 0
  v_mov_b64 v[20:21], 0
  v_mov_b64 v[22:23], 0
  s_nop 3
  buffer_load_dwordx4 v[52:55], v0, s[4:7], s48 offen offset:1024
  s_nop 7
  buffer_load_dwordx4 v[72:75], v0, s[4:7], s48 offen offset:2048
  s_nop 7
  buffer_load_dwordx4 v[76:79], v0, s[4:7], s48 offen offset:3072
  s_nop 7
  buffer_load_dwordx4 v[48:51], v0, s[4:7], s74 offen offset:0 sc1
  s_waitcnt vmcnt(4) lgkmcnt(0)
  v_smfmac_f32_16x16x64_bf16 v[16:19], v[40:43], v[56:63], v1
  buffer_load_dwordx4 v[44:47], v0, s[4:7], s75 offen offset:0
  ds_read_b128 v[56:59], v2 offset:36864
  v_max_u32 v11, v40, v42
  v_smfmac_f32_16x16x64_bf16 v[20:23], v[40:43], v[64:71], v1
  ds_read_b128 v[60:63], v2 offset:37888
  v_smfmac_f32_16x16x64_bf16 v[24:27], v[40:43], a[0:7], v1
  ds_read_b128 v[64:67], v2 offset:38912
  v_smfmac_f32_16x16x64_bf16 v[28:31], v[40:43], a[8:15], v1
  ds_read_b128 v[68:71], v2 offset:39936
  s_waitcnt vmcnt(4)
  v_smfmac_f32_16x16x64_bf16 v[16:19], v[52:55], a[32:39], v1
  v_max3_u32 v11, v11, v52, v54
  v_smfmac_f32_16x16x64_bf16 v[20:23], v[52:55], a[40:47], v1
  ds_write_b128 v0, v[40:43] offset:0
  v_smfmac_f32_16x16x64_bf16 v[24:27], v[52:55], a[48:55], v1
  buffer_load_dwordx4 v[32:35], v0, s[4:7], s55 offen offset:2048 sc1
  v_smfmac_f32_16x16x64_bf16 v[28:31], v[52:55], a[56:63], v1
  s_waitcnt vmcnt(4) lgkmcnt(3)
  v_smfmac_f32_16x16x64_bf16 v[16:19], v[72:75], v[56:63], v1
  ds_read_b128 v[56:59], v2 offset:61440
  v_max3_u32 v11, v11, v72, v74
  s_waitcnt lgkmcnt(2)
  v_smfmac_f32_16x16x64_bf16 v[20:23], v[72:75], v[64:71], v1
  ds_read_b128 v[60:63], v2 offset:62464
  v_smfmac_f32_16x16x64_bf16 v[24:27], v[72:75], a[80:87], v1
  ds_read_b128 v[64:67], v2 offset:63488
  v_smfmac_f32_16x16x64_bf16 v[28:31], v[72:75], a[88:95], v1
  ds_read_b128 v[68:71], v2 offset:64512
  s_waitcnt vmcnt(3)
  v_smfmac_f32_16x16x64_bf16 v[16:19], v[76:79], a[112:119], v1
  buffer_load_dwordx4 v[72:75], v0, s[4:7], s55 offen offset:0 sc1
  v_max3_u32 v11, v11, v76, v78
  v_smfmac_f32_16x16x64_bf16 v[20:23], v[76:79], a[120:127], v1
  v_smfmac_f32_16x16x64_bf16 v[24:27], v[76:79], a[128:135], v1
  v_smfmac_f32_16x16x64_bf16 v[28:31], v[76:79], a[136:143], v1
  s_waitcnt vmcnt(3)
  ds_write_b128 v0, v[48:51] offset:4096
  s_waitcnt vmcnt(2) lgkmcnt(3)
  v_smfmac_f32_16x16x64_bf16 v[16:19], v[44:47], v[56:63], v1
  ds_read_b128 v[56:59], v2 offset:45056
  buffer_load_dwordx4 v[76:79], v0, s[4:7], s55 offen offset:1024 sc1
  v_max3_u32 v11, v11, v44, v46
  s_waitcnt lgkmcnt(2)
  v_smfmac_f32_16x16x64_bf16 v[20:23], v[44:47], v[64:71], v1
  ds_read_b128 v[60:63], v2 offset:46080
  ds_read_b128 v[64:67], v2 offset:47104
  v_max3_u32 v11, v11, v48, v50
  v_smfmac_f32_16x16x64_bf16 v[24:27], v[44:47], v[144:151], v1
  ds_read_b128 v[68:71], v2 offset:48128
  v_cmp_eq_u32 vcc, -1, v11
  v_smfmac_f32_16x16x64_bf16 v[28:31], v[44:47], v[152:159], v1
  v_lshlrev_b32 v6, 3, v0
  v_smfmac_f32_16x16x64_bf16 v[24:27], v[48:51], a[160:167], v1
  s_cbranch_vccnz L_cs0_h2q
  buffer_load_dwordx4 v[36:39], v0, s[4:7], s55 offen offset:3072 sc1
  v_smfmac_f32_16x16x64_bf16 v[28:31], v[48:51], a[168:175], v1
  s_waitcnt lgkmcnt(4)
  s_barrier
  ds_read_b128 v[40:43], v0 offset:5120
  s_waitcnt lgkmcnt(3)
  v_smfmac_f32_16x16x64_bf16 v[16:19], v[48:51], v[56:63], v1
  ds_read_b128 v[52:55], v0 offset:6144
  ds_read_b128 v[56:59], v2 offset:53248
  s_waitcnt lgkmcnt(3)
  v_smfmac_f32_16x16x64_bf16 v[20:23], v[48:51], v[64:71], v1
  ds_read_b128 v[60:63], v2 offset:54272
  ds_read_b128 v[64:67], v2 offset:55296
  s_waitcnt lgkmcnt(4)
  v_smfmac_f32_16x16x64_bf16 v[16:19], v[40:43], a[192:199], v1
  ds_read_b128 v[48:51], v0 offset:7168
  ds_read_b128 v[68:71], v2 offset:56320
  s_add_u32 s55, s55, s56
  v_smfmac_f32_16x16x64_bf16 v[20:23], v[40:43], a[200:207], v1
  v_smfmac_f32_16x16x64_bf16 v[24:27], v[40:43], a[208:215], v1
  v_smfmac_f32_16x16x64_bf16 v[28:31], v[40:43], a[216:223], v1
  s_mov_b32 exec_hi, 0
  buffer_load_dword v6, v6, s[4:7], s55 offen sc1
  s_mov_b32 exec_hi, -1
  s_waitcnt lgkmcnt(3)
  v_smfmac_f32_16x16x64_bf16 v[16:19], v[52:55], v[56:63], v1
  buffer_load_dword v6, v8, s[4:7], s51 offen sc1
  s_waitcnt lgkmcnt(0)
  v_smfmac_f32_16x16x64_bf16 v[20:23], v[52:55], v[64:71], v1
  v_smfmac_f32_16x16x64_bf16 v[16:19], v[48:51], v[96:103], v1
  v_smfmac_f32_16x16x64_bf16 v[20:23], v[48:51], v[104:111], v1
  ds_read_b128 v[64:67], v0 offset:15360
  v_smfmac_f32_16x16x64_bf16 v[24:27], v[52:55], a[240:247], v1
  ds_read_b128 v[68:71], v0 offset:15360
  v_add_f32 v16, v16, v18
  v_smfmac_f32_16x16x64_bf16 v[24:27], v[48:51], v[112:119], v1
  s_nop 0
  s_nop 0
  v_add_f32 v17, v17, v19
  v_smfmac_f32_16x16x64_bf16 v[28:31], v[52:55], a[248:255], v1
  s_mov_b64 vcc, s[72:73]
  v_cvt_pk_bf16_f32 v57, v16, v17
  v_smfmac_f32_16x16x64_bf16 v[28:31], v[48:51], v[120:127], v1
  v_add_f32 v24, v24, v26
  v_add_f32 v25, v25, v27
  v_cvt_pk_bf16_f32 v56, v24, v25
  ds_write_b64 v7, v[56:57] offset:8192
  v_pk_add_f32 v[20:21], v[20:21], v[22:23]
  s_nop 0
  v_pk_add_f32 v[28:29], v[28:29], v[30:31]
  v_cvt_pk_bf16_f32 v59, v20, v21
  v_cvt_pk_bf16_f32 v58, v28, v29
  ds_write_b64 v7, v[58:59] offset:8704
  ds_read_b64_tr_b16 v[60:61], v8 offset:8192
  ds_read_b64_tr_b16 v[62:63], v8 offset:8704
  s_waitcnt lgkmcnt(5)
  v_smfmac_f32_16x16x64_bf16 v[64:67], v[44:47], v[160:167], v1
  buffer_store_dwordx2 v[12:13], v5, s[4:7], s57 offen sc1
  s_waitcnt lgkmcnt(4)
  v_smfmac_f32_16x16x64_bf16 v[68:71], v[44:47], v[168:175], v1
  ds_read_b128 v[44:47], v0 offset:0
  v_lshrrev_b32 v59, 2, v0
  v_smfmac_f32_16x16x64_bf16 v[64:67], v[40:43], a[224:231], v1
  v_mov_b32 v31, 0x3f803f80
  v_smfmac_f32_16x16x64_bf16 v[68:71], v[40:43], a[232:239], v1
  ds_read_b128 v[40:43], v0 offset:1024
  v_smfmac_f32_16x16x64_bf16 v[64:67], v[52:55], v[80:87], v1
  s_waitcnt vmcnt(5) lgkmcnt(2)
  v_mfma_f32_16x16x32_bf16 v[16:19], v[72:75], v[60:63], 0
  v_mov_b32 v30, 0x3f803f80
  s_waitcnt vmcnt(4)
  v_mfma_f32_16x16x32_bf16 v[20:23], v[76:79], v[60:63], 0
  v_mov_b32 v29, 0x3f803f80
  v_mfma_f32_16x16x32_bf16 v[24:27], v[60:63], v[60:63], 0
  v_mov_b32 v28, 0x3f803f80
  v_smfmac_f32_16x16x64_bf16 v[68:71], v[52:55], v[88:95], v1
  ds_read_b128 v[52:55], v0 offset:2048
  v_cndmask_b32_dpp v16, v20, v16, vcc quad_perm:[2,3,0,1] row_mask:0xf bank_mask:0xf
  v_cndmask_b32_dpp v17, v21, v17, vcc quad_perm:[2,3,0,1] row_mask:0xf bank_mask:0xf
  v_cndmask_b32_dpp v18, v22, v18, vcc quad_perm:[2,3,0,1] row_mask:0xf bank_mask:0xf
  v_cndmask_b32_dpp v19, v23, v19, vcc quad_perm:[2,3,0,1] row_mask:0xf bank_mask:0xf
  v_cndmask_b32_dpp v24, v25, v24, vcc quad_perm:[2,3,0,1] row_mask:0xf bank_mask:0xf
  v_smfmac_f32_16x16x64_bf16 v[64:67], v[48:51], v[128:135], v1
  ds_write_b128 v0, v[16:19] offset:8192
  ds_write_b32 v59, v24 offset:12288
  v_smfmac_f32_16x16x64_bf16 v[68:71], v[48:51], v[136:143], v1
  ds_read_b128 v[48:51], v0 offset:3072
  s_waitcnt lgkmcnt(5)
  v_smfmac_f32_16x16x64_bf16 v[64:67], v[44:47], a[16:23], v1
  v_smfmac_f32_16x16x64_bf16 v[68:71], v[44:47], a[24:31], v1
  ds_read_b128 v[44:47], v0 offset:4096
  s_waitcnt lgkmcnt(5)
  v_smfmac_f32_16x16x64_bf16 v[64:67], v[40:43], a[64:71], v1
  v_smfmac_f32_16x16x64_bf16 v[68:71], v[40:43], a[72:79], v1
  s_waitcnt lgkmcnt(2)
  s_barrier
  ds_read_b128 v[20:23], v0 offset:9216
  ds_read_b128 v[72:75], v0 offset:10240
  v_smfmac_f32_16x16x64_bf16 v[64:67], v[52:55], a[96:103], v1
  ds_read_b128 v[76:79], v0 offset:11264
  v_smfmac_f32_16x16x64_bf16 v[68:71], v[52:55], a[104:111], v1
  ds_read2st64_b32 v[26:27], v59 offset0:49 offset1:50
  s_waitcnt lgkmcnt(5)
  v_smfmac_f32_16x16x64_bf16 v[64:67], v[48:51], a[144:151], v1
  ds_read_b32 v25, v59 offset:13056
  v_smfmac_f32_16x16x64_bf16 v[68:71], v[48:51], a[152:159], v1
  ds_read_b128 v[60:63], v2 offset:5120
  s_waitcnt lgkmcnt(6)
  v_smfmac_f32_16x16x64_bf16 v[64:67], v[44:47], a[176:183], v1
  ds_read_b128 v[56:59], v2 offset:4096
  v_smfmac_f32_16x16x64_bf16 v[68:71], v[44:47], a[184:191], v1
  ds_read_b128 v[40:43], v2 offset:12288
  s_waitcnt lgkmcnt(7)
  v_add_f32 v16, v16, v20
  v_add_f32 v17, v17, v21
  v_add_f32 v18, v18, v22
  v_add_f32 v19, v19, v23
  s_waitcnt lgkmcnt(5)
  v_pk_add_f32 v[72:73], v[72:73], v[76:77]
  v_pk_add_f32 v[74:75], v[74:75], v[78:79]
  s_waitcnt lgkmcnt(3)
  v_pk_add_f32 v[24:25], v[24:25], v[26:27]
  v_pk_add_f32 v[16:17], v[16:17], v[72:73]
  v_pk_add_f32 v[18:19], v[18:19], v[74:75]
  v_add_f32 v24, v24, v25
  v_max3_f32 v72, v16, v17, v18
  v_max3_f32 v72, v72, v19, v24
  v_pk_add_f32 v[64:65], v[64:65], v[66:67]
  v_pk_add_f32 v[68:69], v[68:69], v[70:71]
  v_max_f32_dpp v72, v72, v72 quad_perm:[2,3,0,1] row_mask:0xf bank_mask:0xf
  v_mov_b32 v73, v72
  v_cvt_pk_bf16_f32 v70, v64, v65
  v_cvt_pk_bf16_f32 v71, v68, v69
  v_permlane16_swap_b32 v73, v72
  v_max_f32 v72, v72, v73
  v_mov_b32 v73, v72
  v_mov_b32 v27, 0
  v_mov_b32 v68, 0
  v_permlane32_swap_b32 v73, v72
  v_max_f32 v72, v72, v73
  v_mul_f32 v72, s70, v72
  v_fma_f32 v16, v16, s70, -v72
  v_fma_f32 v17, v17, s70, -v72
  v_fma_f32 v18, v18, s70, -v72
  v_fma_f32 v19, v19, s70, -v72
  v_fma_f32 v24, v24, s70, -v72
  v_exp_f32 v16, v16
  v_exp_f32 v17, v17
  v_exp_f32 v18, v18
  v_exp_f32 v19, v19
  v_cvt_pk_bf16_f32 v20, v16, v17
  v_cvt_pk_bf16_f32 v21, v18, v19
  v_exp_f32 v24, v24
  v_mov_b32_dpp v22, v20 quad_perm:[2,3,0,1] row_mask:0xf bank_mask:0xf
  v_mov_b32_dpp v23, v21 quad_perm:[2,3,0,1] row_mask:0xf bank_mask:0xf
  v_mov_b32_dpp v25, v24 quad_perm:[2,3,0,1] row_mask:0xf bank_mask:0xf
  v_cvt_pk_bf16_f32 v26, v24, v25
  v_mfma_f32_16x16x32_bf16 v[16:19], v[28:31], v[20:23], 0
  ds_read_b128 v[48:51], v2 offset:14336
  v_mov_b32 v69, v26
  v_mfma_f32_16x16x32_bf16 v[72:75], v[32:35], v[20:23], 0
  ds_read_b128 v[52:55], v2 offset:15360
  v_mov_b64 v[32:33], 0
  v_mfma_f32_16x16x16_bf16 v[16:19], v[28:29], v[26:27], v[16:19]
  ds_read_b128 v[44:47], v2 offset:13312
  v_mov_b64 v[34:35], 0
  s_waitcnt vmcnt(3)
  v_mfma_f32_16x16x32_bf16 v[76:79], v[36:39], v[20:23], 0
  ds_read_b128 v[64:67], v2 offset:6144
  v_mfma_f32_16x16x16_bf16 v[72:75], v[70:71], v[26:27], v[72:75]
  v_rcp_f32 v24, v16
  v_mfma_f32_16x16x16_bf16 v[76:79], v[70:71], v[68:69], v[76:79]
  ds_read_b128 v[68:71], v2 offset:7168
  s_mov_b64 exec, s[72:73]
  s_nop 1
  v_pk_mul_f32 v[72:73], v[72:73], v[24:25] op_sel_hi:[1,0]
  v_pk_mul_f32 v[74:75], v[74:75], v[24:25] op_sel_hi:[1,0]
  v_cvt_pk_bf16_f32 v36, v72, v73
  v_cvt_pk_bf16_f32 v37, v74, v75
  v_pk_mul_f32 v[76:77], v[76:77], v[24:25] op_sel_hi:[1,0]
  v_pk_mul_f32 v[78:79], v[78:79], v[24:25] op_sel_hi:[1,0]
  v_cvt_pk_bf16_f32 v38, v76, v77
  v_cvt_pk_bf16_f32 v39, v78, v79
  ds_write_b128 v9, v[36:39] offset:13312
  s_mov_b64 exec, -1
  v_mfma_f32_16x16x16_bf16 v[16:19], v[32:33], v[32:33], 0
  v_mfma_f32_16x16x16_bf16 v[20:23], v[32:33], v[32:33], 0
  v_mfma_f32_16x16x16_bf16 v[24:27], v[32:33], v[32:33], 0
  v_mfma_f32_16x16x16_bf16 v[28:31], v[32:33], v[32:33], 0
  s_waitcnt lgkmcnt(0)
  s_barrier
  ds_read_b128 v[72:75], v0 offset:13312
  ds_read_b128 v[76:79], v0 offset:14336
  s_waitcnt lgkmcnt(1)
  v_smfmac_f32_16x16x64_bf16 v[16:19], v[72:75], v[56:63], v1
  v_mov_b64 v[56:57], 0
  v_smfmac_f32_16x16x64_bf16 v[20:23], v[72:75], v[64:71], v1
  v_mov_b64 v[58:59], 0
  s_waitcnt lgkmcnt(0)
  v_smfmac_f32_16x16x64_bf16 v[16:19], v[76:79], v[40:47], v1
  ds_read_b128 v[40:43], v2 offset:0
  v_mov_b64 v[60:61], 0
  v_smfmac_f32_16x16x64_bf16 v[20:23], v[76:79], v[48:55], v1
  ds_read_b128 v[44:47], v2 offset:1024
  ds_read_b128 v[48:51], v2 offset:2048
  v_mov_b64 v[62:63], 0
  v_smfmac_f32_16x16x64_bf16 v[24:27], v[72:75], v[176:183], v1
  ds_read_b128 v[52:55], v2 offset:3072
  v_add_f32 v16, v16, v18
  v_add_f32 v17, v17, v19
  v_smfmac_f32_16x16x64_bf16 v[28:31], v[72:75], v[184:191], v1
  ds_read_b128 v[64:67], v0 offset:15360
  v_cvt_pk_bf16_f32 v38, v16, v17
  v_bfi_b32 v38, v10, s35, v38
  v_smfmac_f32_16x16x64_bf16 v[24:27], v[76:79], v[192:199], v1
  ds_read_b128 v[68:71], v0 offset:15360
  v_add_f32 v20, v20, v22
  v_add_f32 v21, v21, v23
  v_smfmac_f32_16x16x64_bf16 v[28:31], v[76:79], v[200:207], v1
  v_cvt_pk_bf16_f32 v39, v20, v21
  s_waitcnt lgkmcnt(4)
  v_smfmac_f32_16x16x64_bf16 v[32:35], v[72:75], v[40:47], v1
  ds_read_b128 v[40:43], v2 offset:20480
  buffer_store_dwordx2 v[38:39], v3, s[4:7], s40 offen sc1
  v_add_f32 v24, v24, v26
  v_add_f32 v25, v25, v27
  s_waitcnt lgkmcnt(3)
  v_smfmac_f32_16x16x64_bf16 v[32:35], v[76:79], v[48:55], v1
  ds_read_b128 v[44:47], v2 offset:21504
  v_cvt_pk_bf16_f32 v36, v24, v25
  v_bfi_b32 v36, v10, s35, v36
  v_smfmac_f32_16x16x64_bf16 v[56:59], v[72:75], v[208:215], v1
  ds_read_b128 v[48:51], v2 offset:22528
  v_add_f32 v28, v28, v30
  v_add_f32 v29, v29, v31
  v_smfmac_f32_16x16x64_bf16 v[60:63], v[72:75], v[216:223], v1
  ds_read_b128 v[52:55], v2 offset:23552
  v_cvt_pk_bf16_f32 v37, v28, v29
  v_add_f32 v32, v32, v34
  v_smfmac_f32_16x16x64_bf16 v[56:59], v[76:79], v[224:231], v1
  buffer_store_dwordx2 v[36:37], v3, s[4:7], s41 offen sc1
  v_add_f32 v33, v33, v35
  v_cvt_pk_bf16_f32 v34, v32, v33
  v_smfmac_f32_16x16x64_bf16 v[60:63], v[76:79], v[232:239], v1
  v_bfi_b32 v34, v10, s35, v34
  s_waitcnt lgkmcnt(5)
  v_smfmac_f32_16x16x64_bf16 v[64:67], v[72:75], v[240:247], v1
  buffer_store_dword v34, v4, s[4:7], s40 offen sc1
  v_add_f32 v56, v56, v58
  v_add_f32 v57, v57, v59
  s_waitcnt lgkmcnt(4)
  v_smfmac_f32_16x16x64_bf16 v[68:71], v[72:75], v[248:255], v1
  v_cvt_pk_bf16_f32 v38, v56, v57
  v_bfi_b32 v38, v10, s35, v38
  s_waitcnt lgkmcnt(2)
  v_smfmac_f32_16x16x64_bf16 v[64:67], v[76:79], v[40:47], v1
  v_add_f32 v60, v60, v62
  s_waitcnt lgkmcnt(0)
  v_smfmac_f32_16x16x64_bf16 v[68:71], v[76:79], v[48:55], v1
  v_add_f32 v61, v61, v63
  v_cvt_pk_bf16_f32 v39, v60, v61
  buffer_store_dwordx2 v[38:39], v3, s[4:7], s42 offen sc1
  v_pk_add_f32 v[64:65], v[64:65], v[66:67]
  v_cvt_pk_bf16_f32 v36, v64, v65
  v_bfi_b32 v36, v10, s35, v36
  v_pk_add_f32 v[68:69], v[68:69], v[70:71]
  v_cvt_pk_bf16_f32 v37, v68, v69
  buffer_store_dwordx2 v[36:37], v3, s[4:7], s43 offen sc1
  buffer_load_dwordx4 v[16:19], v0, s[4:7], s44 offen sc1
  buffer_load_dwordx4 v[20:23], v0, s[4:7], s44 offen offset:1024 sc1
  v_mov_b32 v40, 0x3f80
  v_cndmask_b32 v40, v40, 1.0, s[60:61]
  v_cndmask_b32 v46, 0, v40, s[66:67]
  v_cndmask_b32 v47, 0, v40, s[68:69]
  v_cndmask_b32 v44, 0, v40, s[62:63]
  v_cndmask_b32 v45, 0, v40, s[64:65]
  v_cmp_gt_u32 vcc, 64, v0
  v_lshlrev_b32 v74, 4, v0
  v_mov_b32 v73, s35
  v_cndmask_b32 v74, 0x40000000, v74, vcc
  v_bfe_u32 v72, v0, 2, 7
  ds_read_b128 v[56:59], v2 offset:28672
  ds_read_b128 v[60:63], v2 offset:29696
  ds_read_b128 v[64:67], v2 offset:30720
  ds_read_b128 v[68:71], v2 offset:31744
  v_mov_b64 v[24:25], 0
  v_mov_b64 v[26:27], 0
  v_mov_b64 v[28:29], 0
  v_mov_b64 v[30:31], 0
  s_add_u32 s57, s57, s77
  s_add_u32 s48, s48, 9216
  s_add_u32 s51, s51, 9216
  s_add_u32 s49, s53, s48
  s_add_u32 s74, s74, 9216
  s_add_u32 s75, s75, 9216
  s_mov_b32 s77, 9216
  s_branch L_cs0_top
L_cs0_h2q:
L_cs0_h2r:
  buffer_load_dwordx4 v[40:43], v0, s[4:7], s48 offen offset:0 sc1
  buffer_load_dwordx4 v[52:55], v0, s[4:7], s48 offen offset:1024 sc1
  buffer_load_dwordx4 v[72:75], v0, s[4:7], s48 offen offset:2048 sc1
  buffer_load_dwordx4 v[76:79], v0, s[4:7], s48 offen offset:3072 sc1
  buffer_load_dwordx4 v[44:47], v0, s[4:7], s75 offen offset:0 sc1
  s_nop 3
L_cs0_entry:
  ds_read_b128 v[56:59], v2 offset:28672
  ds_read_b128 v[60:63], v2 offset:29696
  ds_read_b128 v[64:67], v2 offset:30720
  ds_read_b128 v[68:71], v2 offset:31744
  s_sub_u32 s31, s31, 1
  s_cbranch_scc1 L_exit
  v_mov_b64 v[16:17], 0
  v_mov_b64 v[18:19], 0
  v_mov_b64 v[20:21], 0
  v_mov_b64 v[22:23], 0
  v_mov_b64 v[24:25], 0
  v_mov_b64 v[26:27], 0
  v_mov_b64 v[28:29], 0
  v_mov_b64 v[30:31], 0
  s_branch L_cs0_h2
L_cs0_fl:
L_cs0_fl1:
  buffer_load_dword v75, v72, s[4:7], s71 offen sc1
  s_waitcnt vmcnt(4)
  v_cmp_gt_i32 vcc, v73, v76
  s_cbranch_vccz L_cs0_fld
  buffer_load_dword v76, v72, s[4:7], s71 offen sc1
  s_waitcnt vmcnt(4)
  v_cmp_gt_i32 vcc, v73, v77
  s_cbranch_vccz L_cs0_fld
  buffer_load_dword v77, v72, s[4:7], s71 offen sc1
  s_waitcnt vmcnt(4)
  v_cmp_gt_i32 vcc, v73, v78
  s_cbranch_vccz L_cs0_fld
  buffer_load_dword v78, v72, s[4:7], s71 offen sc1
  s_waitcnt vmcnt(4)
  v_cmp_gt_i32 vcc, v73, v79
  s_cbranch_vccz L_cs0_fld
  buffer_load_dword v79, v72, s[4:7], s71 offen sc1
  s_waitcnt vmcnt(4)
  v_cmp_gt_i32 vcc, v73, v75
  s_cbranch_vccz L_cs0_fld
  s_sub_u32 s31, s31, 1
  s_cbranch_scc1 L_exit
  s_branch L_cs0_fl1
L_cs0_ru:
  buffer_load_dwordx4 v[16:19], v0, s[4:7], s44 offen sc1
  buffer_load_dwordx4 v[20:23], v0, s[4:7], s44 offen offset:1024 sc1
  s_sub_u32 s31, s31, 1
  s_cbranch_scc1 L_exit
  s_waitcnt vmcnt(0)
  s_branch L_cs0_h1m
L_cs0_done:
  buffer_store_dwordx2 v[12:13], v5, s[4:7], s57 offen sc1
  s_branch L_exit
.p2align 6
L_cs1_top:
  s_waitcnt vmcnt(2)
L_cs1_h1m:
  v_mfma_f32_16x16x32_bf16 v[40:43], v[44:47], v[24:27], 0
  v_bitop3_b32 v12, v24, v28, s35 bitop3:0x7e
  v_and_b32 v12, 1, v12
  v_mfma_f32_16x16x32_bf16 v[40:43], v[44:47], v[28:31], v[40:43]
  v_cmp_ne_u32 vcc, 0, v12
  s_cbranch_vccnz L_cs1_ru
  s_nop 4
  v_add_f32_dpp v40, v40, v40 row_ror:8 row_mask:0xf bank_mask:0xf
  v_add_f32_dpp v41, v41, v41 row_ror:8 row_mask:0xf bank_mask:0xf
  v_add_f32_dpp v42, v42, v42 row_ror:8 row_mask:0xf bank_mask:0xf
  v_add_f32_dpp v43, v43, v43 row_ror:8 row_mask:0xf bank_mask:0xf
  v_add_f32_dpp v40, v40, v40 row_ror:4 row_mask:0xf bank_mask:0xf
  v_add_f32_dpp v41, v41, v41 row_ror:4 row_mask:0xf bank_mask:0xf
  v_add_f32_dpp v42, v42, v42 row_ror:4 row_mask:0xf bank_mask:0xf
  v_add_f32_dpp v43, v43, v43 row_ror:4 row_mask:0xf bank_mask:0xf
  v_cvt_pk_bf16_f32 v12, v40, v41
  v_cvt_pk_bf16_f32 v13, v42, v43
  buffer_store_dwordx2 v[12:13], v5, s[4:7], s49 offen sc1
  s_waitcnt vmcnt(1)
L_cs1_h1x:
  v_mfma_f32_16x16x32_bf16 v[40:43], v[44:47], v[16:19], 0
  v_bitop3_b32 v14, v16, v20, s35 bitop3:0x7e
  v_and_b32 v14, 1, v14
  v_mfma_f32_16x16x32_bf16 v[40:43], v[44:47], v[20:23], v[40:43]
  v_cmp_ne_u32 vcc, 0, v14
  s_nop 0
  s_and_b64 vcc, vcc, s[46:47]
  s_cbranch_scc1 L_cs1_rx
  s_add_u32 s35, s35, 1
  s_cmp_eq_u32 s35, 63
  s_nop 0
  v_add_f32_dpp v40, v40, v40 row_ror:8 row_mask:0xf bank_mask:0xf
  v_add_f32_dpp v41, v41, v41 row_ror:8 row_mask:0xf bank_mask:0xf
  v_add_f32_dpp v42, v42, v42 row_ror:8 row_mask:0xf bank_mask:0xf
  v_add_f32_dpp v43, v43, v43 row_ror:8 row_mask:0xf bank_mask:0xf
  v_add_f32_dpp v40, v40, v40 row_ror:4 row_mask:0xf bank_mask:0xf
  v_add_f32_dpp v41, v41, v41 row_ror:4 row_mask:0xf bank_mask:0xf
  v_add_f32_dpp v42, v42, v42 row_ror:4 row_mask:0xf bank_mask:0xf
  v_add_f32_dpp v43, v43, v43 row_ror:4 row_mask:0xf bank_mask:0xf
  v_cvt_pk_bf16_f32 v14, v40, v41
  v_cvt_pk_bf16_f32 v15, v42, v43
  buffer_store_dwordx2 v[14:15], v5, s[20:23], s50 offen sc1
  s_cbranch_scc1 L_cs1_done
  s_barrier
L_cs1_h2:
  buffer_load_dwordx4 v[40:43], v0, s[4:7], s48 offen offset:0
  v_mov_b64 v[24:25], 0
  v_mov_b64 v[26:27], 0
  v_mov_b64 v[28:29], 0
  v_mov_b64 v[30:31], 0
  v_mov_b64 v[16:17], 0
  v_mov_b64 v[18:19], 0
  v_mov_b64 v[20:21], 0
  v_mov_b64 v[22:23], 0
  buffer_load_dwordx4 v[52:55], v0, s[4:7], s48 offen offset:1024
  s_nop 7
  buffer_load_dwordx4 v[72:75], v0, s[4:7], s48 offen offset:2048
  s_nop 7
  buffer_load_dwordx4 v[76:79], v0, s[4:7], s48 offen offset:3072
  s_nop 7
  buffer_load_dwordx4 v[48:51], v0, s[4:7], s74 offen offset:0 sc1
  s_waitcnt vmcnt(4) lgkmcnt(0)
  v_smfmac_f32_16x16x64_bf16 v[16:19], v[40:43], v[56:63], v1
  buffer_load_dwordx4 v[44:47], v0, s[4:7], s75 offen offset:0
  ds_read_b128 v[56:59], v2 offset:32768
  v_max_u32 v11, v40, v42
  v_smfmac_f32_16x16x64_bf16 v[20:23], v[40:43], v[64:71], v1
  ds_read_b128 v[60:63], v2 offset:33792
  v_smfmac_f32_16x16x64_bf16 v[24:27], v[40:43], a[0:7], v1
  ds_read_b128 v[64:67], v2 offset:34816
  v_smfmac_f32_16x16x64_bf16 v[28:31], v[40:43], a[8:15], v1
  ds_read_b128 v[68:71], v2 offset:35840
  s_waitcnt vmcnt(4)
  v_smfmac_f32_16x16x64_bf16 v[16:19], v[52:55], a[32:39], v1
  v_max3_u32 v11, v11, v52, v54
  v_smfmac_f32_16x16x64_bf16 v[20:23], v[52:55], a[40:47], v1
  v_smfmac_f32_16x16x64_bf16 v[24:27], v[52:55], a[48:55], v1
  ds_write_b128 v0, v[52:55] offset:1024
  v_smfmac_f32_16x16x64_bf16 v[28:31], v[52:55], a[56:63], v1
  buffer_load_dwordx4 v[32:35], v0, s[4:7], s55 offen offset:2048 sc1
  s_waitcnt vmcnt(4) lgkmcnt(3)
  v_smfmac_f32_16x16x64_bf16 v[16:19], v[72:75], v[56:63], v1
  ds_read_b128 v[56:59], v2 offset:57344
  v_max3_u32 v11, v11, v72, v74
  s_waitcnt lgkmcnt(2)
  v_smfmac_f32_16x16x64_bf16 v[20:23], v[72:75], v[64:71], v1
  ds_read_b128 v[60:63], v2 offset:58368
  v_smfmac_f32_16x16x64_bf16 v[24:27], v[72:75], a[80:87], v1
  ds_read_b128 v[64:67], v2 offset:59392
  v_smfmac_f32_16x16x64_bf16 v[28:31], v[72:75], a[88:95], v1
  ds_read_b128 v[68:71], v2 offset:60416
  s_waitcnt vmcnt(3)
  v_smfmac_f32_16x16x64_bf16 v[16:19], v[76:79], a[112:119], v1
  v_max3_u32 v11, v11, v76, v78
  v_smfmac_f32_16x16x64_bf16 v[20:23], v[76:79], a[120:127], v1
  buffer_load_dwordx4 v[72:75], v0, s[4:7], s55 offen offset:0 sc1
  v_smfmac_f32_16x16x64_bf16 v[24:27], v[76:79], a[128:135], v1
  v_smfmac_f32_16x16x64_bf16 v[28:31], v[76:79], a[136:143], v1
  s_waitcnt vmcnt(3)
  ds_write_b128 v0, v[48:51] offset:5120
  s_waitcnt vmcnt(2) lgkmcnt(3)
  v_smfmac_f32_16x16x64_bf16 v[16:19], v[44:47], v[56:63], v1
  ds_read_b128 v[56:59], v2 offset:40960
  v_max3_u32 v11, v11, v44, v46
  s_waitcnt lgkmcnt(2)
  v_smfmac_f32_16x16x64_bf16 v[20:23], v[44:47], v[64:71], v1
  ds_read_b128 v[60:63], v2 offset:41984
  buffer_load_dwordx4 v[76:79], v0, s[4:7], s55 offen offset:1024 sc1
  v_max3_u32 v11, v11, v48, v50
  v_smfmac_f32_16x16x64_bf16 v[24:27], v[44:47], v[144:151], v1
  ds_read_b128 v[64:67], v2 offset:43008
  v_cmp_eq_u32 vcc, -1, v11
  v_smfmac_f32_16x16x64_bf16 v[28:31], v[44:47], v[152:159], v1
  ds_read_b128 v[68:71], v2 offset:44032
  v_lshlrev_b32 v6, 3, v0
  v_smfmac_f32_16x16x64_bf16 v[24:27], v[48:51], a[208:215], v1
  s_cbranch_vccnz L_cs1_h2q
  v_smfmac_f32_16x16x64_bf16 v[28:31], v[48:51], a[216:223], v1
  s_waitcnt lgkmcnt(4)
  s_barrier
  ds_read_b128 v[40:43], v0 offset:4096
  buffer_load_dwordx4 v[36:39], v0, s[4:7], s55 offen offset:3072 sc1
  v_smfmac_f32_16x16x64_bf16 v[16:19], v[48:51], a[192:199], v1
  ds_read_b128 v[52:55], v0 offset:7168
  v_smfmac_f32_16x16x64_bf16 v[20:23], v[48:51], a[200:207], v1
  s_waitcnt lgkmcnt(1)
  v_smfmac_f32_16x16x64_bf16 v[16:19], v[40:43], v[56:63], v1
  ds_read_b128 v[48:51], v0 offset:6144
  ds_read_b128 v[56:59], v2 offset:49152
  s_add_u32 s55, s55, s56
  v_smfmac_f32_16x16x64_bf16 v[20:23], v[40:43], v[64:71], v1
  ds_read_b128 v[60:63], v2 offset:50176
  ds_read_b128 v[64:67], v2 offset:51200
  v_smfmac_f32_16x16x64_bf16 v[24:27], v[40:43], a[160:167], v1
  ds_read_b128 v[68:71], v2 offset:52224
  buffer_store_dwordx2 v[14:15], v5, s[20:23], s59 offen sc1
  v_smfmac_f32_16x16x64_bf16 v[28:31], v[40:43], a[168:175], v1
  s_waitcnt lgkmcnt(5)
  v_smfmac_f32_16x16x64_bf16 v[16:19], v[52:55], v[96:103], v1
  v_smfmac_f32_16x16x64_bf16 v[20:23], v[52:55], v[104:111], v1
  s_mov_b32 exec_hi, 0
  buffer_load_dword v6, v6, s[4:7], s55 offen sc1
  s_mov_b32 exec_hi, -1
  s_waitcnt lgkmcnt(2)
  v_smfmac_f32_16x16x64_bf16 v[16:19], v[48:51], v[56:63], v1
  s_waitcnt lgkmcnt(0)
  v_smfmac_f32_16x16x64_bf16 v[20:23], v[48:51], v[64:71], v1
  ds_read_b128 v[64:67], v0 offset:15360
  v_smfmac_f32_16x16x64_bf16 v[24:27], v[52:55], v[112:119], v1
  ds_read_b128 v[68:71], v0 offset:15360
  v_add_f32 v16, v16, v18
  v_smfmac_f32_16x16x64_bf16 v[24:27], v[48:51], a[240:247], v1
  s_nop 0
  s_nop 0
  v_add_f32 v17, v17, v19
  v_smfmac_f32_16x16x64_bf16 v[28:31], v[52:55], v[120:127], v1
  s_mov_b64 vcc, s[72:73]
  v_cvt_pk_bf16_f32 v57, v16, v17
  v_smfmac_f32_16x16x64_bf16 v[28:31], v[48:51], a[248:255], v1
  v_add_f32 v24, v24, v26
  v_add_f32 v25, v25, v27
  v_cvt_pk_bf16_f32 v56, v24, v25
  ds_write_b64 v7, v[56:57] offset:9216
  v_pk_add_f32 v[20:21], v[20:21], v[22:23]
  s_nop 0
  v_pk_add_f32 v[28:29], v[28:29], v[30:31]
  v_cvt_pk_bf16_f32 v59, v20, v21
  v_cvt_pk_bf16_f32 v58, v28, v29
  ds_write_b64 v7, v[58:59] offset:9728
  ds_read_b64_tr_b16 v[60:61], v8 offset:9216
  ds_read_b64_tr_b16 v[62:63], v8 offset:9728
  s_waitcnt lgkmcnt(5)
  v_smfmac_f32_16x16x64_bf16 v[64:67], v[44:47], v[160:167], v1
  s_waitcnt lgkmcnt(4)
  v_smfmac_f32_16x16x64_bf16 v[68:71], v[44:47], v[168:175], v1
  buffer_store_dwordx2 v[12:13], v5, s[4:7], s57 offen sc1
  ds_read_b128 v[44:47], v0 offset:0
  v_lshrrev_b32 v59, 2, v0
  v_smfmac_f32_16x16x64_bf16 v[64:67], v[40:43], a[176:183], v1
  v_mov_b32 v31, 0x3f803f80
  v_smfmac_f32_16x16x64_bf16 v[68:71], v[40:43], a[184:191], v1
  ds_read_b128 v[40:43], v0 offset:1024
  v_smfmac_f32_16x16x64_bf16 v[64:67], v[52:55], v[128:135], v1
  s_waitcnt vmcnt(5) lgkmcnt(2)
  v_mfma_f32_16x16x32_bf16 v[16:19], v[72:75], v[60:63], 0
  v_mov_b32 v30, 0x3f803f80
  s_waitcnt vmcnt(4)
  v_mfma_f32_16x16x32_bf16 v[20:23], v[76:79], v[60:63], 0
  v_mov_b32 v29, 0x3f803f80
  v_mfma_f32_16x16x32_bf16 v[24:27], v[60:63], v[60:63], 0
  v_mov_b32 v28, 0x3f803f80
  v_smfmac_f32_16x16x64_bf16 v[68:71], v[52:55], v[136:143], v1
  ds_read_b128 v[52:55], v0 offset:2048
  v_cndmask_b32_dpp v16, v20, v16, vcc quad_perm:[2,3,0,1] row_mask:0xf bank_mask:0xf
  v_cndmask_b32_dpp v17, v21, v17, vcc quad_perm:[2,3,0,1] row_mask:0xf bank_mask:0xf
  v_cndmask_b32_dpp v18, v22, v18, vcc quad_perm:[2,3,0,1] row_mask:0xf bank_mask:0xf
  v_cndmask_b32_dpp v19, v23, v19, vcc quad_perm:[2,3,0,1] row_mask:0xf bank_mask:0xf
  v_cndmask_b32_dpp v24, v25, v24, vcc quad_perm:[2,3,0,1] row_mask:0xf bank_mask:0xf
  v_smfmac_f32_16x16x64_bf16 v[64:67], v[48:51], v[80:87], v1
  ds_write_b128 v0, v[16:19] offset:9216
  ds_write_b32 v59, v24 offset:12544
  v_smfmac_f32_16x16x64_bf16 v[68:71], v[48:51], v[88:95], v1
  ds_read_b128 v[48:51], v0 offset:3072
  s_waitcnt lgkmcnt(5)
  v_smfmac_f32_16x16x64_bf16 v[64:67], v[44:47], a[16:23], v1
  v_smfmac_f32_16x16x64_bf16 v[68:71], v[44:47], a[24:31], v1
  ds_read_b128 v[44:47], v0 offset:5120
  s_waitcnt lgkmcnt(5)
  v_smfmac_f32_16x16x64_bf16 v[64:67], v[40:43], a[64:71], v1
  v_smfmac_f32_16x16x64_bf16 v[68:71], v[40:43], a[72:79], v1
  s_waitcnt lgkmcnt(2)
  s_barrier
  ds_read_b128 v[20:23], v0 offset:8192
  ds_read_b128 v[72:75], v0 offset:11264
  v_smfmac_f32_16x16x64_bf16 v[64:67], v[52:55], a[96:103], v1
  ds_read_b128 v[76:79], v0 offset:10240
  v_smfmac_f32_16x16x64_bf16 v[68:71], v[52:55], a[104:111], v1
  ds_read2st64_b32 v[26:27], v59 offset0:48 offset1:51
  s_waitcnt lgkmcnt(5)
  v_smfmac_f32_16x16x64_bf16 v[64:67], v[48:51], a[144:151], v1
  ds_read_b32 v25, v59 offset:12800
  v_smfmac_f32_16x16x64_bf16 v[68:71], v[48:51], a[152:159], v1
  ds_read_b128 v[60:63], v2 offset:1024
  s_waitcnt lgkmcnt(6)
  v_smfmac_f32_16x16x64_bf16 v[64:67], v[44:47], a[224:231], v1
  ds_read_b128 v[56:59], v2 offset:0
  v_smfmac_f32_16x16x64_bf16 v[68:71], v[44:47], a[232:239], v1
  ds_read_b128 v[40:43], v2 offset:8192
  s_waitcnt lgkmcnt(7)
  v_add_f32 v16, v16, v20
  v_add_f32 v17, v17, v21
  v_add_f32 v18, v18, v22
  v_add_f32 v19, v19, v23
  s_waitcnt lgkmcnt(5)
  v_pk_add_f32 v[72:73], v[72:73], v[76:77]
  v_pk_add_f32 v[74:75], v[74:75], v[78:79]
  s_waitcnt lgkmcnt(3)
  v_pk_add_f32 v[24:25], v[24:25], v[26:27]
  v_pk_add_f32 v[16:17], v[16:17], v[72:73]
  v_pk_add_f32 v[18:19], v[18:19], v[74:75]
  v_add_f32 v24, v24, v25
  v_max3_f32 v72, v16, v17, v18
  v_max3_f32 v72, v72, v19, v24
  v_pk_add_f32 v[64:65], v[64:65], v[66:67]
  v_pk_add_f32 v[68:69], v[68:69], v[70:71]
  v_max_f32_dpp v72, v72, v72 quad_perm:[2,3,0,1] row_mask:0xf bank_mask:0xf
  v_mov_b32 v73, v72
  v_cvt_pk_bf16_f32 v70, v64, v65
  v_cvt_pk_bf16_f32 v71, v68, v69
  v_permlane16_swap_b32 v73, v72
  v_max_f32 v72, v72, v73
  v_mov_b32 v73, v72
  v_mov_b32 v27, 0
  v_mov_b32 v68, 0
  v_permlane32_swap_b32 v73, v72
  v_max_f32 v72, v72, v73
  v_mul_f32 v72, s70, v72
  v_fma_f32 v16, v16, s70, -v72
  v_fma_f32 v17, v17, s70, -v72
  v_fma_f32 v18, v18, s70, -v72
  v_fma_f32 v19, v19, s70, -v72
  v_fma_f32 v24, v24, s70, -v72
  v_exp_f32 v16, v16
  v_exp_f32 v17, v17
  v_exp_f32 v18, v18
  v_exp_f32 v19, v19
  v_cvt_pk_bf16_f32 v20, v16, v17
  v_cvt_pk_bf16_f32 v21, v18, v19
  v_exp_f32 v24, v24
  v_mov_b32_dpp v22, v20 quad_perm:[2,3,0,1] row_mask:0xf bank_mask:0xf
  v_mov_b32_dpp v23, v21 quad_perm:[2,3,0,1] row_mask:0xf bank_mask:0xf
  v_mov_b32_dpp v25, v24 quad_perm:[2,3,0,1] row_mask:0xf bank_mask:0xf
  v_cvt_pk_bf16_f32 v26, v24, v25
  v_mfma_f32_16x16x32_bf16 v[16:19], v[28:31], v[20:23], 0
  ds_read_b128 v[48:51], v2 offset:10240
  v_mov_b32 v69, v26
  v_mfma_f32_16x16x32_bf16 v[72:75], v[32:35], v[20:23], 0
  ds_read_b128 v[52:55], v2 offset:11264
  v_mov_b64 v[32:33], 0
  v_mfma_f32_16x16x16_bf16 v[16:19], v[28:29], v[26:27], v[16:19]
  ds_read_b128 v[44:47], v2 offset:9216
  v_mov_b64 v[34:35], 0
  s_waitcnt vmcnt(3)
  v_mfma_f32_16x16x32_bf16 v[76:79], v[36:39], v[20:23], 0
  ds_read_b128 v[64:67], v2 offset:2048
  v_mfma_f32_16x16x16_bf16 v[72:75], v[70:71], v[26:27], v[72:75]
  v_rcp_f32 v24, v16
  v_mfma_f32_16x16x16_bf16 v[76:79], v[70:71], v[68:69], v[76:79]
  ds_read_b128 v[68:71], v2 offset:3072
  s_mov_b64 exec, s[72:73]
  s_nop 1
  v_pk_mul_f32 v[72:73], v[72:73], v[24:25] op_sel_hi:[1,0]
  v_pk_mul_f32 v[74:75], v[74:75], v[24:25] op_sel_hi:[1,0]
  v_cvt_pk_bf16_f32 v36, v72, v73
  v_cvt_pk_bf16_f32 v37, v74, v75
  v_pk_mul_f32 v[76:77], v[76:77], v[24:25] op_sel_hi:[1,0]
  v_pk_mul_f32 v[78:79], v[78:79], v[24:25] op_sel_hi:[1,0]
  v_cvt_pk_bf16_f32 v38, v76, v77
  v_cvt_pk_bf16_f32 v39, v78, v79
  ds_write_b128 v9, v[36:39] offset:13824
  s_mov_b64 exec, -1
  v_mfma_f32_16x16x16_bf16 v[16:19], v[32:33], v[32:33], 0
  v_mfma_f32_16x16x16_bf16 v[20:23], v[32:33], v[32:33], 0
  v_mfma_f32_16x16x16_bf16 v[24:27], v[32:33], v[32:33], 0
  v_mfma_f32_16x16x16_bf16 v[28:31], v[32:33], v[32:33], 0
  s_waitcnt lgkmcnt(0)
  s_barrier
  ds_read_b128 v[72:75], v0 offset:13312
  ds_read_b128 v[76:79], v0 offset:14336
  s_waitcnt lgkmcnt(1)
  v_smfmac_f32_16x16x64_bf16 v[16:19], v[72:75], v[56:63], v1
  v_mov_b64 v[56:57], 0
  v_smfmac_f32_16x16x64_bf16 v[20:23], v[72:75], v[64:71], v1
  v_mov_b64 v[58:59], 0
  s_waitcnt lgkmcnt(0)
  v_smfmac_f32_16x16x64_bf16 v[16:19], v[76:79], v[40:47], v1
  ds_read_b128 v[40:43], v2 offset:61440
  v_mov_b64 v[60:61], 0
  v_smfmac_f32_16x16x64_bf16 v[20:23], v[76:79], v[48:55], v1
  ds_read_b128 v[44:47], v2 offset:62464
  ds_read_b128 v[48:51], v2 offset:63488
  v_mov_b64 v[62:63], 0
  v_smfmac_f32_16x16x64_bf16 v[24:27], v[72:75], v[176:183], v1
  ds_read_b128 v[52:55], v2 offset:64512
  v_add_f32 v16, v16, v18
  v_add_f32 v17, v17, v19
  v_smfmac_f32_16x16x64_bf16 v[28:31], v[72:75], v[184:191], v1
  ds_read_b128 v[64:67], v0 offset:15360
  v_cvt_pk_bf16_f32 v38, v16, v17
  v_bfi_b32 v38, v10, s35, v38
  v_smfmac_f32_16x16x64_bf16 v[24:27], v[76:79], v[192:199], v1
  ds_read_b128 v[68:71], v0 offset:15360
  v_add_f32 v20, v20, v22
  v_add_f32 v21, v21, v23
  v_smfmac_f32_16x16x64_bf16 v[28:31], v[76:79], v[200:207], v1
  v_cvt_pk_bf16_f32 v39, v20, v21
  s_waitcnt lgkmcnt(4)
  v_smfmac_f32_16x16x64_bf16 v[32:35], v[72:75], v[40:47], v1
  ds_read_b128 v[40:43], v2 offset:16384
  buffer_store_dwordx2 v[38:39], v3, s[4:7], s40 offen sc1
  v_add_f32 v24, v24, v26
  v_add_f32 v25, v25, v27
  s_waitcnt lgkmcnt(3)
  v_smfmac_f32_16x16x64_bf16 v[32:35], v[76:79], v[48:55], v1
  ds_read_b128 v[44:47], v2 offset:17408
  v_cvt_pk_bf16_f32 v36, v24, v25
  v_bfi_b32 v36, v10, s35, v36
  v_smfmac_f32_16x16x64_bf16 v[56:59], v[72:75], v[208:215], v1
  ds_read_b128 v[48:51], v2 offset:18432
  v_add_f32 v28, v28, v30
  v_add_f32 v29, v29, v31
  v_smfmac_f32_16x16x64_bf16 v[60:63], v[72:75], v[216:223], v1
  ds_read_b128 v[52:55], v2 offset:19456
  v_cvt_pk_bf16_f32 v37, v28, v29
  v_add_f32 v32, v32, v34
  v_smfmac_f32_16x16x64_bf16 v[56:59], v[76:79], v[224:231], v1
  buffer_store_dwordx2 v[36:37], v3, s[4:7], s41 offen sc1
  v_add_f32 v33, v33, v35
  v_cvt_pk_bf16_f32 v34, v32, v33
  v_smfmac_f32_16x16x64_bf16 v[60:63], v[76:79], v[232:239], v1
  v_bfi_b32 v34, v10, s35, v34
  s_waitcnt lgkmcnt(5)
  v_smfmac_f32_16x16x64_bf16 v[64:67], v[72:75], v[240:247], v1
  buffer_store_dword v34, v4, s[4:7], s40 offen sc1
  v_add_f32 v56, v56, v58
  v_add_f32 v57, v57, v59
  s_waitcnt lgkmcnt(4)
  v_smfmac_f32_16x16x64_bf16 v[68:71], v[72:75], v[248:255], v1
  v_cvt_pk_bf16_f32 v38, v56, v57
  v_bfi_b32 v38, v10, s35, v38
  s_waitcnt lgkmcnt(2)
  v_smfmac_f32_16x16x64_bf16 v[64:67], v[76:79], v[40:47], v1
  v_add_f32 v60, v60, v62
  s_waitcnt lgkmcnt(0)
  v_smfmac_f32_16x16x64_bf16 v[68:71], v[76:79], v[48:55], v1
  v_add_f32 v61, v61, v63
  v_cvt_pk_bf16_f32 v39, v60, v61
  buffer_store_dwordx2 v[38:39], v3, s[4:7], s42 offen sc1
  v_pk_add_f32 v[64:65], v[64:65], v[66:67]
  v_cvt_pk_bf16_f32 v36, v64, v65
  v_bfi_b32 v36, v10, s35, v36
  v_pk_add_f32 v[68:69], v[68:69], v[70:71]
  v_cvt_pk_bf16_f32 v37, v68, v69
  buffer_store_dwordx2 v[36:37], v3, s[4:7], s43 offen sc1
  v_mov_b32 v40, 0x3f80
  v_cndmask_b32 v40, v40, 1.0, s[60:61]
  v_cndmask_b32 v46, 0, v40, s[66:67]
  v_cndmask_b32 v47, 0, v40, s[68:69]
  v_cndmask_b32 v44, 0, v40, s[62:63]
  v_cndmask_b32 v45, 0, v40, s[64:65]
  ds_read_b128 v[56:59], v2 offset:24576
  ds_read_b128 v[60:63], v2 offset:25600
  ds_read_b128 v[64:67], v2 offset:26624
  ds_read_b128 v[68:71], v2 offset:27648
  s_add_u32 s57, s57, s77
  s_add_u32 s48, s48, 9216
  s_add_u32 s59, s59, s77
  s_add_u32 s50, s54, s48
  s_add_u32 s49, s53, s48
  s_add_u32 s74, s74, 9216
  s_add_u32 s75, s75, 9216
  s_mov_b32 s77, 9216
  s_nop 11
  buffer_load_dwordx4 v[24:27], v0, s[4:7], s44 offen sc1
  buffer_load_dwordx4 v[28:31], v0, s[4:7], s44 offen offset:1024 sc1
  s_nop 14
  buffer_load_dwordx4 v[16:19], v0, s[20:23], s45 offen sc1
  buffer_load_dwordx4 v[20:23], v0, s[20:23], s45 offen offset:1024 sc1
  s_branch L_cs1_top
L_cs1_h2q:
L_cs1_h2r:
  buffer_load_dwordx4 v[40:43], v0, s[4:7], s48 offen offset:0 sc1
  buffer_load_dwordx4 v[52:55], v0, s[4:7], s48 offen offset:1024 sc1
  buffer_load_dwordx4 v[72:75], v0, s[4:7], s48 offen offset:2048 sc1
  buffer_load_dwordx4 v[76:79], v0, s[4:7], s48 offen offset:3072 sc1
  buffer_load_dwordx4 v[44:47], v0, s[4:7], s75 offen offset:0 sc1
  s_nop 3
L_cs1_entry:
  ds_read_b128 v[56:59], v2 offset:24576
  ds_read_b128 v[60:63], v2 offset:25600
  ds_read_b128 v[64:67], v2 offset:26624
  ds_read_b128 v[68:71], v2 offset:27648
  s_sub_u32 s31, s31, 1
  s_cbranch_scc1 L_exit
  v_mov_b64 v[16:17], 0
  v_mov_b64 v[18:19], 0
  v_mov_b64 v[20:21], 0
  v_mov_b64 v[22:23], 0
  v_mov_b64 v[24:25], 0
  v_mov_b64 v[26:27], 0
  v_mov_b64 v[28:29], 0
  v_mov_b64 v[30:31], 0
  s_branch L_cs1_h2
L_cs1_ru:
  buffer_load_dwordx4 v[24:27], v0, s[4:7], s44 offen sc1
  buffer_load_dwordx4 v[28:31], v0, s[4:7], s44 offen offset:1024 sc1
  buffer_load_dwordx4 v[16:19], v0, s[20:23], s45 offen sc1
  buffer_load_dwordx4 v[20:23], v0, s[20:23], s45 offen offset:1024 sc1
  s_sub_u32 s31, s31, 1
  s_cbranch_scc1 L_exit
  s_waitcnt vmcnt(0)
  s_branch L_cs1_h1m
L_cs1_rx:
  buffer_load_dwordx4 v[16:19], v0, s[4:7], s45 offen sc1
  buffer_load_dwordx4 v[20:23], v0, s[4:7], s45 offen offset:1024 sc1
  s_sub_u32 s31, s31, 1
  s_cbranch_scc1 L_exit
  s_waitcnt vmcnt(0)
  s_branch L_cs1_h1x
L_cs1_done:
  buffer_store_dwordx2 v[12:13], v5, s[4:7], s57 offen sc1
  buffer_store_dwordx2 v[14:15], v5, s[20:23], s59 offen sc1
  s_branch L_exit
.p2align 6
L_cs2_top:
  s_waitcnt vmcnt(0)
L_cs2_h1m:
  v_mfma_f32_16x16x32_bf16 v[40:43], v[44:47], v[24:27], 0
  v_bitop3_b32 v12, v24, v28, s35 bitop3:0x7e
  v_and_b32 v12, 1, v12
  v_mfma_f32_16x16x32_bf16 v[40:43], v[44:47], v[28:31], v[40:43]
  v_cmp_ne_u32 vcc, 0, v12
  s_cbranch_vccnz L_cs2_ru
  s_add_u32 s35, s35, 1
  s_cmp_eq_u32 s35, 63
  s_nop 2
  v_add_f32_dpp v40, v40, v40 row_ror:8 row_mask:0xf bank_mask:0xf
  v_add_f32_dpp v41, v41, v41 row_ror:8 row_mask:0xf bank_mask:0xf
  v_add_f32_dpp v42, v42, v42 row_ror:8 row_mask:0xf bank_mask:0xf
  v_add_f32_dpp v43, v43, v43 row_ror:8 row_mask:0xf bank_mask:0xf
  v_add_f32_dpp v40, v40, v40 row_ror:4 row_mask:0xf bank_mask:0xf
  v_add_f32_dpp v41, v41, v41 row_ror:4 row_mask:0xf bank_mask:0xf
  v_add_f32_dpp v42, v42, v42 row_ror:4 row_mask:0xf bank_mask:0xf
  v_add_f32_dpp v43, v43, v43 row_ror:4 row_mask:0xf bank_mask:0xf
  v_cvt_pk_bf16_f32 v12, v40, v41
  v_cvt_pk_bf16_f32 v13, v42, v43
  buffer_store_dwordx2 v[12:13], v5, s[4:7], s49 offen sc1
  s_cbranch_scc1 L_cs2_done
  s_barrier
L_cs2_h2:
  buffer_load_dwordx4 v[40:43], v0, s[4:7], s48 offen offset:0
  v_mov_b64 v[24:25], 0
  v_mov_b64 v[26:27], 0
  v_mov_b64 v[28:29], 0
  v_mov_b64 v[30:31], 0
  s_nop 3
  buffer_load_dwordx4 v[52:55], v0, s[4:7], s48 offen offset:1024
  s_nop 7
  buffer_load_dwordx4 v[72:75], v0, s[4:7], s48 offen offset:2048
  s_nop 7
  buffer_load_dwordx4 v[76:79], v0, s[4:7], s48 offen offset:3072
  s_nop 7
  buffer_load_dwordx4 v[48:51], v0, s[4:7], s74 offen offset:0 sc1
  s_waitcnt vmcnt(4) lgkmcnt(0)
  v_smfmac_f32_16x16x64_bf16 v[16:19], v[40:43], v[56:63], v1
  buffer_load_dwordx4 v[44:47], v0, s[4:7], s75 offen offset:0
  ds_read_b128 v[56:59], v2 offset:36864
  v_max_u32 v11, v40, v42
  v_smfmac_f32_16x16x64_bf16 v[20:23], v[40:43], v[64:71], v1
  ds_read_b128 v[60:63], v2 offset:37888
  v_smfmac_f32_16x16x64_bf16 v[24:27], v[40:43], a[0:7], v1
  ds_read_b128 v[64:67], v2 offset:38912
  v_smfmac_f32_16x16x64_bf16 v[28:31], v[40:43], a[8:15], v1
  ds_read_b128 v[68:71], v2 offset:39936
  s_waitcnt vmcnt(4)
  v_smfmac_f32_16x16x64_bf16 v[16:19], v[52:55], a[32:39], v1
  v_max3_u32 v11, v11, v52, v54
  v_smfmac_f32_16x16x64_bf16 v[20:23], v[52:55], a[40:47], v1
  v_smfmac_f32_16x16x64_bf16 v[24:27], v[52:55], a[48:55], v1
  v_smfmac_f32_16x16x64_bf16 v[28:31], v[52:55], a[56:63], v1
  s_waitcnt vmcnt(3) lgkmcnt(2)
  v_smfmac_f32_16x16x64_bf16 v[16:19], v[72:75], v[56:63], v1
  ds_read_b128 v[56:59], v2 offset:61440
  buffer_load_dwordx4 v[32:35], v0, s[4:7], s55 offen offset:2048 sc1
  v_max3_u32 v11, v11, v72, v74
  s_waitcnt lgkmcnt(1)
  v_smfmac_f32_16x16x64_bf16 v[20:23], v[72:75], v[64:71], v1
  ds_write_b128 v0, v[72:75] offset:2048
  ds_read_b128 v[60:63], v2 offset:62464
  v_smfmac_f32_16x16x64_bf16 v[24:27], v[72:75], a[80:87], v1
  ds_read_b128 v[64:67], v2 offset:63488
  v_smfmac_f32_16x16x64_bf16 v[28:31], v[72:75], a[88:95], v1
  ds_read_b128 v[68:71], v2 offset:64512
  s_waitcnt vmcnt(3)
  v_smfmac_f32_16x16x64_bf16 v[16:19], v[76:79], a[112:119], v1
  v_max3_u32 v11, v11, v76, v78
  v_smfmac_f32_16x16x64_bf16 v[20:23], v[76:79], a[120:127], v1
  v_smfmac_f32_16x16x64_bf16 v[24:27], v[76:79], a[128:135], v1
  buffer_load_dwordx4 v[72:75], v0, s[4:7], s55 offen offset:0 sc1
  v_smfmac_f32_16x16x64_bf16 v[28:31], v[76:79], a[136:143], v1
  s_waitcnt vmcnt(3)
  ds_write_b128 v0, v[48:51] offset:6144
  s_waitcnt vmcnt(2) lgkmcnt(3)
  v_smfmac_f32_16x16x64_bf16 v[16:19], v[44:47], v[56:63], v1
  ds_read_b128 v[56:59], v2 offset:53248
  v_max3_u32 v11, v11, v44, v46
  s_waitcnt lgkmcnt(2)
  v_smfmac_f32_16x16x64_bf16 v[20:23], v[44:47], v[64:71], v1
  ds_read_b128 v[60:63], v2 offset:54272
  ds_read_b128 v[64:67], v2 offset:55296
  v_max3_u32 v11, v11, v48, v50
  v_smfmac_f32_16x16x64_bf16 v[24:27], v[44:47], v[144:151], v1
  ds_read_b128 v[68:71], v2 offset:56320
  buffer_load_dwordx4 v[76:79], v0, s[4:7], s55 offen offset:1024 sc1
  v_cmp_eq_u32 vcc, -1, v11
  v_smfmac_f32_16x16x64_bf16 v[28:31], v[44:47], v[152:159], v1
  v_lshlrev_b32 v6, 3, v0
  v_smfmac_f32_16x16x64_bf16 v[24:27], v[48:51], a[240:247], v1
  s_cbranch_vccnz L_cs2_h2q
  v_smfmac_f32_16x16x64_bf16 v[28:31], v[48:51], a[248:255], v1
  s_waitcnt lgkmcnt(4)
  s_barrier
  ds_read_b128 v[40:43], v0 offset:7168
  s_waitcnt lgkmcnt(3)
  v_smfmac_f32_16x16x64_bf16 v[16:19], v[48:51], v[56:63], v1
  ds_read_b128 v[52:55], v0 offset:4096
  ds_read_b128 v[56:59], v2 offset:45056
  buffer_load_dwordx4 v[36:39], v0, s[4:7], s55 offen offset:3072 sc1
  s_waitcnt lgkmcnt(3)
  v_smfmac_f32_16x16x64_bf16 v[20:23], v[48:51], v[64:71], v1
  ds_read_b128 v[60:63], v2 offset:46080
  ds_read_b128 v[64:67], v2 offset:47104
  s_waitcnt lgkmcnt(4)
  v_smfmac_f32_16x16x64_bf16 v[16:19], v[40:43], v[96:103], v1
  ds_read_b128 v[48:51], v0 offset:5120
  ds_read_b128 v[68:71], v2 offset:48128
  s_add_u32 s55, s55, s56
  v_smfmac_f32_16x16x64_bf16 v[20:23], v[40:43], v[104:111], v1
  v_smfmac_f32_16x16x64_bf16 v[24:27], v[40:43], v[112:119], v1
  v_smfmac_f32_16x16x64_bf16 v[28:31], v[40:43], v[120:127], v1
  s_waitcnt lgkmcnt(3)
  v_smfmac_f32_16x16x64_bf16 v[16:19], v[52:55], v[56:63], v1
  s_waitcnt lgkmcnt(0)
  v_smfmac_f32_16x16x64_bf16 v[20:23], v[52:55], v[64:71], v1
  v_smfmac_f32_16x16x64_bf16 v[16:19], v[48:51], a[192:199], v1
  v_smfmac_f32_16x16x64_bf16 v[20:23], v[48:51], a[200:207], v1
  ds_read_b128 v[64:67], v0 offset:15360
  s_mov_b32 exec_hi, 0
  buffer_load_dword v6, v6, s[4:7], s55 offen sc1
  s_mov_b32 exec_hi, -1
  v_smfmac_f32_16x16x64_bf16 v[24:27], v[52:55], a[160:167], v1
  ds_read_b128 v[68:71], v0 offset:15360
  v_add_f32 v16, v16, v18
  v_smfmac_f32_16x16x64_bf16 v[24:27], v[48:51], a[208:215], v1
  s_nop 0
  s_nop 0
  v_add_f32 v17, v17, v19
  v_smfmac_f32_16x16x64_bf16 v[28:31], v[52:55], a[168:175], v1
  s_mov_b64 vcc, s[72:73]
  v_cvt_pk_bf16_f32 v57, v16, v17
  v_smfmac_f32_16x16x64_bf16 v[28:31], v[48:51], a[216:223], v1
  v_add_f32 v24, v24, v26
  v_add_f32 v25, v25, v27
  v_cvt_pk_bf16_f32 v56, v24, v25
  ds_write_b64 v7, v[56:57] offset:10240
  v_pk_add_f32 v[20:21], v[20:21], v[22:23]
  s_nop 0
  v_pk_add_f32 v[28:29], v[28:29], v[30:31]
  v_cvt_pk_bf16_f32 v59, v20, v21
  v_cvt_pk_bf16_f32 v58, v28, v29
  ds_write_b64 v7, v[58:59] offset:10752
  ds_read_b64_tr_b16 v[60:61], v8 offset:10240
  ds_read_b64_tr_b16 v[62:63], v8 offset:10752
  s_waitcnt lgkmcnt(5)
  v_smfmac_f32_16x16x64_bf16 v[64:67], v[44:47], v[160:167], v1
  s_waitcnt lgkmcnt(4)
  v_smfmac_f32_16x16x64_bf16 v[68:71], v[44:47], v[168:175], v1
  ds_read_b128 v[44:47], v0 offset:0
  v_lshrrev_b32 v59, 2, v0
  v_smfmac_f32_16x16x64_bf16 v[64:67], v[40:43], v[128:135], v1
  buffer_store_dwordx2 v[12:13], v5, s[4:7], s57 offen sc1
  v_mov_b32 v31, 0x3f803f80
  v_smfmac_f32_16x16x64_bf16 v[68:71], v[40:43], v[136:143], v1
  ds_read_b128 v[40:43], v0 offset:1024
  v_smfmac_f32_16x16x64_bf16 v[64:67], v[52:55], a[176:183], v1
  s_waitcnt vmcnt(4) lgkmcnt(2)
  v_mfma_f32_16x16x32_bf16 v[16:19], v[72:75], v[60:63], 0
  v_mov_b32 v30, 0x3f803f80
  s_waitcnt vmcnt(3)
  v_mfma_f32_16x16x32_bf16 v[20:23], v[76:79], v[60:63], 0
  v_mov_b32 v29, 0x3f803f80
  v_mfma_f32_16x16x32_bf16 v[24:27], v[60:63], v[60:63], 0
  v_mov_b32 v28, 0x3f803f80
  v_smfmac_f32_16x16x64_bf16 v[68:71], v[52:55], a[184:191], v1
  ds_read_b128 v[52:55], v0 offset:2048
  v_cndmask_b32_dpp v16, v20, v16, vcc quad_perm:[2,3,0,1] row_mask:0xf bank_mask:0xf
  v_cndmask_b32_dpp v17, v21, v17, vcc quad_perm:[2,3,0,1] row_mask:0xf bank_mask:0xf
  v_cndmask_b32_dpp v18, v22, v18, vcc quad_perm:[2,3,0,1] row_mask:0xf bank_mask:0xf
  v_cndmask_b32_dpp v19, v23, v19, vcc quad_perm:[2,3,0,1] row_mask:0xf bank_mask:0xf
  v_cndmask_b32_dpp v24, v25, v24, vcc quad_perm:[2,3,0,1] row_mask:0xf bank_mask:0xf
  v_smfmac_f32_16x16x64_bf16 v[64:67], v[48:51], a[224:231], v1
  ds_write_b128 v0, v[16:19] offset:10240
  ds_write_b32 v59, v24 offset:12800
  v_smfmac_f32_16x16x64_bf16 v[68:71], v[48:51], a[232:239], v1
  ds_read_b128 v[48:51], v0 offset:3072
  s_waitcnt lgkmcnt(5)
  v_smfmac_f32_16x16x64_bf16 v[64:67], v[44:47], a[16:23], v1
  v_smfmac_f32_16x16x64_bf16 v[68:71], v[44:47], a[24:31], v1
  ds_read_b128 v[44:47], v0 offset:6144
  s_waitcnt lgkmcnt(5)
  v_smfmac_f32_16x16x64_bf16 v[64:67], v[40:43], a[64:71], v1
  v_smfmac_f32_16x16x64_bf16 v[68:71], v[40:43], a[72:79], v1
  s_waitcnt lgkmcnt(2)
  s_barrier
  ds_read_b128 v[20:23], v0 offset:11264
  ds_read_b128 v[72:75], v0 offset:8192
  v_smfmac_f32_16x16x64_bf16 v[64:67], v[52:55], a[96:103], v1
  ds_read_b128 v[76:79], v0 offset:9216
  v_smfmac_f32_16x16x64_bf16 v[68:71], v[52:55], a[104:111], v1
  ds_read2st64_b32 v[26:27], v59 offset0:51 offset1:48
  s_waitcnt lgkmcnt(5)
  v_smfmac_f32_16x16x64_bf16 v[64:67], v[48:51], a[144:151], v1
  ds_read_b32 v25, v59 offset:12544
  v_smfmac_f32_16x16x64_bf16 v[68:71], v[48:51], a[152:159], v1
  ds_read_b128 v[60:63], v2 offset:5120
  s_waitcnt lgkmcnt(6)
  v_smfmac_f32_16x16x64_bf16 v[64:67], v[44:47], v[80:87], v1
  ds_read_b128 v[56:59], v2 offset:4096
  v_smfmac_f32_16x16x64_bf16 v[68:71], v[44:47], v[88:95], v1
  ds_read_b128 v[40:43], v2 offset:12288
  s_waitcnt lgkmcnt(7)
  v_add_f32 v16, v16, v20
  v_add_f32 v17, v17, v21
  v_add_f32 v18, v18, v22
  v_add_f32 v19, v19, v23
  s_waitcnt lgkmcnt(5)
  v_pk_add_f32 v[72:73], v[72:73], v[76:77]
  v_pk_add_f32 v[74:75], v[74:75], v[78:79]
  s_waitcnt lgkmcnt(3)
  v_pk_add_f32 v[24:25], v[24:25], v[26:27]
  v_pk_add_f32 v[16:17], v[16:17], v[72:73]
  v_pk_add_f32 v[18:19], v[18:19], v[74:75]
  v_add_f32 v24, v24, v25
  v_max3_f32 v72, v16, v17, v18
  v_max3_f32 v72, v72, v19, v24
  v_pk_add_f32 v[64:65], v[64:65], v[66:67]
  v_pk_add_f32 v[68:69], v[68:69], v[70:71]
  v_max_f32_dpp v72, v72, v72 quad_perm:[2,3,0,1] row_mask:0xf bank_mask:0xf
  v_mov_b32 v73, v72
  v_cvt_pk_bf16_f32 v70, v64, v65
  v_cvt_pk_bf16_f32 v71, v68, v69
  v_permlane16_swap_b32 v73, v72
  v_max_f32 v72, v72, v73
  v_mov_b32 v73, v72
  v_mov_b32 v27, 0
  v_mov_b32 v68, 0
  v_permlane32_swap_b32 v73, v72
  v_max_f32 v72, v72, v73
  v_mul_f32 v72, s70, v72
  v_fma_f32 v16, v16, s70, -v72
  v_fma_f32 v17, v17, s70, -v72
  v_fma_f32 v18, v18, s70, -v72
  v_fma_f32 v19, v19, s70, -v72
  v_fma_f32 v24, v24, s70, -v72
  v_exp_f32 v16, v16
  v_exp_f32 v17, v17
  v_exp_f32 v18, v18
  v_exp_f32 v19, v19
  v_cvt_pk_bf16_f32 v20, v16, v17
  v_cvt_pk_bf16_f32 v21, v18, v19
  v_exp_f32 v24, v24
  v_mov_b32_dpp v22, v20 quad_perm:[2,3,0,1] row_mask:0xf bank_mask:0xf
  v_mov_b32_dpp v23, v21 quad_perm:[2,3,0,1] row_mask:0xf bank_mask:0xf
  v_mov_b32_dpp v25, v24 quad_perm:[2,3,0,1] row_mask:0xf bank_mask:0xf
  v_cvt_pk_bf16_f32 v26, v24, v25
  v_mfma_f32_16x16x32_bf16 v[16:19], v[28:31], v[20:23], 0
  ds_read_b128 v[48:51], v2 offset:14336
  v_mov_b32 v69, v26
  v_mfma_f32_16x16x32_bf16 v[72:75], v[32:35], v[20:23], 0
  ds_read_b128 v[52:55], v2 offset:15360
  v_mov_b64 v[32:33], 0
  v_mfma_f32_16x16x16_bf16 v[16:19], v[28:29], v[26:27], v[16:19]
  ds_read_b128 v[44:47], v2 offset:13312
  v_mov_b64 v[34:35], 0
  s_waitcnt vmcnt(2)
  v_mfma_f32_16x16x32_bf16 v[76:79], v[36:39], v[20:23], 0
  ds_read_b128 v[64:67], v2 offset:6144
  v_mfma_f32_16x16x16_bf16 v[72:75], v[70:71], v[26:27], v[72:75]
  v_rcp_f32 v24, v16
  v_mfma_f32_16x16x16_bf16 v[76:79], v[70:71], v[68:69], v[76:79]
  ds_read_b128 v[68:71], v2 offset:7168
  s_mov_b64 exec, s[72:73]
  s_nop 1
  v_pk_mul_f32 v[72:73], v[72:73], v[24:25] op_sel_hi:[1,0]
  v_pk_mul_f32 v[74:75], v[74:75], v[24:25] op_sel_hi:[1,0]
  v_cvt_pk_bf16_f32 v36, v72, v73
  v_cvt_pk_bf16_f32 v37, v74, v75
  v_pk_mul_f32 v[76:77], v[76:77], v[24:25] op_sel_hi:[1,0]
  v_pk_mul_f32 v[78:79], v[78:79], v[24:25] op_sel_hi:[1,0]
  v_cvt_pk_bf16_f32 v38, v76, v77
  v_cvt_pk_bf16_f32 v39, v78, v79
  ds_write_b128 v9, v[36:39] offset:14336
  s_mov_b64 exec, -1
  v_mfma_f32_16x16x16_bf16 v[16:19], v[32:33], v[32:33], 0
  v_mfma_f32_16x16x16_bf16 v[20:23], v[32:33], v[32:33], 0
  v_mfma_f32_16x16x16_bf16 v[24:27], v[32:33], v[32:33], 0
  v_mfma_f32_16x16x16_bf16 v[28:31], v[32:33], v[32:33], 0
  s_waitcnt lgkmcnt(0)
  s_barrier
  ds_read_b128 v[72:75], v0 offset:13312
  ds_read_b128 v[76:79], v0 offset:14336
  s_waitcnt lgkmcnt(1)
  v_smfmac_f32_16x16x64_bf16 v[16:19], v[72:75], v[56:63], v1
  v_mov_b64 v[56:57], 0
  v_smfmac_f32_16x16x64_bf16 v[20:23], v[72:75], v[64:71], v1
  v_mov_b64 v[58:59], 0
  s_waitcnt lgkmcnt(0)
  v_smfmac_f32_16x16x64_bf16 v[16:19], v[76:79], v[40:47], v1
  ds_read_b128 v[40:43], v2 offset:0
  v_mov_b64 v[60:61], 0
  v_smfmac_f32_16x16x64_bf16 v[20:23], v[76:79], v[48:55], v1
  ds_read_b128 v[44:47], v2 offset:1024
  ds_read_b128 v[48:51], v2 offset:2048
  v_mov_b64 v[62:63], 0
  v_smfmac_f32_16x16x64_bf16 v[24:27], v[72:75], v[176:183], v1
  ds_read_b128 v[52:55], v2 offset:3072
  v_add_f32 v16, v16, v18
  v_add_f32 v17, v17, v19
  v_smfmac_f32_16x16x64_bf16 v[28:31], v[72:75], v[184:191], v1
  ds_read_b128 v[64:67], v0 offset:15360
  v_cvt_pk_bf16_f32 v38, v16, v17
  v_bfi_b32 v38, v10, s35, v38
  v_smfmac_f32_16x16x64_bf16 v[24:27], v[76:79], v[192:199], v1
  ds_read_b128 v[68:71], v0 offset:15360
  v_add_f32 v20, v20, v22
  v_add_f32 v21, v21, v23
  v_smfmac_f32_16x16x64_bf16 v[28:31], v[76:79], v[200:207], v1
  v_cvt_pk_bf16_f32 v39, v20, v21
  s_waitcnt lgkmcnt(4)
  v_smfmac_f32_16x16x64_bf16 v[32:35], v[72:75], v[40:47], v1
  ds_read_b128 v[40:43], v2 offset:20480
  buffer_store_dwordx2 v[38:39], v3, s[4:7], s40 offen sc1
  v_add_f32 v24, v24, v26
  v_add_f32 v25, v25, v27
  s_waitcnt lgkmcnt(3)
  v_smfmac_f32_16x16x64_bf16 v[32:35], v[76:79], v[48:55], v1
  ds_read_b128 v[44:47], v2 offset:21504
  v_cvt_pk_bf16_f32 v36, v24, v25
  v_bfi_b32 v36, v10, s35, v36
  v_smfmac_f32_16x16x64_bf16 v[56:59], v[72:75], v[208:215], v1
  ds_read_b128 v[48:51], v2 offset:22528
  v_add_f32 v28, v28, v30
  v_add_f32 v29, v29, v31
  v_smfmac_f32_16x16x64_bf16 v[60:63], v[72:75], v[216:223], v1
  ds_read_b128 v[52:55], v2 offset:23552
  v_cvt_pk_bf16_f32 v37, v28, v29
  v_add_f32 v32, v32, v34
  v_smfmac_f32_16x16x64_bf16 v[56:59], v[76:79], v[224:231], v1
  buffer_store_dwordx2 v[36:37], v3, s[4:7], s41 offen sc1
  v_add_f32 v33, v33, v35
  v_cvt_pk_bf16_f32 v34, v32, v33
  v_smfmac_f32_16x16x64_bf16 v[60:63], v[76:79], v[232:239], v1
  v_bfi_b32 v34, v10, s35, v34
  s_waitcnt lgkmcnt(5)
  v_smfmac_f32_16x16x64_bf16 v[64:67], v[72:75], v[240:247], v1
  buffer_store_dword v34, v4, s[4:7], s40 offen sc1
  v_add_f32 v56, v56, v58
  v_add_f32 v57, v57, v59
  s_waitcnt lgkmcnt(4)
  v_smfmac_f32_16x16x64_bf16 v[68:71], v[72:75], v[248:255], v1
  v_cvt_pk_bf16_f32 v38, v56, v57
  v_bfi_b32 v38, v10, s35, v38
  s_waitcnt lgkmcnt(2)
  v_smfmac_f32_16x16x64_bf16 v[64:67], v[76:79], v[40:47], v1
  v_add_f32 v60, v60, v62
  s_waitcnt lgkmcnt(0)
  v_smfmac_f32_16x16x64_bf16 v[68:71], v[76:79], v[48:55], v1
  v_add_f32 v61, v61, v63
  v_cvt_pk_bf16_f32 v39, v60, v61
  buffer_store_dwordx2 v[38:39], v3, s[4:7], s42 offen sc1
  v_pk_add_f32 v[64:65], v[64:65], v[66:67]
  v_cvt_pk_bf16_f32 v36, v64, v65
  v_bfi_b32 v36, v10, s35, v36
  v_pk_add_f32 v[68:69], v[68:69], v[70:71]
  v_cvt_pk_bf16_f32 v37, v68, v69
  buffer_store_dwordx2 v[36:37], v3, s[4:7], s43 offen sc1
  v_mov_b32 v40, 0x3f80
  v_cndmask_b32 v40, v40, 1.0, s[60:61]
  v_cndmask_b32 v46, 0, v40, s[66:67]
  v_cndmask_b32 v47, 0, v40, s[68:69]
  v_cndmask_b32 v44, 0, v40, s[62:63]
  v_cndmask_b32 v45, 0, v40, s[64:65]
  ds_read_b128 v[56:59], v2 offset:28672
  ds_read_b128 v[60:63], v2 offset:29696
  ds_read_b128 v[64:67], v2 offset:30720
  ds_read_b128 v[68:71], v2 offset:31744
  v_mov_b64 v[16:17], 0
  v_mov_b64 v[18:19], 0
  v_mov_b64 v[20:21], 0
  v_mov_b64 v[22:23], 0
  s_add_u32 s57, s57, s77
  s_add_u32 s48, s48, 9216
  s_add_u32 s49, s53, s48
  s_add_u32 s74, s74, 9216
  s_add_u32 s75, s75, 9216
  s_mov_b32 s77, 9216
  s_nop 15
  s_nop 15
  s_nop 15
  buffer_load_dwordx4 v[24:27], v0, s[4:7], s44 offen sc1
  buffer_load_dwordx4 v[28:31], v0, s[4:7], s44 offen offset:1024 sc1
  s_branch L_cs2_top
L_cs2_h2q:
L_cs2_h2r:
  buffer_load_dwordx4 v[40:43], v0, s[4:7], s48 offen offset:0 sc1
  buffer_load_dwordx4 v[52:55], v0, s[4:7], s48 offen offset:1024 sc1
  buffer_load_dwordx4 v[72:75], v0, s[4:7], s48 offen offset:2048 sc1
  buffer_load_dwordx4 v[76:79], v0, s[4:7], s48 offen offset:3072 sc1
  buffer_load_dwordx4 v[44:47], v0, s[4:7], s75 offen offset:0 sc1
  s_nop 3
L_cs2_entry:
  ds_read_b128 v[56:59], v2 offset:28672
  ds_read_b128 v[60:63], v2 offset:29696
  ds_read_b128 v[64:67], v2 offset:30720
  ds_read_b128 v[68:71], v2 offset:31744
  s_sub_u32 s31, s31, 1
  s_cbranch_scc1 L_exit
  v_mov_b64 v[16:17], 0
  v_mov_b64 v[18:19], 0
  v_mov_b64 v[20:21], 0
  v_mov_b64 v[22:23], 0
  v_mov_b64 v[24:25], 0
  v_mov_b64 v[26:27], 0
  v_mov_b64 v[28:29], 0
  v_mov_b64 v[30:31], 0
  s_branch L_cs2_h2
L_cs2_ru:
  buffer_load_dwordx4 v[24:27], v0, s[4:7], s44 offen sc1
  buffer_load_dwordx4 v[28:31], v0, s[4:7], s44 offen offset:1024 sc1
  s_sub_u32 s31, s31, 1
  s_cbranch_scc1 L_exit
  s_waitcnt vmcnt(0)
  s_branch L_cs2_h1m
L_cs2_done:
  buffer_store_dwordx2 v[12:13], v5, s[4:7], s57 offen sc1
  s_branch L_exit
.p2align 6
L_cs3_top:
  s_waitcnt vmcnt(0)
L_cs3_h1m:
  v_mfma_f32_16x16x32_bf16 v[40:43], v[44:47], v[24:27], 0
  v_bitop3_b32 v12, v24, v28, s35 bitop3:0x7e
  v_and_b32 v12, 1, v12
  v_mfma_f32_16x16x32_bf16 v[40:43], v[44:47], v[28:31], v[40:43]
  v_cmp_ne_u32 vcc, 0, v12
  s_cbranch_vccnz L_cs3_ru
  s_add_u32 s35, s35, 1
  s_add_u32 s58, s58, 4
  v_readfirstlane_b32 s76, v6
  s_cmp_eq_u32 s35, 63
  s_nop 0
  v_add_f32_dpp v40, v40, v40 row_ror:8 row_mask:0xf bank_mask:0xf
  v_add_f32_dpp v41, v41, v41 row_ror:8 row_mask:0xf bank_mask:0xf
  v_add_f32_dpp v42, v42, v42 row_ror:8 row_mask:0xf bank_mask:0xf
  v_add_f32_dpp v43, v43, v43 row_ror:8 row_mask:0xf bank_mask:0xf
  v_add_f32_dpp v40, v40, v40 row_ror:4 row_mask:0xf bank_mask:0xf
  v_add_f32_dpp v41, v41, v41 row_ror:4 row_mask:0xf bank_mask:0xf
  v_add_f32_dpp v42, v42, v42 row_ror:4 row_mask:0xf bank_mask:0xf
  v_add_f32_dpp v43, v43, v43 row_ror:4 row_mask:0xf bank_mask:0xf
  v_cvt_pk_bf16_f32 v12, v40, v41
  v_cvt_pk_bf16_f32 v13, v42, v43
  buffer_store_dwordx2 v[12:13], v5, s[4:7], s49 offen sc1
  s_cbranch_scc1 L_cs3_done
  s_barrier
L_cs3_h2:
  buffer_load_dwordx4 v[40:43], v0, s[4:7], s48 offen offset:0
  v_mov_b64 v[24:25], 0
  v_mov_b64 v[26:27], 0
  v_mov_b64 v[28:29], 0
  v_mov_b64 v[30:31], 0
  s_nop 3
  buffer_load_dwordx4 v[52:55], v0, s[4:7], s48 offen offset:1024
  s_nop 7
  buffer_load_dwordx4 v[72:75], v0, s[4:7], s48 offen offset:2048
  s_nop 7
  buffer_load_dwordx4 v[76:79], v0, s[4:7], s48 offen offset:3072
  s_nop 7
  buffer_load_dwordx4 v[48:51], v0, s[4:7], s74 offen offset:0 sc1
  s_waitcnt vmcnt(4) lgkmcnt(0)
  v_smfmac_f32_16x16x64_bf16 v[16:19], v[40:43], v[56:63], v1
  buffer_load_dwordx4 v[44:47], v0, s[4:7], s75 offen offset:0
  ds_read_b128 v[56:59], v2 offset:32768
  v_max_u32 v11, v40, v42
  v_smfmac_f32_16x16x64_bf16 v[20:23], v[40:43], v[64:71], v1
  ds_read_b128 v[60:63], v2 offset:33792
  v_smfmac_f32_16x16x64_bf16 v[24:27], v[40:43], a[0:7], v1
  ds_read_b128 v[64:67], v2 offset:34816
  v_smfmac_f32_16x16x64_bf16 v[28:31], v[40:43], a[8:15], v1
  ds_read_b128 v[68:71], v2 offset:35840
  s_waitcnt vmcnt(4)
  v_smfmac_f32_16x16x64_bf16 v[16:19], v[52:55], a[32:39], v1
  v_max3_u32 v11, v11, v52, v54
  v_smfmac_f32_16x16x64_bf16 v[20:23], v[52:55], a[40:47], v1
  v_smfmac_f32_16x16x64_bf16 v[24:27], v[52:55], a[48:55], v1
  v_smfmac_f32_16x16x64_bf16 v[28:31], v[52:55], a[56:63], v1
  s_waitcnt vmcnt(3) lgkmcnt(2)
  v_smfmac_f32_16x16x64_bf16 v[16:19], v[72:75], v[56:63], v1
  ds_read_b128 v[56:59], v2 offset:57344
  v_max3_u32 v11, v11, v72, v74
  s_waitcnt lgkmcnt(1)
  v_smfmac_f32_16x16x64_bf16 v[20:23], v[72:75], v[64:71], v1
  ds_read_b128 v[60:63], v2 offset:58368
  buffer_load_dwordx4 v[32:35], v0, s[4:7], s55 offen offset:2048 sc1
  s_cmp_eq_u32 s76, 0
  s_cbranch_scc1 L_cs3_kvwait
L_cs3_kvok:
  v_smfmac_f32_16x16x64_bf16 v[24:27], v[72:75], a[80:87], v1
  ds_read_b128 v[64:67], v2 offset:59392
  v_smfmac_f32_16x16x64_bf16 v[28:31], v[72:75], a[88:95], v1
  ds_read_b128 v[68:71], v2 offset:60416
  s_waitcnt vmcnt(3)
  v_smfmac_f32_16x16x64_bf16 v[16:19], v[76:79], a[112:119], v1
  v_max3_u32 v11, v11, v76, v78
  v_smfmac_f32_16x16x64_bf16 v[20:23], v[76:79], a[120:127], v1
  ds_write_b128 v0, v[76:79] offset:3072
  v_smfmac_f32_16x16x64_bf16 v[24:27], v[76:79], a[128:135], v1
  v_smfmac_f32_16x16x64_bf16 v[28:31], v[76:79], a[136:143], v1
  s_waitcnt vmcnt(2)
  ds_write_b128 v0, v[48:51] offset:7168
  buffer_load_dwordx4 v[72:75], v0, s[4:7], s55 offen offset:0 sc1
  s_waitcnt vmcnt(2) lgkmcnt(4)
  v_smfmac_f32_16x16x64_bf16 v[16:19], v[44:47], v[56:63], v1
  ds_read_b128 v[56:59], v2 offset:49152
  v_max3_u32 v11, v11, v44, v46
  s_waitcnt lgkmcnt(3)
  v_smfmac_f32_16x16x64_bf16 v[20:23], v[44:47], v[64:71], v1
  ds_read_b128 v[60:63], v2 offset:50176
  v_max3_u32 v11, v11, v48, v50
  v_smfmac_f32_16x16x64_bf16 v[24:27], v[44:47], v[144:151], v1
  ds_read_b128 v[64:67], v2 offset:51200
  v_cmp_eq_u32 vcc, -1, v11
  v_smfmac_f32_16x16x64_bf16 v[28:31], v[44:47], v[152:159], v1
  ds_read_b128 v[68:71], v2 offset:52224
  buffer_load_dwordx4 v[76:79], v0, s[4:7], s55 offen offset:1024 sc1
  v_lshlrev_b32 v6, 3, v0
  v_smfmac_f32_16x16x64_bf16 v[24:27], v[48:51], v[112:119], v1
  s_cbranch_vccnz L_cs3_h2q
  v_smfmac_f32_16x16x64_bf16 v[28:31], v[48:51], v[120:127], v1
  s_waitcnt lgkmcnt(4)
  s_barrier
  ds_read_b128 v[40:43], v0 offset:6144
  v_smfmac_f32_16x16x64_bf16 v[16:19], v[48:51], v[96:103], v1
  ds_read_b128 v[52:55], v0 offset:5120
  v_smfmac_f32_16x16x64_bf16 v[20:23], v[48:51], v[104:111], v1
  buffer_load_dwordx4 v[36:39], v0, s[4:7], s55 offen offset:3072 sc1
  s_waitcnt lgkmcnt(1)
  v_smfmac_f32_16x16x64_bf16 v[16:19], v[40:43], v[56:63], v1
  ds_read_b128 v[48:51], v0 offset:4096
  ds_read_b128 v[56:59], v2 offset:40960
  s_add_u32 s55, s55, s56
  v_smfmac_f32_16x16x64_bf16 v[20:23], v[40:43], v[64:71], v1
  ds_read_b128 v[60:63], v2 offset:41984
  ds_read_b128 v[64:67], v2 offset:43008
  s_mov_b32 exec_hi, 0
  buffer_load_dword v6, v6, s[4:7], s55 offen sc1
  s_mov_b32 exec_hi, -1
  v_smfmac_f32_16x16x64_bf16 v[24:27], v[40:43], a[240:247], v1
  ds_read_b128 v[68:71], v2 offset:44032
  buffer_load_dword v6, off, s[4:7], s58 offset:4 sc1
  v_smfmac_f32_16x16x64_bf16 v[28:31], v[40:43], a[248:255], v1
  s_waitcnt lgkmcnt(5)
  v_smfmac_f32_16x16x64_bf16 v[16:19], v[52:55], a[192:199], v1
  v_smfmac_f32_16x16x64_bf16 v[20:23], v[52:55], a[200:207], v1
  s_waitcnt lgkmcnt(2)
  v_smfmac_f32_16x16x64_bf16 v[16:19], v[48:51], v[56:63], v1
  s_waitcnt lgkmcnt(0)
  v_smfmac_f32_16x16x64_bf16 v[20:23], v[48:51], v[64:71], v1
  ds_read_b128 v[64:67], v0 offset:15360
  v_smfmac_f32_16x16x64_bf16 v[24:27], v[52:55], a[208:215], v1
  ds_read_b128 v[68:71], v0 offset:15360
  v_add_f32 v16, v16, v18
  v_smfmac_f32_16x16x64_bf16 v[24:27], v[48:51], a[160:167], v1
  s_nop 0
  s_nop 0
  v_add_f32 v17, v17, v19
  v_smfmac_f32_16x16x64_bf16 v[28:31], v[52:55], a[216:223], v1
  s_mov_b64 vcc, s[72:73]
  v_cvt_pk_bf16_f32 v57, v16, v17
  v_smfmac_f32_16x16x64_bf16 v[28:31], v[48:51], a[168:175], v1
  v_add_f32 v24, v24, v26
  v_add_f32 v25, v25, v27
  v_cvt_pk_bf16_f32 v56, v24, v25
  ds_write_b64 v7, v[56:57] offset:11264
  v_pk_add_f32 v[20:21], v[20:21], v[22:23]
  s_nop 0
  v_pk_add_f32 v[28:29], v[28:29], v[30:31]
  v_cvt_pk_bf16_f32 v59, v20, v21
  v_cvt_pk_bf16_f32 v58, v28, v29
  ds_write_b64 v7, v[58:59] offset:11776
  ds_read_b64_tr_b16 v[60:61], v8 offset:11264
  ds_read_b64_tr_b16 v[62:63], v8 offset:11776
  s_waitcnt lgkmcnt(5)
  v_smfmac_f32_16x16x64_bf16 v[64:67], v[44:47], v[160:167], v1
  s_waitcnt lgkmcnt(4)
  v_smfmac_f32_16x16x64_bf16 v[68:71], v[44:47], v[168:175], v1
  ds_read_b128 v[44:47], v0 offset:0
  v_lshrrev_b32 v59, 2, v0
  v_smfmac_f32_16x16x64_bf16 v[64:67], v[40:43], v[80:87], v1
  v_mov_b32 v31, 0x3f803f80
  v_smfmac_f32_16x16x64_bf16 v[68:71], v[40:43], v[88:95], v1
  buffer_store_dwordx2 v[12:13], v5, s[4:7], s57 offen sc1
  ds_read_b128 v[40:43], v0 offset:1024
  v_smfmac_f32_16x16x64_bf16 v[64:67], v[52:55], a[224:231], v1
  s_waitcnt vmcnt(5) lgkmcnt(2)
  v_mfma_f32_16x16x32_bf16 v[16:19], v[72:75], v[60:63], 0
  v_mov_b32 v30, 0x3f803f80
  s_waitcnt vmcnt(4)
  v_mfma_f32_16x16x32_bf16 v[20:23], v[76:79], v[60:63], 0
  v_mov_b32 v29, 0x3f803f80
  v_mfma_f32_16x16x32_bf16 v[24:27], v[60:63], v[60:63], 0
  v_mov_b32 v28, 0x3f803f80
  v_smfmac_f32_16x16x64_bf16 v[68:71], v[52:55], a[232:239], v1
  ds_read_b128 v[52:55], v0 offset:2048
  v_cndmask_b32_dpp v16, v20, v16, vcc quad_perm:[2,3,0,1] row_mask:0xf bank_mask:0xf
  v_cndmask_b32_dpp v17, v21, v17, vcc quad_perm:[2,3,0,1] row_mask:0xf bank_mask:0xf
  v_cndmask_b32_dpp v18, v22, v18, vcc quad_perm:[2,3,0,1] row_mask:0xf bank_mask:0xf
  v_cndmask_b32_dpp v19, v23, v19, vcc quad_perm:[2,3,0,1] row_mask:0xf bank_mask:0xf
  v_cndmask_b32_dpp v24, v25, v24, vcc quad_perm:[2,3,0,1] row_mask:0xf bank_mask:0xf
  v_smfmac_f32_16x16x64_bf16 v[64:67], v[48:51], a[176:183], v1
  ds_write_b128 v0, v[16:19] offset:11264
  ds_write_b32 v59, v24 offset:13056
  v_smfmac_f32_16x16x64_bf16 v[68:71], v[48:51], a[184:191], v1
  ds_read_b128 v[48:51], v0 offset:3072
  s_waitcnt lgkmcnt(5)
  v_smfmac_f32_16x16x64_bf16 v[64:67], v[44:47], a[16:23], v1
  v_smfmac_f32_16x16x64_bf16 v[68:71], v[44:47], a[24:31], v1
  ds_read_b128 v[44:47], v0 offset:7168
  s_waitcnt lgkmcnt(5)
  v_smfmac_f32_16x16x64_bf16 v[64:67], v[40:43], a[64:71], v1
  v_smfmac_f32_16x16x64_bf16 v[68:71], v[40:43], a[72:79], v1
  s_waitcnt lgkmcnt(2)
  s_barrier
  ds_read_b128 v[20:23], v0 offset:10240
  ds_read_b128 v[72:75], v0 offset:9216
  v_smfmac_f32_16x16x64_bf16 v[64:67], v[52:55], a[96:103], v1
  ds_read_b128 v[76:79], v0 offset:8192
  v_smfmac_f32_16x16x64_bf16 v[68:71], v[52:55], a[104:111], v1
  ds_read2st64_b32 v[26:27], v59 offset0:50 offset1:49
  s_waitcnt lgkmcnt(5)
  v_smfmac_f32_16x16x64_bf16 v[64:67], v[48:51], a[144:151], v1
  ds_read_b32 v25, v59 offset:12288
  v_smfmac_f32_16x16x64_bf16 v[68:71], v[48:51], a[152:159], v1
  ds_read_b128 v[60:63], v2 offset:1024
  s_waitcnt lgkmcnt(6)
  v_smfmac_f32_16x16x64_bf16 v[64:67], v[44:47], v[128:135], v1
  ds_read_b128 v[56:59], v2 offset:0
  v_smfmac_f32_16x16x64_bf16 v[68:71], v[44:47], v[136:143], v1
  ds_read_b128 v[40:43], v2 offset:8192
  s_waitcnt lgkmcnt(7)
  v_add_f32 v16, v16, v20
  v_add_f32 v17, v17, v21
  v_add_f32 v18, v18, v22
  v_add_f32 v19, v19, v23
  s_waitcnt lgkmcnt(5)
  v_pk_add_f32 v[72:73], v[72:73], v[76:77]
  v_pk_add_f32 v[74:75], v[74:75], v[78:79]
  s_waitcnt lgkmcnt(3)
  v_pk_add_f32 v[24:25], v[24:25], v[26:27]
  v_pk_add_f32 v[16:17], v[16:17], v[72:73]
  v_pk_add_f32 v[18:19], v[18:19], v[74:75]
  v_add_f32 v24, v24, v25
  v_max3_f32 v72, v16, v17, v18
  v_max3_f32 v72, v72, v19, v24
  v_pk_add_f32 v[64:65], v[64:65], v[66:67]
  v_pk_add_f32 v[68:69], v[68:69], v[70:71]
  v_max_f32_dpp v72, v72, v72 quad_perm:[2,3,0,1] row_mask:0xf bank_mask:0xf
  v_mov_b32 v73, v72
  v_cvt_pk_bf16_f32 v70, v64, v65
  v_cvt_pk_bf16_f32 v71, v68, v69
  v_permlane16_swap_b32 v73, v72
  v_max_f32 v72, v72, v73
  v_mov_b32 v73, v72
  v_mov_b32 v27, 0
  v_mov_b32 v68, 0
  v_permlane32_swap_b32 v73, v72
  v_max_f32 v72, v72, v73
  v_mul_f32 v72, s70, v72
  v_fma_f32 v16, v16, s70, -v72
  v_fma_f32 v17, v17, s70, -v72
  v_fma_f32 v18, v18, s70, -v72
  v_fma_f32 v19, v19, s70, -v72
  v_fma_f32 v24, v24, s70, -v72
  v_exp_f32 v16, v16
  v_exp_f32 v17, v17
  v_exp_f32 v18, v18
  v_exp_f32 v19, v19
  v_cvt_pk_bf16_f32 v20, v16, v17
  v_cvt_pk_bf16_f32 v21, v18, v19
  v_exp_f32 v24, v24
  v_mov_b32_dpp v22, v20 quad_perm:[2,3,0,1] row_mask:0xf bank_mask:0xf
  v_mov_b32_dpp v23, v21 quad_perm:[2,3,0,1] row_mask:0xf bank_mask:0xf
  v_mov_b32_dpp v25, v24 quad_perm:[2,3,0,1] row_mask:0xf bank_mask:0xf
  v_cvt_pk_bf16_f32 v26, v24, v25
  v_mfma_f32_16x16x32_bf16 v[16:19], v[28:31], v[20:23], 0
  ds_read_b128 v[48:51], v2 offset:10240
  v_mov_b32 v69, v26
  v_mfma_f32_16x16x32_bf16 v[72:75], v[32:35], v[20:23], 0
  ds_read_b128 v[52:55], v2 offset:11264
  v_mov_b64 v[32:33], 0
  v_mfma_f32_16x16x16_bf16 v[16:19], v[28:29], v[26:27], v[16:19]
  ds_read_b128 v[44:47], v2 offset:9216
  v_mov_b64 v[34:35], 0
  s_waitcnt vmcnt(3)
  v_mfma_f32_16x16x32_bf16 v[76:79], v[36:39], v[20:23], 0
  ds_read_b128 v[64:67], v2 offset:2048
  v_mfma_f32_16x16x16_bf16 v[72:75], v[70:71], v[26:27], v[72:75]
  v_rcp_f32 v24, v16
  v_mfma_f32_16x16x16_bf16 v[76:79], v[70:71], v[68:69], v[76:79]
  ds_read_b128 v[68:71], v2 offset:3072
  s_mov_b64 exec, s[72:73]
  s_nop 1
  v_pk_mul_f32 v[72:73], v[72:73], v[24:25] op_sel_hi:[1,0]
  v_pk_mul_f32 v[74:75], v[74:75], v[24:25] op_sel_hi:[1,0]
  v_cvt_pk_bf16_f32 v36, v72, v73
  v_cvt_pk_bf16_f32 v37, v74, v75
  v_pk_mul_f32 v[76:77], v[76:77], v[24:25] op_sel_hi:[1,0]
  v_pk_mul_f32 v[78:79], v[78:79], v[24:25] op_sel_hi:[1,0]
  v_cvt_pk_bf16_f32 v38, v76, v77
  v_cvt_pk_bf16_f32 v39, v78, v79
  ds_write_b128 v9, v[36:39] offset:14848
  s_mov_b64 exec, -1
  v_mfma_f32_16x16x16_bf16 v[16:19], v[32:33], v[32:33], 0
  v_mfma_f32_16x16x16_bf16 v[20:23], v[32:33], v[32:33], 0
  v_mfma_f32_16x16x16_bf16 v[24:27], v[32:33], v[32:33], 0
  v_mfma_f32_16x16x16_bf16 v[28:31], v[32:33], v[32:33], 0
  s_waitcnt lgkmcnt(0)
  s_barrier
  ds_read_b128 v[72:75], v0 offset:13312
  ds_read_b128 v[76:79], v0 offset:14336
  s_waitcnt lgkmcnt(1)
  v_smfmac_f32_16x16x64_bf16 v[16:19], v[72:75], v[56:63], v1
  v_mov_b64 v[56:57], 0
  v_smfmac_f32_16x16x64_bf16 v[20:23], v[72:75], v[64:71], v1
  v_mov_b64 v[58:59], 0
  s_waitcnt lgkmcnt(0)
  v_smfmac_f32_16x16x64_bf16 v[16:19], v[76:79], v[40:47], v1
  ds_read_b128 v[40:43], v2 offset:61440
  v_mov_b64 v[60:61], 0
  v_smfmac_f32_16x16x64_bf16 v[20:23], v[76:79], v[48:55], v1
  ds_read_b128 v[44:47], v2 offset:62464
  ds_read_b128 v[48:51], v2 offset:63488
  v_mov_b64 v[62:63], 0
  v_smfmac_f32_16x16x64_bf16 v[24:27], v[72:75], v[176:183], v1
  ds_read_b128 v[52:55], v2 offset:64512
  v_add_f32 v16, v16, v18
  v_add_f32 v17, v17, v19
  v_smfmac_f32_16x16x64_bf16 v[28:31], v[72:75], v[184:191], v1
  ds_read_b128 v[64:67], v0 offset:15360
  v_cvt_pk_bf16_f32 v38, v16, v17
  v_bfi_b32 v38, v10, s35, v38
  v_smfmac_f32_16x16x64_bf16 v[24:27], v[76:79], v[192:199], v1
  ds_read_b128 v[68:71], v0 offset:15360
  v_add_f32 v20, v20, v22
  v_add_f32 v21, v21, v23
  v_smfmac_f32_16x16x64_bf16 v[28:31], v[76:79], v[200:207], v1
  v_cvt_pk_bf16_f32 v39, v20, v21
  s_waitcnt lgkmcnt(4)
  v_smfmac_f32_16x16x64_bf16 v[32:35], v[72:75], v[40:47], v1
  ds_read_b128 v[40:43], v2 offset:16384
  buffer_store_dwordx2 v[38:39], v3, s[4:7], s40 offen sc1
  v_add_f32 v24, v24, v26
  v_add_f32 v25, v25, v27
  s_waitcnt lgkmcnt(3)
  v_smfmac_f32_16x16x64_bf16 v[32:35], v[76:79], v[48:55], v1
  ds_read_b128 v[44:47], v2 offset:17408
  v_cvt_pk_bf16_f32 v36, v24, v25
  v_bfi_b32 v36, v10, s35, v36
  v_smfmac_f32_16x16x64_bf16 v[56:59], v[72:75], v[208:215], v1
  ds_read_b128 v[48:51], v2 offset:18432
  v_add_f32 v28, v28, v30
  v_add_f32 v29, v29, v31
  v_smfmac_f32_16x16x64_bf16 v[60:63], v[72:75], v[216:223], v1
  ds_read_b128 v[52:55], v2 offset:19456
  v_cvt_pk_bf16_f32 v37, v28, v29
  v_add_f32 v32, v32, v34
  v_smfmac_f32_16x16x64_bf16 v[56:59], v[76:79], v[224:231], v1
  buffer_store_dwordx2 v[36:37], v3, s[4:7], s41 offen sc1
  v_add_f32 v33, v33, v35
  v_cvt_pk_bf16_f32 v34, v32, v33
  v_smfmac_f32_16x16x64_bf16 v[60:63], v[76:79], v[232:239], v1
  v_bfi_b32 v34, v10, s35, v34
  s_waitcnt lgkmcnt(5)
  v_smfmac_f32_16x16x64_bf16 v[64:67], v[72:75], v[240:247], v1
  buffer_store_dword v34, v4, s[4:7], s40 offen sc1
  v_add_f32 v56, v56, v58
  v_add_f32 v57, v57, v59
  s_waitcnt lgkmcnt(4)
  v_smfmac_f32_16x16x64_bf16 v[68:71], v[72:75], v[248:255], v1
  v_cvt_pk_bf16_f32 v38, v56, v57
  v_bfi_b32 v38, v10, s35, v38
  s_waitcnt lgkmcnt(2)
  v_smfmac_f32_16x16x64_bf16 v[64:67], v[76:79], v[40:47], v1
  v_add_f32 v60, v60, v62
  s_waitcnt lgkmcnt(0)
  v_smfmac_f32_16x16x64_bf16 v[68:71], v[76:79], v[48:55], v1
  v_add_f32 v61, v61, v63
  v_cvt_pk_bf16_f32 v39, v60, v61
  buffer_store_dwordx2 v[38:39], v3, s[4:7], s42 offen sc1
  v_pk_add_f32 v[64:65], v[64:65], v[66:67]
  v_cvt_pk_bf16_f32 v36, v64, v65
  v_bfi_b32 v36, v10, s35, v36
  v_pk_add_f32 v[68:69], v[68:69], v[70:71]
  v_cvt_pk_bf16_f32 v37, v68, v69
  buffer_store_dwordx2 v[36:37], v3, s[4:7], s43 offen sc1
  v_mov_b32 v40, 0x3f80
  v_cndmask_b32 v40, v40, 1.0, s[60:61]
  v_cndmask_b32 v46, 0, v40, s[66:67]
  v_cndmask_b32 v47, 0, v40, s[68:69]
  v_cndmask_b32 v44, 0, v40, s[62:63]
  v_cndmask_b32 v45, 0, v40, s[64:65]
  ds_read_b128 v[56:59], v2 offset:24576
  ds_read_b128 v[60:63], v2 offset:25600
  ds_read_b128 v[64:67], v2 offset:26624
  ds_read_b128 v[68:71], v2 offset:27648
  v_mov_b64 v[16:17], 0
  v_mov_b64 v[18:19], 0
  v_mov_b64 v[20:21], 0
  v_mov_b64 v[22:23], 0
  s_add_u32 s57, s57, s77
  s_add_u32 s48, s48, 9216
  s_add_u32 s49, s53, s48
  s_add_u32 s74, s74, 9216
  s_add_u32 s75, s75, 9216
  s_mov_b32 s77, 9216
  s_nop 15
  s_nop 15
  s_nop 15
  s_nop 7
  buffer_load_dwordx4 v[24:27], v0, s[4:7], s44 offen sc1
  buffer_load_dwordx4 v[28:31], v0, s[4:7], s44 offen offset:1024 sc1
  s_branch L_cs3_top
L_cs3_h2q:
L_cs3_h2r:
  buffer_load_dwordx4 v[40:43], v0, s[4:7], s48 offen offset:0 sc1
  buffer_load_dwordx4 v[52:55], v0, s[4:7], s48 offen offset:1024 sc1
  buffer_load_dwordx4 v[72:75], v0, s[4:7], s48 offen offset:2048 sc1
  buffer_load_dwordx4 v[76:79], v0, s[4:7], s48 offen offset:3072 sc1
  buffer_load_dwordx4 v[44:47], v0, s[4:7], s75 offen offset:0 sc1
  s_nop 3
L_cs3_entry:
  ds_read_b128 v[56:59], v2 offset:24576
  ds_read_b128 v[60:63], v2 offset:25600
  ds_read_b128 v[64:67], v2 offset:26624
  ds_read_b128 v[68:71], v2 offset:27648
  s_sub_u32 s31, s31, 1
  s_cbranch_scc1 L_exit
  v_mov_b64 v[16:17], 0
  v_mov_b64 v[18:19], 0
  v_mov_b64 v[20:21], 0
  v_mov_b64 v[22:23], 0
  v_mov_b64 v[24:25], 0
  v_mov_b64 v[26:27], 0
  v_mov_b64 v[28:29], 0
  v_mov_b64 v[30:31], 0
  s_branch L_cs3_h2
L_cs3_ru:
  buffer_load_dwordx4 v[24:27], v0, s[4:7], s44 offen sc1
  buffer_load_dwordx4 v[28:31], v0, s[4:7], s44 offen offset:1024 sc1
  s_sub_u32 s31, s31, 1
  s_cbranch_scc1 L_exit
  s_waitcnt vmcnt(0)
  s_branch L_cs3_h1m
L_cs3_kvwait:
  buffer_load_dword v6, off, s[4:7], s58 sc1
  s_sub_u32 s31, s31, 1
  s_cbranch_scc1 L_exit
  s_waitcnt vmcnt(0)
  v_cmp_eq_u32 vcc, 0, v6
  s_cbranch_vccnz L_cs3_kvwait
  s_branch L_cs3_kvok
L_cs3_done:
  buffer_store_dwordx2 v[12:13], v5, s[4:7], s57 offen sc1
  s_branch L_exit
.p2align 6
L_init:
  s_sub_u32 s34, s28, 5
  s_lshl_b32 s34, s34, 1
  s_add_u32 s34, s34, s29
  s_sub_u32 s34, s34, 30
  s_lshl_b32 s34, s34, 2
  s_add_u32 s34, s34, s30
  v_lshlrev_b32 v1, 4, v0
  v_mov_b64 v[4:5], -1
  v_mov_b64 v[6:7], -1
  v_mov_b64 v[8:9], 0
  v_mov_b64 v[10:11], 0
  s_lshl_b32 s35, s34, 10
  s_add_u32 s35, s35, 393216
  s_cmp_lt_u32 s34, 9
  s_cbranch_scc0 L_init2
  buffer_store_dwordx4 v[8:11], v1, s[4:7], s35 offen sc1
L_init2:
  s_mov_b32 s12, s66
  s_mov_b32 s13, s67
  s_mov_b32 s14, 0x2400
  s_mov_b32 s15, 0x20000
  s_lshl_b32 s38, s34, 10
  s_add_u32 s38, s38, 3145728
  s_sub_u32 s37, s34, 9
  s_lshl_b32 s39, s37, 10
  s_add_u32 s39, s39, 2097152
  s_cmp_lt_u32 s34, 9
  s_cselect_b32 s36, s34, s37
  s_cselect_b32 s38, s38, s39
  s_lshl_b32 s36, s36, 7
  v_bfe_u32 v12, v0, 2, 2
  v_and_b32 v13, 1, v0
  v_lshl_add_u32 v12, v12, 1, v13
  v_mul_u32_u24 v12, 1152, v12
  v_lshrrev_b32 v13, 4, v0
  v_lshl_add_u32 v12, v13, 5, v12
  v_and_b32 v13, 2, v0
  v_lshl_add_u32 v12, v13, 1, v12
  buffer_load_dword v16, v12, s[12:15], s36 offen offset:0
  buffer_load_dword v17, v12, s[12:15], s36 offen offset:8
  buffer_load_dword v18, v12, s[12:15], s36 offen offset:16
  buffer_load_dword v19, v12, s[12:15], s36 offen offset:24
  s_mul_i32 s35, s34, 12288
  s_add_u32 s35, s35, 0
  buffer_store_dwordx4 v[4:7], v1, s[4:7], s35 offen offset:0 sc1
  buffer_store_dwordx4 v[4:7], v1, s[4:7], s35 offen offset:1024 sc1
  buffer_store_dwordx4 v[4:7], v1, s[4:7], s35 offen offset:2048 sc1
  buffer_store_dwordx4 v[4:7], v1, s[4:7], s35 offen offset:3072 sc1
  s_add_u32 s35, s35, 4096
  buffer_store_dwordx4 v[4:7], v1, s[4:7], s35 offen offset:0 sc1
  buffer_store_dwordx4 v[4:7], v1, s[4:7], s35 offen offset:1024 sc1
  buffer_store_dwordx4 v[4:7], v1, s[4:7], s35 offen offset:2048 sc1
  buffer_store_dwordx4 v[4:7], v1, s[4:7], s35 offen offset:3072 sc1
  s_add_u32 s35, s35, 4096
  buffer_store_dwordx4 v[4:7], v1, s[4:7], s35 offen offset:0 sc1
  buffer_store_dwordx4 v[4:7], v1, s[4:7], s35 offen offset:1024 sc1
  buffer_store_dwordx4 v[4:7], v1, s[4:7], s35 offen offset:2048 sc1
  buffer_store_dwordx4 v[4:7], v1, s[4:7], s35 offen offset:3072 sc1
  s_mul_i32 s35, s34, 1024
  s_add_u32 s35, s35, 360448
  buffer_store_dwordx4 v[4:7], v1, s[4:7], s35 offen offset:0 sc1
  s_mul_i32 s35, s34, 24576
  s_add_u32 s35, s35, 3154944
  buffer_store_dwordx4 v[4:7], v1, s[4:7], s35 offen offset:0 sc1
  buffer_store_dwordx4 v[4:7], v1, s[4:7], s35 offen offset:1024 sc1
  buffer_store_dwordx4 v[4:7], v1, s[4:7], s35 offen offset:2048 sc1
  buffer_store_dwordx4 v[4:7], v1, s[4:7], s35 offen offset:3072 sc1
  s_add_u32 s35, s35, 4096
  buffer_store_dwordx4 v[4:7], v1, s[4:7], s35 offen offset:0 sc1
  buffer_store_dwordx4 v[4:7], v1, s[4:7], s35 offen offset:1024 sc1
  buffer_store_dwordx4 v[4:7], v1, s[4:7], s35 offen offset:2048 sc1
  buffer_store_dwordx4 v[4:7], v1, s[4:7], s35 offen offset:3072 sc1
  s_add_u32 s35, s35, 4096
  buffer_store_dwordx4 v[4:7], v1, s[4:7], s35 offen offset:0 sc1
  buffer_store_dwordx4 v[4:7], v1, s[4:7], s35 offen offset:1024 sc1
  buffer_store_dwordx4 v[4:7], v1, s[4:7], s35 offen offset:2048 sc1
  buffer_store_dwordx4 v[4:7], v1, s[4:7], s35 offen offset:3072 sc1
  s_add_u32 s35, s35, 4096
  buffer_store_dwordx4 v[4:7], v1, s[4:7], s35 offen offset:0 sc1
  buffer_store_dwordx4 v[4:7], v1, s[4:7], s35 offen offset:1024 sc1
  buffer_store_dwordx4 v[4:7], v1, s[4:7], s35 offen offset:2048 sc1
  buffer_store_dwordx4 v[4:7], v1, s[4:7], s35 offen offset:3072 sc1
  s_add_u32 s35, s35, 4096
  buffer_store_dwordx4 v[4:7], v1, s[4:7], s35 offen offset:0 sc1
  buffer_store_dwordx4 v[4:7], v1, s[4:7], s35 offen offset:1024 sc1
  buffer_store_dwordx4 v[4:7], v1, s[4:7], s35 offen offset:2048 sc1
  buffer_store_dwordx4 v[4:7], v1, s[4:7], s35 offen offset:3072 sc1
  s_add_u32 s35, s35, 4096
  buffer_store_dwordx4 v[4:7], v1, s[4:7], s35 offen offset:0 sc1
  buffer_store_dwordx4 v[4:7], v1, s[4:7], s35 offen offset:1024 sc1
  buffer_store_dwordx4 v[4:7], v1, s[4:7], s35 offen offset:2048 sc1
  buffer_store_dwordx4 v[4:7], v1, s[4:7], s35 offen offset:3072 sc1
  s_mul_i32 s35, s34, 24576
  s_add_u32 s35, s35, 2106368
  buffer_store_dwordx4 v[4:7], v1, s[4:7], s35 offen offset:0 sc1
  buffer_store_dwordx4 v[4:7], v1, s[4:7], s35 offen offset:1024 sc1
  buffer_store_dwordx4 v[4:7], v1, s[4:7], s35 offen offset:2048 sc1
  buffer_store_dwordx4 v[4:7], v1, s[4:7], s35 offen offset:3072 sc1
  s_add_u32 s35, s35, 4096
  buffer_store_dwordx4 v[4:7], v1, s[4:7], s35 offen offset:0 sc1
  buffer_store_dwordx4 v[4:7], v1, s[4:7], s35 offen offset:1024 sc1
  buffer_store_dwordx4 v[4:7], v1, s[4:7], s35 offen offset:2048 sc1
  buffer_store_dwordx4 v[4:7], v1, s[4:7], s35 offen offset:3072 sc1
  s_add_u32 s35, s35, 4096
  buffer_store_dwordx4 v[4:7], v1, s[4:7], s35 offen offset:0 sc1
  buffer_store_dwordx4 v[4:7], v1, s[4:7], s35 offen offset:1024 sc1
  buffer_store_dwordx4 v[4:7], v1, s[4:7], s35 offen offset:2048 sc1
  buffer_store_dwordx4 v[4:7], v1, s[4:7], s35 offen offset:3072 sc1
  s_add_u32 s35, s35, 4096
  buffer_store_dwordx4 v[4:7], v1, s[4:7], s35 offen offset:0 sc1
  buffer_store_dwordx4 v[4:7], v1, s[4:7], s35 offen offset:1024 sc1
  buffer_store_dwordx4 v[4:7], v1, s[4:7], s35 offen offset:2048 sc1
  buffer_store_dwordx4 v[4:7], v1, s[4:7], s35 offen offset:3072 sc1
  s_add_u32 s35, s35, 4096
  buffer_store_dwordx4 v[4:7], v1, s[4:7], s35 offen offset:0 sc1
  buffer_store_dwordx4 v[4:7], v1, s[4:7], s35 offen offset:1024 sc1
  buffer_store_dwordx4 v[4:7], v1, s[4:7], s35 offen offset:2048 sc1
  buffer_store_dwordx4 v[4:7], v1, s[4:7], s35 offen offset:3072 sc1
  s_add_u32 s35, s35, 4096
  buffer_store_dwordx4 v[4:7], v1, s[4:7], s35 offen offset:0 sc1
  buffer_store_dwordx4 v[4:7], v1, s[4:7], s35 offen offset:1024 sc1
  buffer_store_dwordx4 v[4:7], v1, s[4:7], s35 offen offset:2048 sc1
  buffer_store_dwordx4 v[4:7], v1, s[4:7], s35 offen offset:3072 sc1
  s_waitcnt vmcnt(63)
  v_min_u32 v16, -2, v16
  v_min_u32 v17, -2, v17
  s_waitcnt vmcnt(62)
  v_min_u32 v18, -2, v18
  s_waitcnt vmcnt(61)
  v_min_u32 v19, -2, v19
  s_cmp_lt_u32 s34, 18
  s_cbranch_scc0 L_init3
  buffer_store_dwordx4 v[16:19], v1, s[4:7], s38 offen sc1
L_init3:
  s_lshl_b32 s33, s30, 6
  v_or_b32 v2, s33, v0
  v_min_u32 v2, 1, v2
  v_lshlrev_b32 v2, 30, v2
  s_waitcnt vmcnt(0)
  s_barrier
  v_mov_b32 v3, 1
  buffer_atomic_add v3, v2, s[8:11], 0 offen offset:64
  s_branch L_exit
.p2align 6
L_pa:
  s_mov_b32 s12, s68
  s_mov_b32 s13, s69
  s_mov_b32 s14, 0x480000
  s_mov_b32 s15, 0x20000
  s_mov_b32 s16, s70
  s_mov_b32 s17, s71
  s_mov_b32 s18, 0x480000
  s_mov_b32 s19, 0x20000
  s_mov_b32 s20, s72
  s_mov_b32 s21, s73
  s_mov_b32 s22, 0x480000
  s_mov_b32 s23, 0x20000
  s_mov_b32 s24, s64
  s_mov_b32 s25, s65
  s_mov_b32 s26, 0x240000
  s_mov_b32 s27, 0x20000
  v_mov_b32 v79, v0
  v_and_b32 v78, 15, v79
  v_lshrrev_b32 v77, 4, v79
  s_sub_u32 s37, s28, 1
  s_lshl_b32 s37, s37, 5
  s_add_u32 s37, s37, s29
  s_lshr_b32 s34, s37, 2
  s_and_b32 s35, s37, 3
  v_lshlrev_b32 v0, 4, v79
  v_lshlrev_b32 v7, 3, v79
  v_add_u32 v7, 122880, v7
  v_mul_u32_u24 v2, 1152, v78
  v_lshl_add_u32 v2, v77, 4, v2
  s_lshr_b32 s37, s30, 1
  s_mul_i32 s37, s37, 18432
  s_and_b32 s33, s30, 1
  s_mul_i32 s33, s33, 576
  s_add_u32 s37, s37, s33
  v_add_u32 v2, s37, v2
  v_lshlrev_b32 v76, 5, v78
  v_lshl_add_u32 v76, v77, 3, v76
  s_lshl_b32 s37, s30, 10
  s_add_u32 s37, s37, 122880
  v_add_u32 v6, s37, v76
  s_and_b32 s37, s30, 1
  s_lshl_b32 s37, s37, 4
  v_lshlrev_b32 v76, 2, v77
  v_sub_u32 v8, v78, v76
  v_add_u32 v8, s37, v8
  s_mov_b32 s48, 0x3e0293ee
  s_mov_b32 s39, s35
  s_mov_b32 s40, 0
  v_mov_b32 v1, 0x4444
  v_mov_b32 v76, 0xeeee
  v_and_b32 v75, 2, v79
  v_cmp_ne_u32 vcc, 0, v75
  s_nop 1
  v_cndmask_b32 v1, v1, v76, vcc
  s_lshl_b32 s33, s30, 6
  v_or_b32 v9, s33, v79
  v_min_u32 v9, 1, v9
  v_lshlrev_b32 v9, 30, v9
  s_mul_i32 s37, s39, 36864
  s_mul_i32 s33, s30, 9216
  s_add_u32 s33, s33, s40
  s_add_u32 m0, s33, 0
  s_nop 0
  buffer_load_dwordx4 v2, s[24:27], s37 offen lds
  s_add_u32 s37, s37, 64
  s_add_u32 m0, s33, 1024
  s_nop 0
  buffer_load_dwordx4 v2, s[24:27], s37 offen lds
  s_add_u32 s37, s37, 64
  s_add_u32 m0, s33, 2048
  s_nop 0
  buffer_load_dwordx4 v2, s[24:27], s37 offen lds
  s_add_u32 s37, s37, 64
  s_add_u32 m0, s33, 3072
  s_nop 0
  buffer_load_dwordx4 v2, s[24:27], s37 offen lds
  s_add_u32 s37, s37, 64
  s_add_u32 m0, s33, 4096
  s_nop 0
  buffer_load_dwordx4 v2, s[24:27], s37 offen lds
  s_add_u32 s37, s37, 64
  s_add_u32 m0, s33, 5120
  s_nop 0
  buffer_load_dwordx4 v2, s[24:27], s37 offen lds
  s_add_u32 s37, s37, 64
  s_add_u32 m0, s33, 6144
  s_nop 0
  buffer_load_dwordx4 v2, s[24:27], s37 offen lds
  s_add_u32 s37, s37, 64
  s_add_u32 m0, s33, 7168
  s_nop 0
  buffer_load_dwordx4 v2, s[24:27], s37 offen lds
  s_add_u32 s37, s37, 64
  s_add_u32 m0, s33, 8192
  s_nop 0
  buffer_load_dwordx4 v2, s[24:27], s37 offen lds
  s_add_u32 s39, s39, 4
  s_min_u32 s39, s39, 63
  s_xor_b32 s40, s40, 36864
  s_lshr_b32 s37, s30, 1
  s_mul_i32 s43, s37, 57344
  s_add_u32 s43, s43, 49152
  s_and_b32 s33, s30, 1
  s_lshl_b32 s36, s33, 12
  s_add_u32 s36, s36, s43
  s_lshl_b32 s33, s33, 5
  v_lshrrev_b32 v43, 3, v79
  v_add_u32 v43, s33, v43
  s_lshl_b32 s44, s34, 8
  v_bfe_u32 v76, v79, 4, 1
  v_lshlrev_b32 v76, 1, v76
  v_and_b32 v75, 7, v79
  v_xor_b32 v76, v76, v75
  v_mul_u32_u24 v12, 8192, v43
  v_lshl_add_u32 v12, v76, 4, v12
  s_lshr_b32 s33, s30, 1
  s_lshl_b32 s33, s33, 7
  s_add_u32 s33, s33, s44
  v_add_u32 v12, s33, v12
  v_xor_b32 v13, 64, v12
  v_lshrrev_b32 v76, 2, v78
  v_lshl_add_u32 v75, v77, 3, v76
  v_lshlrev_b32 v75, 7, v75
  v_and_b32 v74, 3, v78
  v_lshl_add_u32 v75, v74, 3, v75
  v_lshrrev_b32 v76, 1, v76
  v_and_b32 v74, 1, v77
  v_lshl_add_u32 v76, v74, 1, v76
  s_and_b32 s33, s30, 1
  s_lshl_b32 s33, s33, 1
  v_xor_b32 v76, s33, v76
  v_lshl_add_u32 v75, v76, 5, v75
  v_add_u32 v14, s43, v75
  v_xor_b32 v15, 32, v14
  v_lshlrev_b32 v42, 4, v79
  v_add_u32 v42, s36, v42
  s_add_u32 m0, s36, 0
  s_mov_b32 s37, 0x0
  buffer_load_dwordx4 v12, s[16:19], s37 offen  lds
  s_add_u32 m0, s36, 1024
  s_mov_b32 s37, 0x10000
  buffer_load_dwordx4 v13, s[16:19], s37 offen  lds
  s_add_u32 m0, s36, 2048
  s_mov_b32 s37, 0x20000
  buffer_load_dwordx4 v12, s[16:19], s37 offen  lds
  s_add_u32 m0, s36, 3072
  s_mov_b32 s37, 0x30000
  buffer_load_dwordx4 v13, s[16:19], s37 offen  lds
  s_add_u32 m0, s36, 8192
  s_mov_b32 s37, 0x0
  buffer_load_dwordx4 v12, s[20:23], s37 offen  lds
  s_add_u32 m0, s36, 9216
  s_mov_b32 s37, 0x10000
  buffer_load_dwordx4 v13, s[20:23], s37 offen  lds
  s_add_u32 m0, s36, 10240
  s_mov_b32 s37, 0x20000
  buffer_load_dwordx4 v12, s[20:23], s37 offen  lds
  s_add_u32 m0, s36, 11264
  s_mov_b32 s37, 0x30000
  buffer_load_dwordx4 v13, s[20:23], s37 offen  lds
  s_add_u32 m0, s36, 16384
  s_mov_b32 s37, 0x80000
  buffer_load_dwordx4 v12, s[16:19], s37 offen  lds
  s_add_u32 m0, s36, 17408
  s_mov_b32 s37, 0x90000
  buffer_load_dwordx4 v13, s[16:19], s37 offen  lds
  s_add_u32 m0, s36, 18432
  s_mov_b32 s37, 0xa0000
  buffer_load_dwordx4 v12, s[16:19], s37 offen  lds
  s_add_u32 m0, s36, 19456
  s_mov_b32 s37, 0xb0000
  buffer_load_dwordx4 v13, s[16:19], s37 offen  lds
  s_add_u32 m0, s36, 24576
  s_mov_b32 s37, 0x80000
  buffer_load_dwordx4 v12, s[20:23], s37 offen  lds
  s_add_u32 m0, s36, 25600
  s_mov_b32 s37, 0x90000
  buffer_load_dwordx4 v13, s[20:23], s37 offen  lds
  s_add_u32 m0, s36, 26624
  s_mov_b32 s37, 0xa0000
  buffer_load_dwordx4 v12, s[20:23], s37 offen  lds
  s_add_u32 m0, s36, 27648
  s_mov_b32 s37, 0xb0000
  buffer_load_dwordx4 v13, s[20:23], s37 offen  lds
  s_add_u32 m0, s36, 32768
  s_mov_b32 s37, 0x100000
  buffer_load_dwordx4 v12, s[16:19], s37 offen  lds
  s_add_u32 m0, s36, 33792
  s_mov_b32 s37, 0x110000
  buffer_load_dwordx4 v13, s[16:19], s37 offen  lds
  s_add_u32 m0, s36, 34816
  s_mov_b32 s37, 0x120000
  buffer_load_dwordx4 v12, s[16:19], s37 offen  lds
  s_add_u32 m0, s36, 35840
  s_mov_b32 s37, 0x130000
  buffer_load_dwordx4 v13, s[16:19], s37 offen  lds
  s_add_u32 m0, s36, 40960
  s_mov_b32 s37, 0x100000
  buffer_load_dwordx4 v12, s[20:23], s37 offen  lds
  s_add_u32 m0, s36, 41984
  s_mov_b32 s37, 0x110000
  buffer_load_dwordx4 v13, s[20:23], s37 offen  lds
  s_add_u32 m0, s36, 43008
  s_mov_b32 s37, 0x120000
  buffer_load_dwordx4 v12, s[20:23], s37 offen  lds
  s_add_u32 m0, s36, 44032
  s_mov_b32 s37, 0x130000
  buffer_load_dwordx4 v13, s[20:23], s37 offen  lds
  s_add_u32 m0, s36, 49152
  s_mov_b32 s37, 0x180000
  buffer_load_dwordx4 v12, s[16:19], s37 offen  lds
  s_add_u32 m0, s36, 50176
  s_mov_b32 s37, 0x190000
  buffer_load_dwordx4 v13, s[16:19], s37 offen  lds
  s_add_u32 m0, s36, 51200
  s_mov_b32 s37, 0x1a0000
  buffer_load_dwordx4 v12, s[16:19], s37 offen  lds
  s_add_u32 m0, s36, 52224
  s_mov_b32 s37, 0x1b0000
  buffer_load_dwordx4 v13, s[16:19], s37 offen  lds
  s_waitcnt vmcnt(24) lgkmcnt(0)
  s_barrier
  ds_read_b64_tr_b16 a[0:1], v14 offset:0
  ds_read_b64_tr_b16 a[2:3], v14 offset:512
  ds_read_b64_tr_b16 a[4:5], v14 offset:4096
  ds_read_b64_tr_b16 a[6:7], v14 offset:4608
  ds_read_b64_tr_b16 a[8:9], v15 offset:0
  ds_read_b64_tr_b16 a[10:11], v15 offset:512
  ds_read_b64_tr_b16 a[12:13], v15 offset:4096
  ds_read_b64_tr_b16 a[14:15], v15 offset:4608
  s_waitcnt vmcnt(20) lgkmcnt(0)
  s_barrier
  ds_read_b64_tr_b16 a[16:17], v14 offset:8192
  ds_read_b64_tr_b16 a[18:19], v14 offset:8704
  ds_read_b64_tr_b16 a[20:21], v14 offset:12288
  ds_read_b64_tr_b16 a[22:23], v14 offset:12800
  ds_read_b64_tr_b16 a[24:25], v15 offset:8192
  ds_read_b64_tr_b16 a[26:27], v15 offset:8704
  ds_read_b64_tr_b16 a[28:29], v15 offset:12288
  ds_read_b64_tr_b16 a[30:31], v15 offset:12800
  s_add_u32 m0, s36, 0
  s_mov_b32 s37, 0x180000
  buffer_load_dwordx4 v12, s[20:23], s37 offen  lds
  s_add_u32 m0, s36, 1024
  s_mov_b32 s37, 0x190000
  buffer_load_dwordx4 v13, s[20:23], s37 offen  lds
  s_add_u32 m0, s36, 2048
  s_mov_b32 s37, 0x1a0000
  buffer_load_dwordx4 v12, s[20:23], s37 offen  lds
  s_add_u32 m0, s36, 3072
  s_mov_b32 s37, 0x1b0000
  buffer_load_dwordx4 v13, s[20:23], s37 offen  lds
  s_waitcnt vmcnt(20) lgkmcnt(0)
  s_barrier
  ds_read_b64_tr_b16 a[32:33], v14 offset:16384
  ds_read_b64_tr_b16 a[34:35], v14 offset:16896
  ds_read_b64_tr_b16 a[36:37], v14 offset:20480
  ds_read_b64_tr_b16 a[38:39], v14 offset:20992
  ds_read_b64_tr_b16 a[40:41], v15 offset:16384
  ds_read_b64_tr_b16 a[42:43], v15 offset:16896
  ds_read_b64_tr_b16 a[44:45], v15 offset:20480
  ds_read_b64_tr_b16 a[46:47], v15 offset:20992
  s_add_u32 m0, s36, 8192
  s_mov_b32 s37, 0x200000
  buffer_load_dwordx4 v12, s[16:19], s37 offen  lds
  s_add_u32 m0, s36, 9216
  s_mov_b32 s37, 0x210000
  buffer_load_dwordx4 v13, s[16:19], s37 offen  lds
  s_add_u32 m0, s36, 10240
  s_mov_b32 s37, 0x220000
  buffer_load_dwordx4 v12, s[16:19], s37 offen  lds
  s_add_u32 m0, s36, 11264
  s_mov_b32 s37, 0x230000
  buffer_load_dwordx4 v13, s[16:19], s37 offen  lds
  s_waitcnt vmcnt(20) lgkmcnt(0)
  s_barrier
  ds_read_b64_tr_b16 a[48:49], v14 offset:24576
  ds_read_b64_tr_b16 a[50:51], v14 offset:25088
  ds_read_b64_tr_b16 a[52:53], v14 offset:28672
  ds_read_b64_tr_b16 a[54:55], v14 offset:29184
  ds_read_b64_tr_b16 a[56:57], v15 offset:24576
  ds_read_b64_tr_b16 a[58:59], v15 offset:25088
  ds_read_b64_tr_b16 a[60:61], v15 offset:28672
  ds_read_b64_tr_b16 a[62:63], v15 offset:29184
  s_add_u32 m0, s36, 16384
  s_mov_b32 s37, 0x200000
  buffer_load_dwordx4 v12, s[20:23], s37 offen  lds
  s_add_u32 m0, s36, 17408
  s_mov_b32 s37, 0x210000
  buffer_load_dwordx4 v13, s[20:23], s37 offen  lds
  s_add_u32 m0, s36, 18432
  s_mov_b32 s37, 0x220000
  buffer_load_dwordx4 v12, s[20:23], s37 offen  lds
  s_add_u32 m0, s36, 19456
  s_mov_b32 s37, 0x230000
  buffer_load_dwordx4 v13, s[20:23], s37 offen  lds
  s_waitcnt vmcnt(20) lgkmcnt(0)
  s_barrier
  ds_read_b64_tr_b16 a[64:65], v14 offset:32768
  ds_read_b64_tr_b16 a[66:67], v14 offset:33280
  ds_read_b64_tr_b16 a[68:69], v14 offset:36864
  ds_read_b64_tr_b16 a[70:71], v14 offset:37376
  ds_read_b64_tr_b16 a[72:73], v15 offset:32768
  ds_read_b64_tr_b16 a[74:75], v15 offset:33280
  ds_read_b64_tr_b16 a[76:77], v15 offset:36864
  ds_read_b64_tr_b16 a[78:79], v15 offset:37376
  s_add_u32 m0, s36, 24576
  s_mov_b32 s37, 0x280000
  buffer_load_dwordx4 v12, s[16:19], s37 offen  lds
  s_add_u32 m0, s36, 25600
  s_mov_b32 s37, 0x290000
  buffer_load_dwordx4 v13, s[16:19], s37 offen  lds
  s_add_u32 m0, s36, 26624
  s_mov_b32 s37, 0x2a0000
  buffer_load_dwordx4 v12, s[16:19], s37 offen  lds
  s_add_u32 m0, s36, 27648
  s_mov_b32 s37, 0x2b0000
  buffer_load_dwordx4 v13, s[16:19], s37 offen  lds
  s_waitcnt vmcnt(20) lgkmcnt(0)
  s_barrier
  ds_read_b64_tr_b16 a[80:81], v14 offset:40960
  ds_read_b64_tr_b16 a[82:83], v14 offset:41472
  ds_read_b64_tr_b16 a[84:85], v14 offset:45056
  ds_read_b64_tr_b16 a[86:87], v14 offset:45568
  ds_read_b64_tr_b16 a[88:89], v15 offset:40960
  ds_read_b64_tr_b16 a[90:91], v15 offset:41472
  ds_read_b64_tr_b16 a[92:93], v15 offset:45056
  ds_read_b64_tr_b16 a[94:95], v15 offset:45568
  s_add_u32 m0, s36, 32768
  s_mov_b32 s37, 0x280000
  buffer_load_dwordx4 v12, s[20:23], s37 offen  lds
  s_add_u32 m0, s36, 33792
  s_mov_b32 s37, 0x290000
  buffer_load_dwordx4 v13, s[20:23], s37 offen  lds
  s_add_u32 m0, s36, 34816
  s_mov_b32 s37, 0x2a0000
  buffer_load_dwordx4 v12, s[20:23], s37 offen  lds
  s_add_u32 m0, s36, 35840
  s_mov_b32 s37, 0x2b0000
  buffer_load_dwordx4 v13, s[20:23], s37 offen  lds
  s_waitcnt vmcnt(20) lgkmcnt(0)
  s_barrier
  ds_read_b64_tr_b16 a[96:97], v14 offset:49152
  ds_read_b64_tr_b16 a[98:99], v14 offset:49664
  ds_read_b64_tr_b16 a[100:101], v14 offset:53248
  ds_read_b64_tr_b16 a[102:103], v14 offset:53760
  ds_read_b64_tr_b16 a[104:105], v15 offset:49152
  ds_read_b64_tr_b16 a[106:107], v15 offset:49664
  ds_read_b64_tr_b16 a[108:109], v15 offset:53248
  ds_read_b64_tr_b16 a[110:111], v15 offset:53760
  s_add_u32 m0, s36, 40960
  s_mov_b32 s37, 0x300000
  buffer_load_dwordx4 v12, s[16:19], s37 offen  lds
  s_add_u32 m0, s36, 41984
  s_mov_b32 s37, 0x310000
  buffer_load_dwordx4 v13, s[16:19], s37 offen  lds
  s_add_u32 m0, s36, 43008
  s_mov_b32 s37, 0x320000
  buffer_load_dwordx4 v12, s[16:19], s37 offen  lds
  s_add_u32 m0, s36, 44032
  s_mov_b32 s37, 0x330000
  buffer_load_dwordx4 v13, s[16:19], s37 offen  lds
  s_waitcnt vmcnt(20) lgkmcnt(0)
  s_barrier
  ds_read_b64_tr_b16 a[112:113], v14 offset:0
  ds_read_b64_tr_b16 a[114:115], v14 offset:512
  ds_read_b64_tr_b16 a[116:117], v14 offset:4096
  ds_read_b64_tr_b16 a[118:119], v14 offset:4608
  ds_read_b64_tr_b16 a[120:121], v15 offset:0
  ds_read_b64_tr_b16 a[122:123], v15 offset:512
  ds_read_b64_tr_b16 a[124:125], v15 offset:4096
  ds_read_b64_tr_b16 a[126:127], v15 offset:4608
  s_add_u32 m0, s36, 49152
  s_mov_b32 s37, 0x300000
  buffer_load_dwordx4 v12, s[20:23], s37 offen  lds
  s_add_u32 m0, s36, 50176
  s_mov_b32 s37, 0x310000
  buffer_load_dwordx4 v13, s[20:23], s37 offen  lds
  s_add_u32 m0, s36, 51200
  s_mov_b32 s37, 0x320000
  buffer_load_dwordx4 v12, s[20:23], s37 offen  lds
  s_add_u32 m0, s36, 52224
  s_mov_b32 s37, 0x330000
  buffer_load_dwordx4 v13, s[20:23], s37 offen  lds
  s_waitcnt vmcnt(20) lgkmcnt(0)
  s_barrier
  ds_read_b64_tr_b16 a[128:129], v14 offset:8192
  ds_read_b64_tr_b16 a[130:131], v14 offset:8704
  ds_read_b64_tr_b16 a[132:133], v14 offset:12288
  ds_read_b64_tr_b16 a[134:135], v14 offset:12800
  ds_read_b64_tr_b16 a[136:137], v15 offset:8192
  ds_read_b64_tr_b16 a[138:139], v15 offset:8704
  ds_read_b64_tr_b16 a[140:141], v15 offset:12288
  ds_read_b64_tr_b16 a[142:143], v15 offset:12800
  s_add_u32 m0, s36, 0
  s_mov_b32 s37, 0x380000
  buffer_load_dwordx4 v12, s[16:19], s37 offen  lds
  s_add_u32 m0, s36, 1024
  s_mov_b32 s37, 0x390000
  buffer_load_dwordx4 v13, s[16:19], s37 offen  lds
  s_add_u32 m0, s36, 2048
  s_mov_b32 s37, 0x3a0000
  buffer_load_dwordx4 v12, s[16:19], s37 offen  lds
  s_add_u32 m0, s36, 3072
  s_mov_b32 s37, 0x3b0000
  buffer_load_dwordx4 v13, s[16:19], s37 offen  lds
  s_waitcnt vmcnt(20) lgkmcnt(0)
  s_barrier
  ds_read_b64_tr_b16 a[144:145], v14 offset:16384
  ds_read_b64_tr_b16 a[146:147], v14 offset:16896
  ds_read_b64_tr_b16 a[148:149], v14 offset:20480
  ds_read_b64_tr_b16 a[150:151], v14 offset:20992
  ds_read_b64_tr_b16 a[152:153], v15 offset:16384
  ds_read_b64_tr_b16 a[154:155], v15 offset:16896
  ds_read_b64_tr_b16 a[156:157], v15 offset:20480
  ds_read_b64_tr_b16 a[158:159], v15 offset:20992
  s_add_u32 m0, s36, 8192
  s_mov_b32 s37, 0x380000
  buffer_load_dwordx4 v12, s[20:23], s37 offen  lds
  s_add_u32 m0, s36, 9216
  s_mov_b32 s37, 0x390000
  buffer_load_dwordx4 v13, s[20:23], s37 offen  lds
  s_add_u32 m0, s36, 10240
  s_mov_b32 s37, 0x3a0000
  buffer_load_dwordx4 v12, s[20:23], s37 offen  lds
  s_add_u32 m0, s36, 11264
  s_mov_b32 s37, 0x3b0000
  buffer_load_dwordx4 v13, s[20:23], s37 offen  lds
  s_waitcnt vmcnt(20) lgkmcnt(0)
  s_barrier
  ds_read_b64_tr_b16 a[160:161], v14 offset:24576
  ds_read_b64_tr_b16 a[162:163], v14 offset:25088
  ds_read_b64_tr_b16 a[164:165], v14 offset:28672
  ds_read_b64_tr_b16 a[166:167], v14 offset:29184
  ds_read_b64_tr_b16 a[168:169], v15 offset:24576
  ds_read_b64_tr_b16 a[170:171], v15 offset:25088
  ds_read_b64_tr_b16 a[172:173], v15 offset:28672
  ds_read_b64_tr_b16 a[174:175], v15 offset:29184
  s_add_u32 m0, s36, 16384
  s_mov_b32 s37, 0x400000
  buffer_load_dwordx4 v12, s[16:19], s37 offen  lds
  s_add_u32 m0, s36, 17408
  s_mov_b32 s37, 0x410000
  buffer_load_dwordx4 v13, s[16:19], s37 offen  lds
  s_add_u32 m0, s36, 18432
  s_mov_b32 s37, 0x420000
  buffer_load_dwordx4 v12, s[16:19], s37 offen  lds
  s_add_u32 m0, s36, 19456
  s_mov_b32 s37, 0x430000
  buffer_load_dwordx4 v13, s[16:19], s37 offen  lds
  s_waitcnt vmcnt(20) lgkmcnt(0)
  s_barrier
  ds_read_b64_tr_b16 a[176:177], v14 offset:32768
  ds_read_b64_tr_b16 a[178:179], v14 offset:33280
  ds_read_b64_tr_b16 a[180:181], v14 offset:36864
  ds_read_b64_tr_b16 a[182:183], v14 offset:37376
  ds_read_b64_tr_b16 a[184:185], v15 offset:32768
  ds_read_b64_tr_b16 a[186:187], v15 offset:33280
  ds_read_b64_tr_b16 a[188:189], v15 offset:36864
  ds_read_b64_tr_b16 a[190:191], v15 offset:37376
  s_add_u32 m0, s36, 24576
  s_mov_b32 s37, 0x400000
  buffer_load_dwordx4 v12, s[20:23], s37 offen  lds
  s_add_u32 m0, s36, 25600
  s_mov_b32 s37, 0x410000
  buffer_load_dwordx4 v13, s[20:23], s37 offen  lds
  s_add_u32 m0, s36, 26624
  s_mov_b32 s37, 0x420000
  buffer_load_dwordx4 v12, s[20:23], s37 offen  lds
  s_add_u32 m0, s36, 27648
  s_mov_b32 s37, 0x430000
  buffer_load_dwordx4 v13, s[20:23], s37 offen  lds
  s_waitcnt vmcnt(20) lgkmcnt(0)
  s_barrier
  ds_read_b64_tr_b16 a[192:193], v14 offset:40960
  ds_read_b64_tr_b16 a[194:195], v14 offset:41472
  ds_read_b64_tr_b16 a[196:197], v14 offset:45056
  ds_read_b64_tr_b16 a[198:199], v14 offset:45568
  ds_read_b64_tr_b16 a[200:201], v15 offset:40960
  ds_read_b64_tr_b16 a[202:203], v15 offset:41472
  ds_read_b64_tr_b16 a[204:205], v15 offset:45056
  ds_read_b64_tr_b16 a[206:207], v15 offset:45568
  s_waitcnt vmcnt(16) lgkmcnt(0)
  s_barrier
  ds_read_b64_tr_b16 a[208:209], v14 offset:49152
  ds_read_b64_tr_b16 a[210:211], v14 offset:49664
  ds_read_b64_tr_b16 a[212:213], v14 offset:53248
  ds_read_b64_tr_b16 a[214:215], v14 offset:53760
  ds_read_b64_tr_b16 a[216:217], v15 offset:49152
  ds_read_b64_tr_b16 a[218:219], v15 offset:49664
  ds_read_b64_tr_b16 a[220:221], v15 offset:53248
  ds_read_b64_tr_b16 a[222:223], v15 offset:53760
  s_waitcnt vmcnt(12) lgkmcnt(0)
  s_barrier
  ds_read_b64_tr_b16 a[224:225], v14 offset:0
  ds_read_b64_tr_b16 a[226:227], v14 offset:512
  ds_read_b64_tr_b16 a[228:229], v14 offset:4096
  ds_read_b64_tr_b16 a[230:231], v14 offset:4608
  ds_read_b64_tr_b16 a[232:233], v15 offset:0
  ds_read_b64_tr_b16 a[234:235], v15 offset:512
  ds_read_b64_tr_b16 a[236:237], v15 offset:4096
  ds_read_b64_tr_b16 a[238:239], v15 offset:4608
  s_waitcnt vmcnt(8) lgkmcnt(0)
  s_barrier
  ds_read_b64_tr_b16 a[240:241], v14 offset:8192
  ds_read_b64_tr_b16 a[242:243], v14 offset:8704
  ds_read_b64_tr_b16 a[244:245], v14 offset:12288
  ds_read_b64_tr_b16 a[246:247], v14 offset:12800
  ds_read_b64_tr_b16 a[248:249], v15 offset:8192
  ds_read_b64_tr_b16 a[250:251], v15 offset:8704
  ds_read_b64_tr_b16 a[252:253], v15 offset:12288
  ds_read_b64_tr_b16 a[254:255], v15 offset:12800
  s_waitcnt vmcnt(4) lgkmcnt(0)
  s_barrier
  ds_read_b64_tr_b16 v[80:81], v14 offset:16384
  ds_read_b64_tr_b16 v[82:83], v14 offset:16896
  ds_read_b64_tr_b16 v[84:85], v14 offset:20480
  ds_read_b64_tr_b16 v[86:87], v14 offset:20992
  ds_read_b64_tr_b16 v[88:89], v15 offset:16384
  ds_read_b64_tr_b16 v[90:91], v15 offset:16896
  ds_read_b64_tr_b16 v[92:93], v15 offset:20480
  ds_read_b64_tr_b16 v[94:95], v15 offset:20992
  s_waitcnt vmcnt(0) lgkmcnt(0)
  s_barrier
  ds_read_b64_tr_b16 v[96:97], v14 offset:24576
  ds_read_b64_tr_b16 v[98:99], v14 offset:25088
  ds_read_b64_tr_b16 v[100:101], v14 offset:28672
  ds_read_b64_tr_b16 v[102:103], v14 offset:29184
  ds_read_b64_tr_b16 v[104:105], v15 offset:24576
  ds_read_b64_tr_b16 v[106:107], v15 offset:25088
  ds_read_b64_tr_b16 v[108:109], v15 offset:28672
  ds_read_b64_tr_b16 v[110:111], v15 offset:29184
  s_waitcnt lgkmcnt(0)
  s_barrier
  v_mov_b32 v16, 64
L_pa_init:
  buffer_load_dword v17, v16, s[8:11], 0 offen sc1
  s_sub_u32 s31, s31, 1
  s_cbranch_scc1 L_exit
  s_waitcnt vmcnt(0)
  v_readfirstlane_b32 s33, v17
  s_nop 0
  s_cmp_ge_u32 s33, 6
  s_cbranch_scc1 L_pa_init_ok
  s_sleep 2
  s_branch L_pa_init
L_pa_init_ok:
  s_lshl_b32 s43, s34, 14
  s_lshl_b32 s37, s35, 19
  s_add_u32 s43, s43, s37
  s_lshl_b32 s37, s30, 12
  s_add_u32 s43, s43, s37
  s_add_u32 s43, s43, 0x1000000
  s_lshl_b32 s44, s34, 8
  s_lshl_b32 s37, s35, 2
  s_add_u32 s44, s44, s37
  s_add_u32 s44, s44, 0x60000
  s_mul_i32 s45, s35, 9216
  s_add_u32 s45, s45, 0x200000
  s_lshl_b32 s46, s35, 18
  s_and_b32 s37, s30, 1
  s_lshl_b32 s37, s37, 17
  s_add_u32 s46, s46, s37
  s_lshl_b32 s37, s34, 12
  s_add_u32 s46, s46, s37
  s_lshr_b32 s37, s30, 1
  s_lshl_b32 s37, s37, 11
  s_add_u32 s46, s46, s37
  s_add_u32 s46, s46, 0x3000000
  s_mov_b32 s47, s46
  s_lshl_b32 s37, s30, 10
  s_add_u32 s37, s37, 73728
  v_add_u32 v3, s37, v0
  s_and_b32 s37, s30, 1
  s_lshl_b32 s37, s37, 12
  s_add_u32 s37, s37, 73728
  v_add_u32 v4, s37, v0
  s_lshr_b32 s37, s30, 1
  s_lshl_b32 s37, s37, 11
  s_add_u32 s37, s37, 90112
  v_add_u32 v5, s37, v0
  v_mov_b32 v10, v0
  s_mov_b32 s41, 0
  s_mov_b32 s42, 0
  s_barrier
  ds_read_b128 v[64:67], v10 offset:0
  ds_read_b128 v[68:71], v10 offset:18432
  s_waitcnt lgkmcnt(1)
  v_mfma_f32_16x16x32_bf16 v[32:35], a[0:3], v[64:67], 0
  s_waitcnt lgkmcnt(0)
  v_mfma_f32_16x16x32_bf16 v[36:39], a[0:3], v[68:71], 0
  ds_read_b128 v[72:75], v10 offset:1024
  ds_read_b128 v[76:79], v10 offset:19456
  v_mfma_f32_16x16x32_bf16 v[40:43], a[8:11], v[64:67], 0
  v_mfma_f32_16x16x32_bf16 v[44:47], a[8:11], v[68:71], 0
  v_mfma_f32_16x16x32_bf16 v[48:51], v[64:67], a[16:19], 0
  v_mfma_f32_16x16x32_bf16 v[52:55], v[68:71], a[16:19], 0
  v_mfma_f32_16x16x32_bf16 v[56:59], v[64:67], a[24:27], 0
  v_mfma_f32_16x16x32_bf16 v[60:63], v[68:71], a[24:27], 0
  s_waitcnt lgkmcnt(1)
  v_mfma_f32_16x16x32_bf16 v[32:35], a[4:7], v[72:75], v[32:35]
  s_waitcnt lgkmcnt(0)
  v_mfma_f32_16x16x32_bf16 v[36:39], a[4:7], v[76:79], v[36:39]
  ds_read_b128 v[64:67], v10 offset:2048
  ds_read_b128 v[68:71], v10 offset:20480
  v_mfma_f32_16x16x32_bf16 v[40:43], a[12:15], v[72:75], v[40:43]
  v_mfma_f32_16x16x32_bf16 v[44:47], a[12:15], v[76:79], v[44:47]
  v_mfma_f32_16x16x32_bf16 v[48:51], v[72:75], a[20:23], v[48:51]
  v_mfma_f32_16x16x32_bf16 v[52:55], v[76:79], a[20:23], v[52:55]
  v_mfma_f32_16x16x32_bf16 v[56:59], v[72:75], a[28:31], v[56:59]
  v_mfma_f32_16x16x32_bf16 v[60:63], v[76:79], a[28:31], v[60:63]
  s_waitcnt lgkmcnt(1)
  v_mfma_f32_16x16x32_bf16 v[32:35], a[32:35], v[64:67], v[32:35]
  s_waitcnt lgkmcnt(0)
  v_mfma_f32_16x16x32_bf16 v[36:39], a[32:35], v[68:71], v[36:39]
  ds_read_b128 v[72:75], v10 offset:3072
  ds_read_b128 v[76:79], v10 offset:21504
  v_mfma_f32_16x16x32_bf16 v[40:43], a[40:43], v[64:67], v[40:43]
  v_mfma_f32_16x16x32_bf16 v[44:47], a[40:43], v[68:71], v[44:47]
  v_mfma_f32_16x16x32_bf16 v[48:51], v[64:67], a[48:51], v[48:51]
  v_mfma_f32_16x16x32_bf16 v[52:55], v[68:71], a[48:51], v[52:55]
  v_mfma_f32_16x16x32_bf16 v[56:59], v[64:67], a[56:59], v[56:59]
  v_mfma_f32_16x16x32_bf16 v[60:63], v[68:71], a[56:59], v[60:63]
  s_waitcnt lgkmcnt(1)
  v_mfma_f32_16x16x32_bf16 v[32:35], a[36:39], v[72:75], v[32:35]
  s_waitcnt lgkmcnt(0)
  v_mfma_f32_16x16x32_bf16 v[36:39], a[36:39], v[76:79], v[36:39]
  ds_read_b128 v[64:67], v10 offset:4096
  ds_read_b128 v[68:71], v10 offset:22528
  v_mfma_f32_16x16x32_bf16 v[40:43], a[44:47], v[72:75], v[40:43]
  v_mfma_f32_16x16x32_bf16 v[44:47], a[44:47], v[76:79], v[44:47]
  v_mfma_f32_16x16x32_bf16 v[48:51], v[72:75], a[52:55], v[48:51]
  v_mfma_f32_16x16x32_bf16 v[52:55], v[76:79], a[52:55], v[52:55]
  v_mfma_f32_16x16x32_bf16 v[56:59], v[72:75], a[60:63], v[56:59]
  v_mfma_f32_16x16x32_bf16 v[60:63], v[76:79], a[60:63], v[60:63]
  s_waitcnt lgkmcnt(1)
  v_mfma_f32_16x16x32_bf16 v[32:35], a[64:67], v[64:67], v[32:35]
  s_waitcnt lgkmcnt(0)
  v_mfma_f32_16x16x32_bf16 v[36:39], a[64:67], v[68:71], v[36:39]
  ds_read_b128 v[72:75], v10 offset:5120
  ds_read_b128 v[76:79], v10 offset:23552
  v_mfma_f32_16x16x32_bf16 v[40:43], a[72:75], v[64:67], v[40:43]
  v_mfma_f32_16x16x32_bf16 v[44:47], a[72:75], v[68:71], v[44:47]
  v_mfma_f32_16x16x32_bf16 v[48:51], v[64:67], a[80:83], v[48:51]
  v_mfma_f32_16x16x32_bf16 v[52:55], v[68:71], a[80:83], v[52:55]
  v_mfma_f32_16x16x32_bf16 v[56:59], v[64:67], a[88:91], v[56:59]
  v_mfma_f32_16x16x32_bf16 v[60:63], v[68:71], a[88:91], v[60:63]
  s_waitcnt lgkmcnt(1)
  v_mfma_f32_16x16x32_bf16 v[32:35], a[68:71], v[72:75], v[32:35]
  s_waitcnt lgkmcnt(0)
  v_mfma_f32_16x16x32_bf16 v[36:39], a[68:71], v[76:79], v[36:39]
  ds_read_b128 v[64:67], v10 offset:6144
  ds_read_b128 v[68:71], v10 offset:24576
  v_mfma_f32_16x16x32_bf16 v[40:43], a[76:79], v[72:75], v[40:43]
  v_mfma_f32_16x16x32_bf16 v[44:47], a[76:79], v[76:79], v[44:47]
  v_mfma_f32_16x16x32_bf16 v[48:51], v[72:75], a[84:87], v[48:51]
  v_mfma_f32_16x16x32_bf16 v[52:55], v[76:79], a[84:87], v[52:55]
  v_mfma_f32_16x16x32_bf16 v[56:59], v[72:75], a[92:95], v[56:59]
  v_mfma_f32_16x16x32_bf16 v[60:63], v[76:79], a[92:95], v[60:63]
  s_waitcnt lgkmcnt(1)
  v_mfma_f32_16x16x32_bf16 v[32:35], a[96:99], v[64:67], v[32:35]
  s_waitcnt lgkmcnt(0)
  v_mfma_f32_16x16x32_bf16 v[36:39], a[96:99], v[68:71], v[36:39]
  ds_read_b128 v[72:75], v10 offset:7168
  ds_read_b128 v[76:79], v10 offset:25600
  v_mfma_f32_16x16x32_bf16 v[40:43], a[104:107], v[64:67], v[40:43]
  v_mfma_f32_16x16x32_bf16 v[44:47], a[104:107], v[68:71], v[44:47]
  v_mfma_f32_16x16x32_bf16 v[48:51], v[64:67], a[112:115], v[48:51]
  v_mfma_f32_16x16x32_bf16 v[52:55], v[68:71], a[112:115], v[52:55]
  v_mfma_f32_16x16x32_bf16 v[56:59], v[64:67], a[120:123], v[56:59]
  v_mfma_f32_16x16x32_bf16 v[60:63], v[68:71], a[120:123], v[60:63]
  s_waitcnt lgkmcnt(1)
  v_mfma_f32_16x16x32_bf16 v[32:35], a[100:103], v[72:75], v[32:35]
  s_waitcnt lgkmcnt(0)
  v_mfma_f32_16x16x32_bf16 v[36:39], a[100:103], v[76:79], v[36:39]
  ds_read_b128 v[64:67], v10 offset:8192
  ds_read_b128 v[68:71], v10 offset:26624
  v_mfma_f32_16x16x32_bf16 v[40:43], a[108:111], v[72:75], v[40:43]
  v_mfma_f32_16x16x32_bf16 v[44:47], a[108:111], v[76:79], v[44:47]
  v_mfma_f32_16x16x32_bf16 v[48:51], v[72:75], a[116:119], v[48:51]
  v_mfma_f32_16x16x32_bf16 v[52:55], v[76:79], a[116:119], v[52:55]
  v_mfma_f32_16x16x32_bf16 v[56:59], v[72:75], a[124:127], v[56:59]
  v_mfma_f32_16x16x32_bf16 v[60:63], v[76:79], a[124:127], v[60:63]
  s_waitcnt lgkmcnt(1)
  v_mfma_f32_16x16x32_bf16 v[32:35], a[128:131], v[64:67], v[32:35]
  s_waitcnt lgkmcnt(0)
  v_mfma_f32_16x16x32_bf16 v[36:39], a[128:131], v[68:71], v[36:39]
  ds_read_b128 v[72:75], v10 offset:9216
  ds_read_b128 v[76:79], v10 offset:27648
  v_mfma_f32_16x16x32_bf16 v[40:43], a[136:139], v[64:67], v[40:43]
  v_mfma_f32_16x16x32_bf16 v[44:47], a[136:139], v[68:71], v[44:47]
  v_mfma_f32_16x16x32_bf16 v[48:51], v[64:67], a[144:147], v[48:51]
  v_mfma_f32_16x16x32_bf16 v[52:55], v[68:71], a[144:147], v[52:55]
  v_mfma_f32_16x16x32_bf16 v[56:59], v[64:67], a[152:155], v[56:59]
  v_mfma_f32_16x16x32_bf16 v[60:63], v[68:71], a[152:155], v[60:63]
  s_waitcnt lgkmcnt(1)
  v_mfma_f32_16x16x32_bf16 v[32:35], a[132:135], v[72:75], v[32:35]
  s_waitcnt lgkmcnt(0)
  v_mfma_f32_16x16x32_bf16 v[36:39], a[132:135], v[76:79], v[36:39]
  ds_read_b128 v[64:67], v10 offset:10240
  ds_read_b128 v[68:71], v10 offset:28672
  v_mfma_f32_16x16x32_bf16 v[40:43], a[140:143], v[72:75], v[40:43]
  v_mfma_f32_16x16x32_bf16 v[44:47], a[140:143], v[76:79], v[44:47]
  v_mfma_f32_16x16x32_bf16 v[48:51], v[72:75], a[148:151], v[48:51]
  v_mfma_f32_16x16x32_bf16 v[52:55], v[76:79], a[148:151], v[52:55]
  v_mfma_f32_16x16x32_bf16 v[56:59], v[72:75], a[156:159], v[56:59]
  v_mfma_f32_16x16x32_bf16 v[60:63], v[76:79], a[156:159], v[60:63]
  s_waitcnt lgkmcnt(1)
  v_mfma_f32_16x16x32_bf16 v[32:35], a[160:163], v[64:67], v[32:35]
  s_waitcnt lgkmcnt(0)
  v_mfma_f32_16x16x32_bf16 v[36:39], a[160:163], v[68:71], v[36:39]
  ds_read_b128 v[72:75], v10 offset:11264
  ds_read_b128 v[76:79], v10 offset:29696
  v_mfma_f32_16x16x32_bf16 v[40:43], a[168:171], v[64:67], v[40:43]
  v_mfma_f32_16x16x32_bf16 v[44:47], a[168:171], v[68:71], v[44:47]
  v_mfma_f32_16x16x32_bf16 v[48:51], v[64:67], a[176:179], v[48:51]
  v_mfma_f32_16x16x32_bf16 v[52:55], v[68:71], a[176:179], v[52:55]
  v_mfma_f32_16x16x32_bf16 v[56:59], v[64:67], a[184:187], v[56:59]
  v_mfma_f32_16x16x32_bf16 v[60:63], v[68:71], a[184:187], v[60:63]
  s_waitcnt lgkmcnt(1)
  v_mfma_f32_16x16x32_bf16 v[32:35], a[164:167], v[72:75], v[32:35]
  s_waitcnt lgkmcnt(0)
  v_mfma_f32_16x16x32_bf16 v[36:39], a[164:167], v[76:79], v[36:39]
  ds_read_b128 v[64:67], v10 offset:12288
  ds_read_b128 v[68:71], v10 offset:30720
  v_mfma_f32_16x16x32_bf16 v[40:43], a[172:175], v[72:75], v[40:43]
  v_mfma_f32_16x16x32_bf16 v[44:47], a[172:175], v[76:79], v[44:47]
  v_mfma_f32_16x16x32_bf16 v[48:51], v[72:75], a[180:183], v[48:51]
  v_mfma_f32_16x16x32_bf16 v[52:55], v[76:79], a[180:183], v[52:55]
  v_mfma_f32_16x16x32_bf16 v[56:59], v[72:75], a[188:191], v[56:59]
  v_mfma_f32_16x16x32_bf16 v[60:63], v[76:79], a[188:191], v[60:63]
  s_waitcnt lgkmcnt(1)
  v_mfma_f32_16x16x32_bf16 v[32:35], a[192:195], v[64:67], v[32:35]
  s_waitcnt lgkmcnt(0)
  v_mfma_f32_16x16x32_bf16 v[36:39], a[192:195], v[68:71], v[36:39]
  ds_read_b128 v[72:75], v10 offset:13312
  ds_read_b128 v[76:79], v10 offset:31744
  v_mfma_f32_16x16x32_bf16 v[40:43], a[200:203], v[64:67], v[40:43]
  v_mfma_f32_16x16x32_bf16 v[44:47], a[200:203], v[68:71], v[44:47]
  v_mfma_f32_16x16x32_bf16 v[48:51], v[64:67], a[208:211], v[48:51]
  v_mfma_f32_16x16x32_bf16 v[52:55], v[68:71], a[208:211], v[52:55]
  v_mfma_f32_16x16x32_bf16 v[56:59], v[64:67], a[216:219], v[56:59]
  v_mfma_f32_16x16x32_bf16 v[60:63], v[68:71], a[216:219], v[60:63]
  s_waitcnt lgkmcnt(1)
  v_mfma_f32_16x16x32_bf16 v[32:35], a[196:199], v[72:75], v[32:35]
  s_waitcnt lgkmcnt(0)
  v_mfma_f32_16x16x32_bf16 v[36:39], a[196:199], v[76:79], v[36:39]
  ds_read_b128 v[64:67], v10 offset:14336
  ds_read_b128 v[68:71], v10 offset:32768
  v_mfma_f32_16x16x32_bf16 v[40:43], a[204:207], v[72:75], v[40:43]
  v_mfma_f32_16x16x32_bf16 v[44:47], a[204:207], v[76:79], v[44:47]
  v_mfma_f32_16x16x32_bf16 v[48:51], v[72:75], a[212:215], v[48:51]
  v_mfma_f32_16x16x32_bf16 v[52:55], v[76:79], a[212:215], v[52:55]
  v_mfma_f32_16x16x32_bf16 v[56:59], v[72:75], a[220:223], v[56:59]
  v_mfma_f32_16x16x32_bf16 v[60:63], v[76:79], a[220:223], v[60:63]
  s_waitcnt lgkmcnt(1)
  v_mfma_f32_16x16x32_bf16 v[32:35], a[224:227], v[64:67], v[32:35]
  s_waitcnt lgkmcnt(0)
  v_mfma_f32_16x16x32_bf16 v[36:39], a[224:227], v[68:71], v[36:39]
  ds_read_b128 v[72:75], v10 offset:15360
  ds_read_b128 v[76:79], v10 offset:33792
  v_mfma_f32_16x16x32_bf16 v[40:43], a[232:235], v[64:67], v[40:43]
  v_mfma_f32_16x16x32_bf16 v[44:47], a[232:235], v[68:71], v[44:47]
  v_mfma_f32_16x16x32_bf16 v[48:51], v[64:67], a[240:243], v[48:51]
  v_mfma_f32_16x16x32_bf16 v[52:55], v[68:71], a[240:243], v[52:55]
  v_mfma_f32_16x16x32_bf16 v[56:59], v[64:67], a[248:251], v[56:59]
  v_mfma_f32_16x16x32_bf16 v[60:63], v[68:71], a[248:251], v[60:63]
  s_waitcnt lgkmcnt(1)
  v_mfma_f32_16x16x32_bf16 v[32:35], a[228:231], v[72:75], v[32:35]
  s_waitcnt lgkmcnt(0)
  v_mfma_f32_16x16x32_bf16 v[36:39], a[228:231], v[76:79], v[36:39]
  ds_read_b128 v[64:67], v10 offset:16384
  ds_read_b128 v[68:71], v10 offset:34816
  v_mfma_f32_16x16x32_bf16 v[40:43], a[236:239], v[72:75], v[40:43]
  v_mfma_f32_16x16x32_bf16 v[44:47], a[236:239], v[76:79], v[44:47]
  v_mfma_f32_16x16x32_bf16 v[48:51], v[72:75], a[244:247], v[48:51]
  v_mfma_f32_16x16x32_bf16 v[52:55], v[76:79], a[244:247], v[52:55]
  v_mfma_f32_16x16x32_bf16 v[56:59], v[72:75], a[252:255], v[56:59]
  v_mfma_f32_16x16x32_bf16 v[60:63], v[76:79], a[252:255], v[60:63]
  s_waitcnt lgkmcnt(1)
  v_mfma_f32_16x16x32_bf16 v[32:35], v[80:83], v[64:67], v[32:35]
  s_waitcnt lgkmcnt(0)
  v_mfma_f32_16x16x32_bf16 v[36:39], v[80:83], v[68:71], v[36:39]
  ds_read_b128 v[72:75], v10 offset:17408
  ds_read_b128 v[76:79], v10 offset:35840
  v_mfma_f32_16x16x32_bf16 v[40:43], v[88:91], v[64:67], v[40:43]
  v_mfma_f32_16x16x32_bf16 v[44:47], v[88:91], v[68:71], v[44:47]
  v_mfma_f32_16x16x32_bf16 v[48:51], v[64:67], v[96:99], v[48:51]
  v_mfma_f32_16x16x32_bf16 v[52:55], v[68:71], v[96:99], v[52:55]
  v_mfma_f32_16x16x32_bf16 v[56:59], v[64:67], v[104:107], v[56:59]
  v_mfma_f32_16x16x32_bf16 v[60:63], v[68:71], v[104:107], v[60:63]
  s_waitcnt lgkmcnt(1)
  v_mfma_f32_16x16x32_bf16 v[32:35], v[84:87], v[72:75], v[32:35]
  s_waitcnt lgkmcnt(0)
  v_mfma_f32_16x16x32_bf16 v[36:39], v[84:87], v[76:79], v[36:39]
  v_mfma_f32_16x16x32_bf16 v[40:43], v[92:95], v[72:75], v[40:43]
  v_mfma_f32_16x16x32_bf16 v[44:47], v[92:95], v[76:79], v[44:47]
  v_mfma_f32_16x16x32_bf16 v[48:51], v[72:75], v[100:103], v[48:51]
  v_mfma_f32_16x16x32_bf16 v[52:55], v[76:79], v[100:103], v[52:55]
  v_mfma_f32_16x16x32_bf16 v[56:59], v[72:75], v[108:111], v[56:59]
  v_mfma_f32_16x16x32_bf16 v[60:63], v[76:79], v[108:111], v[60:63]
  v_cvt_pk_bf16_f32 v72, v32, v33
  v_cvt_pk_bf16_f32 v73, v34, v35
  v_cvt_pk_bf16_f32 v74, v40, v41
  v_cvt_pk_bf16_f32 v75, v42, v43
  buffer_store_dwordx4 v[72:75], v0, s[4:7], s43 offen offset:0 sc1
  v_cvt_pk_bf16_f32 v76, v36, v37
  v_cvt_pk_bf16_f32 v77, v38, v39
  v_cvt_pk_bf16_f32 v78, v44, v45
  v_cvt_pk_bf16_f32 v79, v46, v47
  buffer_store_dwordx4 v[76:79], v0, s[4:7], s43 offen offset:1024 sc1
  v_cvt_pk_bf16_f32 v64, v48, v49
  v_cvt_pk_bf16_f32 v65, v50, v51
  v_cvt_pk_bf16_f32 v66, v52, v53
  v_cvt_pk_bf16_f32 v67, v54, v55
  buffer_store_dwordx4 v[64:67], v0, s[4:7], s43 offen offset:2048 sc1
  v_cvt_pk_bf16_f32 v68, v56, v57
  v_cvt_pk_bf16_f32 v69, v58, v59
  v_cvt_pk_bf16_f32 v70, v60, v61
  v_cvt_pk_bf16_f32 v71, v62, v63
  buffer_store_dwordx4 v[68:71], v0, s[4:7], s43 offen offset:3072 sc1
  s_waitcnt vmcnt(0)
  s_barrier
  v_mov_b32 v16, 1
  buffer_store_dword v16, v9, s[4:7], s44 offen sc1
  s_add_u32 m0, s36, 0
  s_mov_b32 s37, 0x0
  buffer_load_dwordx4 v12, s[12:15], s37 offen  lds
  s_add_u32 m0, s36, 1024
  s_mov_b32 s37, 0x10000
  buffer_load_dwordx4 v13, s[12:15], s37 offen  lds
  s_add_u32 m0, s36, 2048
  s_mov_b32 s37, 0x20000
  buffer_load_dwordx4 v12, s[12:15], s37 offen  lds
  s_add_u32 m0, s36, 3072
  s_mov_b32 s37, 0x30000
  buffer_load_dwordx4 v13, s[12:15], s37 offen  lds
  s_add_u32 m0, s36, 8192
  s_mov_b32 s37, 0x80000
  buffer_load_dwordx4 v12, s[12:15], s37 offen  lds
  s_add_u32 m0, s36, 9216
  s_mov_b32 s37, 0x90000
  buffer_load_dwordx4 v13, s[12:15], s37 offen  lds
  s_add_u32 m0, s36, 10240
  s_mov_b32 s37, 0xa0000
  buffer_load_dwordx4 v12, s[12:15], s37 offen  lds
  s_add_u32 m0, s36, 11264
  s_mov_b32 s37, 0xb0000
  buffer_load_dwordx4 v13, s[12:15], s37 offen  lds
  s_add_u32 m0, s36, 16384
  s_mov_b32 s37, 0x100000
  buffer_load_dwordx4 v12, s[12:15], s37 offen  lds
  s_add_u32 m0, s36, 17408
  s_mov_b32 s37, 0x110000
  buffer_load_dwordx4 v13, s[12:15], s37 offen  lds
  s_add_u32 m0, s36, 18432
  s_mov_b32 s37, 0x120000
  buffer_load_dwordx4 v12, s[12:15], s37 offen  lds
  s_add_u32 m0, s36, 19456
  s_mov_b32 s37, 0x130000
  buffer_load_dwordx4 v13, s[12:15], s37 offen  lds
  s_add_u32 m0, s36, 24576
  s_mov_b32 s37, 0x180000
  buffer_load_dwordx4 v12, s[12:15], s37 offen  lds
  s_add_u32 m0, s36, 25600
  s_mov_b32 s37, 0x190000
  buffer_load_dwordx4 v13, s[12:15], s37 offen  lds
  s_add_u32 m0, s36, 26624
  s_mov_b32 s37, 0x1a0000
  buffer_load_dwordx4 v12, s[12:15], s37 offen  lds
  s_add_u32 m0, s36, 27648
  s_mov_b32 s37, 0x1b0000
  buffer_load_dwordx4 v13, s[12:15], s37 offen  lds
  s_add_u32 m0, s36, 32768
  s_mov_b32 s37, 0x200000
  buffer_load_dwordx4 v12, s[12:15], s37 offen  lds
  s_add_u32 m0, s36, 33792
  s_mov_b32 s37, 0x210000
  buffer_load_dwordx4 v13, s[12:15], s37 offen  lds
  s_add_u32 m0, s36, 34816
  s_mov_b32 s37, 0x220000
  buffer_load_dwordx4 v12, s[12:15], s37 offen  lds
  s_add_u32 m0, s36, 35840
  s_mov_b32 s37, 0x230000
  buffer_load_dwordx4 v13, s[12:15], s37 offen  lds
  s_add_u32 m0, s36, 40960
  s_mov_b32 s37, 0x280000
  buffer_load_dwordx4 v12, s[12:15], s37 offen  lds
  s_add_u32 m0, s36, 41984
  s_mov_b32 s37, 0x290000
  buffer_load_dwordx4 v13, s[12:15], s37 offen  lds
  s_add_u32 m0, s36, 43008
  s_mov_b32 s37, 0x2a0000
  buffer_load_dwordx4 v12, s[12:15], s37 offen  lds
  s_add_u32 m0, s36, 44032
  s_mov_b32 s37, 0x2b0000
  buffer_load_dwordx4 v13, s[12:15], s37 offen  lds
  s_add_u32 m0, s36, 49152
  s_mov_b32 s37, 0x300000
  buffer_load_dwordx4 v12, s[12:15], s37 offen  lds
  s_add_u32 m0, s36, 50176
  s_mov_b32 s37, 0x310000
  buffer_load_dwordx4 v13, s[12:15], s37 offen  lds
  s_add_u32 m0, s36, 51200
  s_mov_b32 s37, 0x320000
  buffer_load_dwordx4 v12, s[12:15], s37 offen  lds
  s_add_u32 m0, s36, 52224
  s_mov_b32 s37, 0x330000
  buffer_load_dwordx4 v13, s[12:15], s37 offen  lds
  s_waitcnt vmcnt(24) lgkmcnt(0)
  s_barrier
  ds_read_b64_tr_b16 v[112:113], v14 offset:0
  ds_read_b64_tr_b16 v[114:115], v14 offset:512
  ds_read_b64_tr_b16 v[116:117], v14 offset:4096
  ds_read_b64_tr_b16 v[118:119], v14 offset:4608
  ds_read_b64_tr_b16 v[120:121], v15 offset:0
  ds_read_b64_tr_b16 v[122:123], v15 offset:512
  ds_read_b64_tr_b16 v[124:125], v15 offset:4096
  ds_read_b64_tr_b16 v[126:127], v15 offset:4608
  s_waitcnt vmcnt(20) lgkmcnt(0)
  s_barrier
  ds_read_b64_tr_b16 v[128:129], v14 offset:8192
  ds_read_b64_tr_b16 v[130:131], v14 offset:8704
  ds_read_b64_tr_b16 v[132:133], v14 offset:12288
  ds_read_b64_tr_b16 v[134:135], v14 offset:12800
  ds_read_b64_tr_b16 v[136:137], v15 offset:8192
  ds_read_b64_tr_b16 v[138:139], v15 offset:8704
  ds_read_b64_tr_b16 v[140:141], v15 offset:12288
  ds_read_b64_tr_b16 v[142:143], v15 offset:12800
  s_add_u32 m0, s36, 0
  s_mov_b32 s37, 0x380000
  buffer_load_dwordx4 v12, s[12:15], s37 offen  lds
  s_add_u32 m0, s36, 1024
  s_mov_b32 s37, 0x390000
  buffer_load_dwordx4 v13, s[12:15], s37 offen  lds
  s_add_u32 m0, s36, 2048
  s_mov_b32 s37, 0x3a0000
  buffer_load_dwordx4 v12, s[12:15], s37 offen  lds
  s_add_u32 m0, s36, 3072
  s_mov_b32 s37, 0x3b0000
  buffer_load_dwordx4 v13, s[12:15], s37 offen  lds
  s_waitcnt vmcnt(20) lgkmcnt(0)
  s_barrier
  ds_read_b64_tr_b16 v[144:145], v14 offset:16384
  ds_read_b64_tr_b16 v[146:147], v14 offset:16896
  ds_read_b64_tr_b16 v[148:149], v14 offset:20480
  ds_read_b64_tr_b16 v[150:151], v14 offset:20992
  ds_read_b64_tr_b16 v[152:153], v15 offset:16384
  ds_read_b64_tr_b16 v[154:155], v15 offset:16896
  ds_read_b64_tr_b16 v[156:157], v15 offset:20480
  ds_read_b64_tr_b16 v[158:159], v15 offset:20992
  s_add_u32 m0, s36, 8192
  s_mov_b32 s37, 0x400000
  buffer_load_dwordx4 v12, s[12:15], s37 offen  lds
  s_add_u32 m0, s36, 9216
  s_mov_b32 s37, 0x410000
  buffer_load_dwordx4 v13, s[12:15], s37 offen  lds
  s_add_u32 m0, s36, 10240
  s_mov_b32 s37, 0x420000
  buffer_load_dwordx4 v12, s[12:15], s37 offen  lds
  s_add_u32 m0, s36, 11264
  s_mov_b32 s37, 0x430000
  buffer_load_dwordx4 v13, s[12:15], s37 offen  lds
  s_waitcnt vmcnt(20) lgkmcnt(0)
  s_barrier
  ds_read_b64_tr_b16 v[160:161], v14 offset:24576
  ds_read_b64_tr_b16 v[162:163], v14 offset:25088
  ds_read_b64_tr_b16 v[164:165], v14 offset:28672
  ds_read_b64_tr_b16 v[166:167], v14 offset:29184
  ds_read_b64_tr_b16 v[168:169], v15 offset:24576
  ds_read_b64_tr_b16 v[170:171], v15 offset:25088
  ds_read_b64_tr_b16 v[172:173], v15 offset:28672
  ds_read_b64_tr_b16 v[174:175], v15 offset:29184
  s_waitcnt vmcnt(16) lgkmcnt(0)
  s_barrier
  ds_read_b64_tr_b16 v[176:177], v14 offset:32768
  ds_read_b64_tr_b16 v[178:179], v14 offset:33280
  ds_read_b64_tr_b16 v[180:181], v14 offset:36864
  ds_read_b64_tr_b16 v[182:183], v14 offset:37376
  ds_read_b64_tr_b16 v[184:185], v15 offset:32768
  ds_read_b64_tr_b16 v[186:187], v15 offset:33280
  ds_read_b64_tr_b16 v[188:189], v15 offset:36864
  ds_read_b64_tr_b16 v[190:191], v15 offset:37376
  s_waitcnt vmcnt(12) lgkmcnt(0)
  s_barrier
  ds_read_b64_tr_b16 v[192:193], v14 offset:40960
  ds_read_b64_tr_b16 v[194:195], v14 offset:41472
  ds_read_b64_tr_b16 v[196:197], v14 offset:45056
  ds_read_b64_tr_b16 v[198:199], v14 offset:45568
  ds_read_b64_tr_b16 v[200:201], v15 offset:40960
  ds_read_b64_tr_b16 v[202:203], v15 offset:41472
  ds_read_b64_tr_b16 v[204:205], v15 offset:45056
  ds_read_b64_tr_b16 v[206:207], v15 offset:45568
  s_waitcnt vmcnt(8) lgkmcnt(0)
  s_barrier
  ds_read_b64_tr_b16 v[208:209], v14 offset:49152
  ds_read_b64_tr_b16 v[210:211], v14 offset:49664
  ds_read_b64_tr_b16 v[212:213], v14 offset:53248
  ds_read_b64_tr_b16 v[214:215], v14 offset:53760
  ds_read_b64_tr_b16 v[216:217], v15 offset:49152
  ds_read_b64_tr_b16 v[218:219], v15 offset:49664
  ds_read_b64_tr_b16 v[220:221], v15 offset:53248
  ds_read_b64_tr_b16 v[222:223], v15 offset:53760
  s_waitcnt vmcnt(4) lgkmcnt(0)
  s_barrier
  ds_read_b64_tr_b16 v[224:225], v14 offset:0
  ds_read_b64_tr_b16 v[226:227], v14 offset:512
  ds_read_b64_tr_b16 v[228:229], v14 offset:4096
  ds_read_b64_tr_b16 v[230:231], v14 offset:4608
  ds_read_b64_tr_b16 v[232:233], v15 offset:0
  ds_read_b64_tr_b16 v[234:235], v15 offset:512
  ds_read_b64_tr_b16 v[236:237], v15 offset:4096
  ds_read_b64_tr_b16 v[238:239], v15 offset:4608
  s_waitcnt vmcnt(0) lgkmcnt(0)
  s_barrier
  ds_read_b64_tr_b16 v[240:241], v14 offset:8192
  ds_read_b64_tr_b16 v[242:243], v14 offset:8704
  ds_read_b64_tr_b16 v[244:245], v14 offset:12288
  ds_read_b64_tr_b16 v[246:247], v14 offset:12800
  ds_read_b64_tr_b16 v[248:249], v15 offset:8192
  ds_read_b64_tr_b16 v[250:251], v15 offset:8704
  ds_read_b64_tr_b16 v[252:253], v15 offset:12288
  ds_read_b64_tr_b16 v[254:255], v15 offset:12800
  s_waitcnt lgkmcnt(0)
  s_barrier
L_pa_proj:
  s_mul_i32 s37, s39, 36864
  s_mul_i32 s33, s30, 9216
  s_add_u32 s33, s33, s40
  s_add_u32 m0, s33, 0
  s_nop 0
  buffer_load_dwordx4 v2, s[24:27], s37 offen lds
  s_add_u32 s37, s37, 64
  s_add_u32 m0, s33, 1024
  s_nop 0
  buffer_load_dwordx4 v2, s[24:27], s37 offen lds
  s_add_u32 s37, s37, 64
  s_add_u32 m0, s33, 2048
  s_nop 0
  buffer_load_dwordx4 v2, s[24:27], s37 offen lds
  s_add_u32 s37, s37, 64
  s_add_u32 m0, s33, 3072
  s_nop 0
  buffer_load_dwordx4 v2, s[24:27], s37 offen lds
  s_add_u32 s37, s37, 64
  s_add_u32 m0, s33, 4096
  s_nop 0
  buffer_load_dwordx4 v2, s[24:27], s37 offen lds
  s_add_u32 s37, s37, 64
  s_add_u32 m0, s33, 5120
  s_nop 0
  buffer_load_dwordx4 v2, s[24:27], s37 offen lds
  s_add_u32 s37, s37, 64
  s_add_u32 m0, s33, 6144
  s_nop 0
  buffer_load_dwordx4 v2, s[24:27], s37 offen lds
  s_add_u32 s37, s37, 64
  s_add_u32 m0, s33, 7168
  s_nop 0
  buffer_load_dwordx4 v2, s[24:27], s37 offen lds
  s_add_u32 s37, s37, 64
  s_add_u32 m0, s33, 8192
  s_nop 0
  buffer_load_dwordx4 v2, s[24:27], s37 offen lds
  s_add_u32 s39, s39, 4
  s_min_u32 s39, s39, 63
  s_xor_b32 s40, s40, 36864
  ds_read_b128 v[64:67], v10 offset:0
  ds_read_b128 v[68:71], v10 offset:18432
  s_waitcnt lgkmcnt(1)
  v_mfma_f32_16x16x32_bf16 v[16:19], v[112:115], v[64:67], 0
  s_waitcnt lgkmcnt(0)
  v_mfma_f32_16x16x32_bf16 v[20:23], v[112:115], v[68:71], 0
  ds_read_b128 v[72:75], v10 offset:1024
  ds_read_b128 v[76:79], v10 offset:19456
  v_mfma_f32_16x16x32_bf16 v[24:27], v[120:123], v[64:67], 0
  v_mfma_f32_16x16x32_bf16 v[28:31], v[120:123], v[68:71], 0
  v_mfma_f32_16x16x32_bf16 v[32:35], a[0:3], v[64:67], 0
  v_mfma_f32_16x16x32_bf16 v[36:39], a[0:3], v[68:71], 0
  v_mfma_f32_16x16x32_bf16 v[40:43], a[8:11], v[64:67], 0
  v_mfma_f32_16x16x32_bf16 v[44:47], a[8:11], v[68:71], 0
  v_mfma_f32_16x16x32_bf16 v[48:51], v[64:67], a[16:19], 0
  v_mfma_f32_16x16x32_bf16 v[52:55], v[68:71], a[16:19], 0
  v_mfma_f32_16x16x32_bf16 v[56:59], v[64:67], a[24:27], 0
  v_mfma_f32_16x16x32_bf16 v[60:63], v[68:71], a[24:27], 0
  s_waitcnt lgkmcnt(1)
  v_mfma_f32_16x16x32_bf16 v[16:19], v[116:119], v[72:75], v[16:19]
  s_waitcnt lgkmcnt(0)
  v_mfma_f32_16x16x32_bf16 v[20:23], v[116:119], v[76:79], v[20:23]
  ds_read_b128 v[64:67], v10 offset:2048
  ds_read_b128 v[68:71], v10 offset:20480
  v_mfma_f32_16x16x32_bf16 v[24:27], v[124:127], v[72:75], v[24:27]
  v_mfma_f32_16x16x32_bf16 v[28:31], v[124:127], v[76:79], v[28:31]
  v_mfma_f32_16x16x32_bf16 v[32:35], a[4:7], v[72:75], v[32:35]
  v_mfma_f32_16x16x32_bf16 v[36:39], a[4:7], v[76:79], v[36:39]
  v_mfma_f32_16x16x32_bf16 v[40:43], a[12:15], v[72:75], v[40:43]
  v_mfma_f32_16x16x32_bf16 v[44:47], a[12:15], v[76:79], v[44:47]
  v_mfma_f32_16x16x32_bf16 v[48:51], v[72:75], a[20:23], v[48:51]
  v_mfma_f32_16x16x32_bf16 v[52:55], v[76:79], a[20:23], v[52:55]
  v_mfma_f32_16x16x32_bf16 v[56:59], v[72:75], a[28:31], v[56:59]
  v_mfma_f32_16x16x32_bf16 v[60:63], v[76:79], a[28:31], v[60:63]
  s_waitcnt lgkmcnt(1)
  v_mfma_f32_16x16x32_bf16 v[16:19], v[128:131], v[64:67], v[16:19]
  s_waitcnt lgkmcnt(0)
  v_mfma_f32_16x16x32_bf16 v[20:23], v[128:131], v[68:71], v[20:23]
  ds_read_b128 v[72:75], v10 offset:3072
  ds_read_b128 v[76:79], v10 offset:21504
  v_mfma_f32_16x16x32_bf16 v[24:27], v[136:139], v[64:67], v[24:27]
  v_mfma_f32_16x16x32_bf16 v[28:31], v[136:139], v[68:71], v[28:31]
  v_mfma_f32_16x16x32_bf16 v[32:35], a[32:35], v[64:67], v[32:35]
  v_mfma_f32_16x16x32_bf16 v[36:39], a[32:35], v[68:71], v[36:39]
  v_mfma_f32_16x16x32_bf16 v[40:43], a[40:43], v[64:67], v[40:43]
  v_mfma_f32_16x16x32_bf16 v[44:47], a[40:43], v[68:71], v[44:47]
  v_mfma_f32_16x16x32_bf16 v[48:51], v[64:67], a[48:51], v[48:51]
  v_mfma_f32_16x16x32_bf16 v[52:55], v[68:71], a[48:51], v[52:55]
  v_mfma_f32_16x16x32_bf16 v[56:59], v[64:67], a[56:59], v[56:59]
  v_mfma_f32_16x16x32_bf16 v[60:63], v[68:71], a[56:59], v[60:63]
  s_waitcnt lgkmcnt(1)
  v_mfma_f32_16x16x32_bf16 v[16:19], v[132:135], v[72:75], v[16:19]
  s_waitcnt lgkmcnt(0)
  v_mfma_f32_16x16x32_bf16 v[20:23], v[132:135], v[76:79], v[20:23]
  ds_read_b128 v[64:67], v10 offset:4096
  ds_read_b128 v[68:71], v10 offset:22528
  v_mfma_f32_16x16x32_bf16 v[24:27], v[140:143], v[72:75], v[24:27]
  v_mfma_f32_16x16x32_bf16 v[28:31], v[140:143], v[76:79], v[28:31]
  v_mfma_f32_16x16x32_bf16 v[32:35], a[36:39], v[72:75], v[32:35]
  v_mfma_f32_16x16x32_bf16 v[36:39], a[36:39], v[76:79], v[36:39]
  v_mfma_f32_16x16x32_bf16 v[40:43], a[44:47], v[72:75], v[40:43]
  v_mfma_f32_16x16x32_bf16 v[44:47], a[44:47], v[76:79], v[44:47]
  v_mfma_f32_16x16x32_bf16 v[48:51], v[72:75], a[52:55], v[48:51]
  v_mfma_f32_16x16x32_bf16 v[52:55], v[76:79], a[52:55], v[52:55]
  v_mfma_f32_16x16x32_bf16 v[56:59], v[72:75], a[60:63], v[56:59]
  v_mfma_f32_16x16x32_bf16 v[60:63], v[76:79], a[60:63], v[60:63]
  s_waitcnt lgkmcnt(1)
  v_mfma_f32_16x16x32_bf16 v[16:19], v[144:147], v[64:67], v[16:19]
  s_waitcnt lgkmcnt(0)
  v_mfma_f32_16x16x32_bf16 v[20:23], v[144:147], v[68:71], v[20:23]
  ds_read_b128 v[72:75], v10 offset:5120
  ds_read_b128 v[76:79], v10 offset:23552
  v_mfma_f32_16x16x32_bf16 v[24:27], v[152:155], v[64:67], v[24:27]
  v_mfma_f32_16x16x32_bf16 v[28:31], v[152:155], v[68:71], v[28:31]
  v_mfma_f32_16x16x32_bf16 v[32:35], a[64:67], v[64:67], v[32:35]
  v_mfma_f32_16x16x32_bf16 v[36:39], a[64:67], v[68:71], v[36:39]
  v_mfma_f32_16x16x32_bf16 v[40:43], a[72:75], v[64:67], v[40:43]
  v_mfma_f32_16x16x32_bf16 v[44:47], a[72:75], v[68:71], v[44:47]
  v_mfma_f32_16x16x32_bf16 v[48:51], v[64:67], a[80:83], v[48:51]
  v_mfma_f32_16x16x32_bf16 v[52:55], v[68:71], a[80:83], v[52:55]
  v_mfma_f32_16x16x32_bf16 v[56:59], v[64:67], a[88:91], v[56:59]
  v_mfma_f32_16x16x32_bf16 v[60:63], v[68:71], a[88:91], v[60:63]
  s_waitcnt lgkmcnt(1)
  v_mfma_f32_16x16x32_bf16 v[16:19], v[148:151], v[72:75], v[16:19]
  s_waitcnt lgkmcnt(0)
  v_mfma_f32_16x16x32_bf16 v[20:23], v[148:151], v[76:79], v[20:23]
  ds_read_b128 v[64:67], v10 offset:6144
  ds_read_b128 v[68:71], v10 offset:24576
  v_mfma_f32_16x16x32_bf16 v[24:27], v[156:159], v[72:75], v[24:27]
  v_mfma_f32_16x16x32_bf16 v[28:31], v[156:159], v[76:79], v[28:31]
  v_mfma_f32_16x16x32_bf16 v[32:35], a[68:71], v[72:75], v[32:35]
  v_mfma_f32_16x16x32_bf16 v[36:39], a[68:71], v[76:79], v[36:39]
  v_mfma_f32_16x16x32_bf16 v[40:43], a[76:79], v[72:75], v[40:43]
  v_mfma_f32_16x16x32_bf16 v[44:47], a[76:79], v[76:79], v[44:47]
  v_mfma_f32_16x16x32_bf16 v[48:51], v[72:75], a[84:87], v[48:51]
  v_mfma_f32_16x16x32_bf16 v[52:55], v[76:79], a[84:87], v[52:55]
  v_mfma_f32_16x16x32_bf16 v[56:59], v[72:75], a[92:95], v[56:59]
  v_mfma_f32_16x16x32_bf16 v[60:63], v[76:79], a[92:95], v[60:63]
  s_waitcnt lgkmcnt(1)
  v_mfma_f32_16x16x32_bf16 v[16:19], v[160:163], v[64:67], v[16:19]
  s_waitcnt lgkmcnt(0)
  v_mfma_f32_16x16x32_bf16 v[20:23], v[160:163], v[68:71], v[20:23]
  ds_read_b128 v[72:75], v10 offset:7168
  ds_read_b128 v[76:79], v10 offset:25600
  v_mfma_f32_16x16x32_bf16 v[24:27], v[168:171], v[64:67], v[24:27]
  v_mfma_f32_16x16x32_bf16 v[28:31], v[168:171], v[68:71], v[28:31]
  v_mfma_f32_16x16x32_bf16 v[32:35], a[96:99], v[64:67], v[32:35]
  v_mfma_f32_16x16x32_bf16 v[36:39], a[96:99], v[68:71], v[36:39]
  v_mfma_f32_16x16x32_bf16 v[40:43], a[104:107], v[64:67], v[40:43]
  v_mfma_f32_16x16x32_bf16 v[44:47], a[104:107], v[68:71], v[44:47]
  v_mfma_f32_16x16x32_bf16 v[48:51], v[64:67], a[112:115], v[48:51]
  v_mfma_f32_16x16x32_bf16 v[52:55], v[68:71], a[112:115], v[52:55]
  v_mfma_f32_16x16x32_bf16 v[56:59], v[64:67], a[120:123], v[56:59]
  v_mfma_f32_16x16x32_bf16 v[60:63], v[68:71], a[120:123], v[60:63]
  s_waitcnt lgkmcnt(1)
  v_mfma_f32_16x16x32_bf16 v[16:19], v[164:167], v[72:75], v[16:19]
  s_waitcnt lgkmcnt(0)
  v_mfma_f32_16x16x32_bf16 v[20:23], v[164:167], v[76:79], v[20:23]
  ds_read_b128 v[64:67], v10 offset:8192
  ds_read_b128 v[68:71], v10 offset:26624
  v_mfma_f32_16x16x32_bf16 v[24:27], v[172:175], v[72:75], v[24:27]
  v_mfma_f32_16x16x32_bf16 v[28:31], v[172:175], v[76:79], v[28:31]
  v_mfma_f32_16x16x32_bf16 v[32:35], a[100:103], v[72:75], v[32:35]
  v_mfma_f32_16x16x32_bf16 v[36:39], a[100:103], v[76:79], v[36:39]
  v_mfma_f32_16x16x32_bf16 v[40:43], a[108:111], v[72:75], v[40:43]
  v_mfma_f32_16x16x32_bf16 v[44:47], a[108:111], v[76:79], v[44:47]
  v_mfma_f32_16x16x32_bf16 v[48:51], v[72:75], a[116:119], v[48:51]
  v_mfma_f32_16x16x32_bf16 v[52:55], v[76:79], a[116:119], v[52:55]
  v_mfma_f32_16x16x32_bf16 v[56:59], v[72:75], a[124:127], v[56:59]
  v_mfma_f32_16x16x32_bf16 v[60:63], v[76:79], a[124:127], v[60:63]
  s_waitcnt lgkmcnt(1)
  v_mfma_f32_16x16x32_bf16 v[16:19], v[176:179], v[64:67], v[16:19]
  s_waitcnt lgkmcnt(0)
  v_mfma_f32_16x16x32_bf16 v[20:23], v[176:179], v[68:71], v[20:23]
  ds_read_b128 v[72:75], v10 offset:9216
  ds_read_b128 v[76:79], v10 offset:27648
  v_mfma_f32_16x16x32_bf16 v[24:27], v[184:187], v[64:67], v[24:27]
  v_mfma_f32_16x16x32_bf16 v[28:31], v[184:187], v[68:71], v[28:31]
  v_mfma_f32_16x16x32_bf16 v[32:35], a[128:131], v[64:67], v[32:35]
  v_mfma_f32_16x16x32_bf16 v[36:39], a[128:131], v[68:71], v[36:39]
  v_mfma_f32_16x16x32_bf16 v[40:43], a[136:139], v[64:67], v[40:43]
  v_mfma_f32_16x16x32_bf16 v[44:47], a[136:139], v[68:71], v[44:47]
  v_mfma_f32_16x16x32_bf16 v[48:51], v[64:67], a[144:147], v[48:51]
  v_mfma_f32_16x16x32_bf16 v[52:55], v[68:71], a[144:147], v[52:55]
  v_mfma_f32_16x16x32_bf16 v[56:59], v[64:67], a[152:155], v[56:59]
  v_mfma_f32_16x16x32_bf16 v[60:63], v[68:71], a[152:155], v[60:63]
  s_waitcnt lgkmcnt(1)
  v_mfma_f32_16x16x32_bf16 v[16:19], v[180:183], v[72:75], v[16:19]
  s_waitcnt lgkmcnt(0)
  v_mfma_f32_16x16x32_bf16 v[20:23], v[180:183], v[76:79], v[20:23]
  ds_read_b128 v[64:67], v10 offset:10240
  ds_read_b128 v[68:71], v10 offset:28672
  v_mfma_f32_16x16x32_bf16 v[24:27], v[188:191], v[72:75], v[24:27]
  v_mfma_f32_16x16x32_bf16 v[28:31], v[188:191], v[76:79], v[28:31]
  v_mfma_f32_16x16x32_bf16 v[32:35], a[132:135], v[72:75], v[32:35]
  v_mfma_f32_16x16x32_bf16 v[36:39], a[132:135], v[76:79], v[36:39]
  v_mfma_f32_16x16x32_bf16 v[40:43], a[140:143], v[72:75], v[40:43]
  v_mfma_f32_16x16x32_bf16 v[44:47], a[140:143], v[76:79], v[44:47]
  v_mfma_f32_16x16x32_bf16 v[48:51], v[72:75], a[148:151], v[48:51]
  v_mfma_f32_16x16x32_bf16 v[52:55], v[76:79], a[148:151], v[52:55]
  v_mfma_f32_16x16x32_bf16 v[56:59], v[72:75], a[156:159], v[56:59]
  v_mfma_f32_16x16x32_bf16 v[60:63], v[76:79], a[156:159], v[60:63]
  s_waitcnt lgkmcnt(1)
  v_mfma_f32_16x16x32_bf16 v[16:19], v[192:195], v[64:67], v[16:19]
  s_waitcnt lgkmcnt(0)
  v_mfma_f32_16x16x32_bf16 v[20:23], v[192:195], v[68:71], v[20:23]
  ds_read_b128 v[72:75], v10 offset:11264
  ds_read_b128 v[76:79], v10 offset:29696
  v_mfma_f32_16x16x32_bf16 v[24:27], v[200:203], v[64:67], v[24:27]
  v_mfma_f32_16x16x32_bf16 v[28:31], v[200:203], v[68:71], v[28:31]
  v_mfma_f32_16x16x32_bf16 v[32:35], a[160:163], v[64:67], v[32:35]
  v_mfma_f32_16x16x32_bf16 v[36:39], a[160:163], v[68:71], v[36:39]
  v_mfma_f32_16x16x32_bf16 v[40:43], a[168:171], v[64:67], v[40:43]
  v_mfma_f32_16x16x32_bf16 v[44:47], a[168:171], v[68:71], v[44:47]
  v_mfma_f32_16x16x32_bf16 v[48:51], v[64:67], a[176:179], v[48:51]
  v_mfma_f32_16x16x32_bf16 v[52:55], v[68:71], a[176:179], v[52:55]
  v_mfma_f32_16x16x32_bf16 v[56:59], v[64:67], a[184:187], v[56:59]
  v_mfma_f32_16x16x32_bf16 v[60:63], v[68:71], a[184:187], v[60:63]
  s_waitcnt lgkmcnt(1)
  v_mfma_f32_16x16x32_bf16 v[16:19], v[196:199], v[72:75], v[16:19]
  s_waitcnt lgkmcnt(0)
  v_mfma_f32_16x16x32_bf16 v[20:23], v[196:199], v[76:79], v[20:23]
  ds_read_b128 v[64:67], v10 offset:12288
  ds_read_b128 v[68:71], v10 offset:30720
  v_mfma_f32_16x16x32_bf16 v[24:27], v[204:207], v[72:75], v[24:27]
  v_mfma_f32_16x16x32_bf16 v[28:31], v[204:207], v[76:79], v[28:31]
  v_mfma_f32_16x16x32_bf16 v[32:35], a[164:167], v[72:75], v[32:35]
  v_mfma_f32_16x16x32_bf16 v[36:39], a[164:167], v[76:79], v[36:39]
  v_mfma_f32_16x16x32_bf16 v[40:43], a[172:175], v[72:75], v[40:43]
  v_mfma_f32_16x16x32_bf16 v[44:47], a[172:175], v[76:79], v[44:47]
  v_mfma_f32_16x16x32_bf16 v[48:51], v[72:75], a[180:183], v[48:51]
  v_mfma_f32_16x16x32_bf16 v[52:55], v[76:79], a[180:183], v[52:55]
  v_mfma_f32_16x16x32_bf16 v[56:59], v[72:75], a[188:191], v[56:59]
  v_mfma_f32_16x16x32_bf16 v[60:63], v[76:79], a[188:191], v[60:63]
  s_waitcnt lgkmcnt(1)
  v_mfma_f32_16x16x32_bf16 v[16:19], v[208:211], v[64:67], v[16:19]
  s_waitcnt lgkmcnt(0)
  v_mfma_f32_16x16x32_bf16 v[20:23], v[208:211], v[68:71], v[20:23]
  ds_read_b128 v[72:75], v10 offset:13312
  ds_read_b128 v[76:79], v10 offset:31744
  v_mfma_f32_16x16x32_bf16 v[24:27], v[216:219], v[64:67], v[24:27]
  v_mfma_f32_16x16x32_bf16 v[28:31], v[216:219], v[68:71], v[28:31]
  v_mfma_f32_16x16x32_bf16 v[32:35], a[192:195], v[64:67], v[32:35]
  v_mfma_f32_16x16x32_bf16 v[36:39], a[192:195], v[68:71], v[36:39]
  v_mfma_f32_16x16x32_bf16 v[40:43], a[200:203], v[64:67], v[40:43]
  v_mfma_f32_16x16x32_bf16 v[44:47], a[200:203], v[68:71], v[44:47]
  v_mfma_f32_16x16x32_bf16 v[48:51], v[64:67], a[208:211], v[48:51]
  v_mfma_f32_16x16x32_bf16 v[52:55], v[68:71], a[208:211], v[52:55]
  v_mfma_f32_16x16x32_bf16 v[56:59], v[64:67], a[216:219], v[56:59]
  v_mfma_f32_16x16x32_bf16 v[60:63], v[68:71], a[216:219], v[60:63]
  s_waitcnt lgkmcnt(1)
  v_mfma_f32_16x16x32_bf16 v[16:19], v[212:215], v[72:75], v[16:19]
  s_waitcnt lgkmcnt(0)
  v_mfma_f32_16x16x32_bf16 v[20:23], v[212:215], v[76:79], v[20:23]
  ds_read_b128 v[64:67], v10 offset:14336
  ds_read_b128 v[68:71], v10 offset:32768
  v_mfma_f32_16x16x32_bf16 v[24:27], v[220:223], v[72:75], v[24:27]
  v_mfma_f32_16x16x32_bf16 v[28:31], v[220:223], v[76:79], v[28:31]
  v_mfma_f32_16x16x32_bf16 v[32:35], a[196:199], v[72:75], v[32:35]
  v_mfma_f32_16x16x32_bf16 v[36:39], a[196:199], v[76:79], v[36:39]
  v_mfma_f32_16x16x32_bf16 v[40:43], a[204:207], v[72:75], v[40:43]
  v_mfma_f32_16x16x32_bf16 v[44:47], a[204:207], v[76:79], v[44:47]
  v_mfma_f32_16x16x32_bf16 v[48:51], v[72:75], a[212:215], v[48:51]
  v_mfma_f32_16x16x32_bf16 v[52:55], v[76:79], a[212:215], v[52:55]
  v_mfma_f32_16x16x32_bf16 v[56:59], v[72:75], a[220:223], v[56:59]
  v_mfma_f32_16x16x32_bf16 v[60:63], v[76:79], a[220:223], v[60:63]
  s_waitcnt lgkmcnt(1)
  v_mfma_f32_16x16x32_bf16 v[16:19], v[224:227], v[64:67], v[16:19]
  s_waitcnt lgkmcnt(0)
  v_mfma_f32_16x16x32_bf16 v[20:23], v[224:227], v[68:71], v[20:23]
  ds_read_b128 v[72:75], v10 offset:15360
  ds_read_b128 v[76:79], v10 offset:33792
  v_mfma_f32_16x16x32_bf16 v[24:27], v[232:235], v[64:67], v[24:27]
  v_mfma_f32_16x16x32_bf16 v[28:31], v[232:235], v[68:71], v[28:31]
  v_mfma_f32_16x16x32_bf16 v[32:35], a[224:227], v[64:67], v[32:35]
  v_mfma_f32_16x16x32_bf16 v[36:39], a[224:227], v[68:71], v[36:39]
  v_mfma_f32_16x16x32_bf16 v[40:43], a[232:235], v[64:67], v[40:43]
  v_mfma_f32_16x16x32_bf16 v[44:47], a[232:235], v[68:71], v[44:47]
  v_mfma_f32_16x16x32_bf16 v[48:51], v[64:67], a[240:243], v[48:51]
  v_mfma_f32_16x16x32_bf16 v[52:55], v[68:71], a[240:243], v[52:55]
  v_mfma_f32_16x16x32_bf16 v[56:59], v[64:67], a[248:251], v[56:59]
  v_mfma_f32_16x16x32_bf16 v[60:63], v[68:71], a[248:251], v[60:63]
  s_waitcnt lgkmcnt(1)
  v_mfma_f32_16x16x32_bf16 v[16:19], v[228:231], v[72:75], v[16:19]
  s_waitcnt lgkmcnt(0)
  v_mfma_f32_16x16x32_bf16 v[20:23], v[228:231], v[76:79], v[20:23]
  ds_read_b128 v[64:67], v10 offset:16384
  ds_read_b128 v[68:71], v10 offset:34816
  v_mfma_f32_16x16x32_bf16 v[24:27], v[236:239], v[72:75], v[24:27]
  v_mfma_f32_16x16x32_bf16 v[28:31], v[236:239], v[76:79], v[28:31]
  v_mfma_f32_16x16x32_bf16 v[32:35], a[228:231], v[72:75], v[32:35]
  v_mfma_f32_16x16x32_bf16 v[36:39], a[228:231], v[76:79], v[36:39]
  v_mfma_f32_16x16x32_bf16 v[40:43], a[236:239], v[72:75], v[40:43]
  v_mfma_f32_16x16x32_bf16 v[44:47], a[236:239], v[76:79], v[44:47]
  v_mfma_f32_16x16x32_bf16 v[48:51], v[72:75], a[244:247], v[48:51]
  v_mfma_f32_16x16x32_bf16 v[52:55], v[76:79], a[244:247], v[52:55]
  v_mfma_f32_16x16x32_bf16 v[56:59], v[72:75], a[252:255], v[56:59]
  v_mfma_f32_16x16x32_bf16 v[60:63], v[76:79], a[252:255], v[60:63]
  s_waitcnt lgkmcnt(1)
  v_mfma_f32_16x16x32_bf16 v[16:19], v[240:243], v[64:67], v[16:19]
  s_waitcnt lgkmcnt(0)
  v_mfma_f32_16x16x32_bf16 v[20:23], v[240:243], v[68:71], v[20:23]
  ds_read_b128 v[72:75], v10 offset:17408
  ds_read_b128 v[76:79], v10 offset:35840
  v_mfma_f32_16x16x32_bf16 v[24:27], v[248:251], v[64:67], v[24:27]
  v_mfma_f32_16x16x32_bf16 v[28:31], v[248:251], v[68:71], v[28:31]
  v_mfma_f32_16x16x32_bf16 v[32:35], v[80:83], v[64:67], v[32:35]
  v_mfma_f32_16x16x32_bf16 v[36:39], v[80:83], v[68:71], v[36:39]
  v_mfma_f32_16x16x32_bf16 v[40:43], v[88:91], v[64:67], v[40:43]
  v_mfma_f32_16x16x32_bf16 v[44:47], v[88:91], v[68:71], v[44:47]
  v_mfma_f32_16x16x32_bf16 v[48:51], v[64:67], v[96:99], v[48:51]
  v_mfma_f32_16x16x32_bf16 v[52:55], v[68:71], v[96:99], v[52:55]
  v_mfma_f32_16x16x32_bf16 v[56:59], v[64:67], v[104:107], v[56:59]
  v_mfma_f32_16x16x32_bf16 v[60:63], v[68:71], v[104:107], v[60:63]
  s_waitcnt lgkmcnt(1)
  v_mfma_f32_16x16x32_bf16 v[16:19], v[244:247], v[72:75], v[16:19]
  s_waitcnt lgkmcnt(0)
  v_mfma_f32_16x16x32_bf16 v[20:23], v[244:247], v[76:79], v[20:23]
  v_mfma_f32_16x16x32_bf16 v[24:27], v[252:255], v[72:75], v[24:27]
  v_mfma_f32_16x16x32_bf16 v[28:31], v[252:255], v[76:79], v[28:31]
  v_mfma_f32_16x16x32_bf16 v[32:35], v[84:87], v[72:75], v[32:35]
  v_mfma_f32_16x16x32_bf16 v[36:39], v[84:87], v[76:79], v[36:39]
  v_mfma_f32_16x16x32_bf16 v[40:43], v[92:95], v[72:75], v[40:43]
  v_mfma_f32_16x16x32_bf16 v[44:47], v[92:95], v[76:79], v[44:47]
  v_mfma_f32_16x16x32_bf16 v[48:51], v[72:75], v[100:103], v[48:51]
  v_mfma_f32_16x16x32_bf16 v[52:55], v[76:79], v[100:103], v[52:55]
  v_mfma_f32_16x16x32_bf16 v[56:59], v[72:75], v[108:111], v[56:59]
  v_mfma_f32_16x16x32_bf16 v[60:63], v[76:79], v[108:111], v[60:63]
  v_cvt_pk_bf16_f32 v64, v16, v17
  v_cvt_pk_bf16_f32 v65, v18, v19
  v_cvt_pk_bf16_f32 v66, v24, v25
  v_cvt_pk_bf16_f32 v67, v26, v27
  ds_write_b128 v3, v[64:67] offset:0
  v_cvt_pk_bf16_f32 v68, v20, v21
  v_cvt_pk_bf16_f32 v69, v22, v23
  v_cvt_pk_bf16_f32 v70, v28, v29
  v_cvt_pk_bf16_f32 v71, v30, v31
  ds_write_b128 v3, v[68:71] offset:4096
  v_cvt_pk_bf16_f32 v72, v32, v33
  v_cvt_pk_bf16_f32 v73, v34, v35
  v_cvt_pk_bf16_f32 v74, v40, v41
  v_cvt_pk_bf16_f32 v75, v42, v43
  ds_write_b128 v3, v[72:75] offset:8192
  buffer_store_dwordx4 v[72:75], v0, s[4:7], s43 offen offset:0 sc1
  v_cvt_pk_bf16_f32 v76, v36, v37
  v_cvt_pk_bf16_f32 v77, v38, v39
  v_cvt_pk_bf16_f32 v78, v44, v45
  v_cvt_pk_bf16_f32 v79, v46, v47
  ds_write_b128 v3, v[76:79] offset:12288
  buffer_store_dwordx4 v[76:79], v0, s[4:7], s43 offen offset:1024 sc1
  v_cvt_pk_bf16_f32 v64, v48, v49
  v_cvt_pk_bf16_f32 v65, v50, v51
  v_cvt_pk_bf16_f32 v66, v52, v53
  v_cvt_pk_bf16_f32 v67, v54, v55
  ds_write_b128 v3, v[64:67] offset:16384
  buffer_store_dwordx4 v[64:67], v0, s[4:7], s43 offen offset:2048 sc1
  v_cvt_pk_bf16_f32 v68, v56, v57
  v_cvt_pk_bf16_f32 v69, v58, v59
  v_cvt_pk_bf16_f32 v70, v60, v61
  v_cvt_pk_bf16_f32 v71, v62, v63
  ds_write_b128 v3, v[68:71] offset:20480
  buffer_store_dwordx4 v[68:71], v0, s[4:7], s43 offen offset:3072 sc1
  v_mov_b64 v[16:17], -1
  v_mov_b64 v[18:19], -1
  buffer_store_dwordx4 v[16:19], v0, s[4:7], s47 offen offset:0 sc1
  buffer_store_dwordx4 v[16:19], v0, s[4:7], s47 offen offset:1024 sc1
  s_waitcnt vmcnt(0) lgkmcnt(0)
  s_barrier
  s_add_u32 s47, s47, 1048576
  buffer_store_dword v1, v9, s[4:7], s44 offen sc1
  s_add_u32 s43, s43, 2097152
  s_add_u32 s44, s44, 16
  v_xor_b32 v10, 36864, v10
  s_bitcmp1_b32 s42, 0
  s_cselect_b32 s37, -1, 1
  s_mul_i32 s37, s37, 24576
  v_add_u32 v3, s37, v3
  s_add_u32 s42, s42, 1
  s_cmp_eq_u32 s42, 1
  s_cbranch_scc1 L_pa_proj
L_pa_att:
  v_add_u32 v11, s41, v0
  v_add_u32 v11, 81920, v11
  ds_read_b128 v[16:19], v4 offset:0
  ds_read_b128 v[20:23], v4 offset:1024
  ds_read_b128 v[24:27], v4 offset:2048
  ds_read_b128 v[28:31], v4 offset:3072
  ds_read_b128 v[32:35], v11 offset:0
  ds_read_b128 v[36:39], v11 offset:1024
  ds_read_b128 v[40:43], v11 offset:2048
  ds_read_b128 v[44:47], v11 offset:3072
  ds_read_b128 v[48:51], v11 offset:4096
  ds_read_b128 v[52:55], v11 offset:5120
  ds_read_b128 v[56:59], v11 offset:6144
  ds_read_b128 v[60:63], v11 offset:7168
  s_waitcnt lgkmcnt(7)
  v_mfma_f32_16x16x32_bf16 v[64:67], v[32:35], v[16:19], 0
  s_waitcnt lgkmcnt(3)
  v_mfma_f32_16x16x32_bf16 v[68:71], v[48:51], v[16:19], 0
  v_mfma_f32_16x16x32_bf16 v[64:67], v[36:39], v[20:23], v[64:67]
  s_waitcnt lgkmcnt(2)
  v_mfma_f32_16x16x32_bf16 v[68:71], v[52:55], v[20:23], v[68:71]
  v_mfma_f32_16x16x32_bf16 v[64:67], v[40:43], v[24:27], v[64:67]
  s_waitcnt lgkmcnt(1)
  v_mfma_f32_16x16x32_bf16 v[68:71], v[56:59], v[24:27], v[68:71]
  v_mfma_f32_16x16x32_bf16 v[64:67], v[44:47], v[28:31], v[64:67]
  s_waitcnt lgkmcnt(0)
  v_mfma_f32_16x16x32_bf16 v[68:71], v[60:63], v[28:31], v[68:71]
  v_mov_b32 v76, 0xd028965f
  v_cmp_gt_i32 vcc, 0, v8
  s_nop 1
  v_cndmask_b32 v64, v64, v76, vcc
  v_cmp_gt_i32 vcc, 1, v8
  s_nop 1
  v_cndmask_b32 v65, v65, v76, vcc
  v_cmp_gt_i32 vcc, 2, v8
  s_nop 1
  v_cndmask_b32 v66, v66, v76, vcc
  v_cmp_gt_i32 vcc, 3, v8
  s_nop 1
  v_cndmask_b32 v67, v67, v76, vcc
  v_cmp_gt_i32 vcc, 16, v8
  s_nop 1
  v_cndmask_b32 v68, v68, v76, vcc
  v_cmp_gt_i32 vcc, 17, v8
  s_nop 1
  v_cndmask_b32 v69, v69, v76, vcc
  v_cmp_gt_i32 vcc, 18, v8
  s_nop 1
  v_cndmask_b32 v70, v70, v76, vcc
  v_cmp_gt_i32 vcc, 19, v8
  s_nop 1
  v_cndmask_b32 v71, v71, v76, vcc
  s_add_u32 s37, s45, 4096
  s_add_u32 s33, s45, 8192
  s_cmp_ge_u32 s42, 17
  s_cbranch_scc1 L_pa_poll
L_pa_doze:
  s_sleep 16
  buffer_load_dword v76, v0, s[4:7], s45 offen sc1
  s_sub_u32 s31, s31, 1
  s_cbranch_scc1 L_exit
  s_waitcnt vmcnt(0)
  v_cmp_eq_u32 vcc, -1, v76
  s_cbranch_vccnz L_pa_doze
L_pa_poll:
  buffer_load_dwordx4 v[16:19], v0, s[4:7], s45 offen offset:0 sc1
  buffer_load_dwordx4 v[20:23], v0, s[4:7], s45 offen offset:1024 sc1
  buffer_load_dwordx4 v[24:27], v0, s[4:7], s45 offen offset:2048 sc1
  buffer_load_dwordx4 v[28:31], v0, s[4:7], s45 offen offset:3072 sc1
  buffer_load_dwordx4 v[32:35], v0, s[4:7], s37 offen offset:0 sc1
  buffer_load_dwordx4 v[36:39], v0, s[4:7], s37 offen offset:1024 sc1
  buffer_load_dwordx4 v[40:43], v0, s[4:7], s37 offen offset:2048 sc1
  buffer_load_dwordx4 v[44:47], v0, s[4:7], s37 offen offset:3072 sc1
  buffer_load_dwordx4 v[48:51], v0, s[4:7], s33 offen offset:0 sc1
  s_sub_u32 s31, s31, 1
  s_cbranch_scc1 L_exit
  v_mov_b64 v[52:53], 0
  v_mov_b64 v[54:55], 0
  v_mov_b64 v[56:57], 0
  v_mov_b64 v[58:59], 0
  v_mov_b64 v[60:61], 0
  v_mov_b64 v[62:63], 0
  v_mov_b64 v[72:73], 0
  v_mov_b64 v[74:75], 0
  s_waitcnt vmcnt(8)
  v_max_u32 v76, v16, v18
  v_cmp_eq_u32 vcc, -1, v76
  s_cbranch_vccnz L_pa_poll
  v_smfmac_f32_16x16x64_bf16 v[52:55], v[16:19], a[0:7], v1
  v_smfmac_f32_16x16x64_bf16 v[56:59], v[16:19], a[8:15], v1
  v_smfmac_f32_16x16x64_bf16 v[60:63], v[16:19], a[16:23], v1
  v_smfmac_f32_16x16x64_bf16 v[72:75], v[16:19], a[24:31], v1
  s_waitcnt vmcnt(7)
  v_smfmac_f32_16x16x64_bf16 v[52:55], v[20:23], a[32:39], v1
  v_max3_u32 v76, v76, v20, v22
  v_smfmac_f32_16x16x64_bf16 v[56:59], v[20:23], a[40:47], v1
  v_smfmac_f32_16x16x64_bf16 v[60:63], v[20:23], a[48:55], v1
  v_smfmac_f32_16x16x64_bf16 v[72:75], v[20:23], a[56:63], v1
  s_waitcnt vmcnt(6)
  v_smfmac_f32_16x16x64_bf16 v[52:55], v[24:27], a[64:71], v1
  v_max3_u32 v76, v76, v24, v26
  v_smfmac_f32_16x16x64_bf16 v[56:59], v[24:27], a[72:79], v1
  v_smfmac_f32_16x16x64_bf16 v[60:63], v[24:27], a[80:87], v1
  v_smfmac_f32_16x16x64_bf16 v[72:75], v[24:27], a[88:95], v1
  s_waitcnt vmcnt(5)
  v_smfmac_f32_16x16x64_bf16 v[52:55], v[28:31], a[96:103], v1
  v_max3_u32 v76, v76, v28, v30
  v_smfmac_f32_16x16x64_bf16 v[56:59], v[28:31], a[104:111], v1
  v_smfmac_f32_16x16x64_bf16 v[60:63], v[28:31], a[112:119], v1
  v_smfmac_f32_16x16x64_bf16 v[72:75], v[28:31], a[120:127], v1
  s_waitcnt vmcnt(4)
  v_smfmac_f32_16x16x64_bf16 v[52:55], v[32:35], a[128:135], v1
  v_max3_u32 v76, v76, v32, v34
  v_smfmac_f32_16x16x64_bf16 v[56:59], v[32:35], a[136:143], v1
  v_smfmac_f32_16x16x64_bf16 v[60:63], v[32:35], a[144:151], v1
  v_smfmac_f32_16x16x64_bf16 v[72:75], v[32:35], a[152:159], v1
  s_waitcnt vmcnt(3)
  v_smfmac_f32_16x16x64_bf16 v[52:55], v[36:39], a[160:167], v1
  v_max3_u32 v76, v76, v36, v38
  v_smfmac_f32_16x16x64_bf16 v[56:59], v[36:39], a[168:175], v1
  v_smfmac_f32_16x16x64_bf16 v[60:63], v[36:39], a[176:183], v1
  v_smfmac_f32_16x16x64_bf16 v[72:75], v[36:39], a[184:191], v1
  s_waitcnt vmcnt(2)
  v_smfmac_f32_16x16x64_bf16 v[52:55], v[40:43], a[192:199], v1
  v_max3_u32 v76, v76, v40, v42
  v_smfmac_f32_16x16x64_bf16 v[56:59], v[40:43], a[200:207], v1
  v_smfmac_f32_16x16x64_bf16 v[60:63], v[40:43], a[208:215], v1
  v_smfmac_f32_16x16x64_bf16 v[72:75], v[40:43], a[216:223], v1
  s_waitcnt vmcnt(1)
  v_smfmac_f32_16x16x64_bf16 v[52:55], v[44:47], a[224:231], v1
  v_max3_u32 v76, v76, v44, v46
  v_smfmac_f32_16x16x64_bf16 v[56:59], v[44:47], a[232:239], v1
  v_smfmac_f32_16x16x64_bf16 v[60:63], v[44:47], a[240:247], v1
  v_smfmac_f32_16x16x64_bf16 v[72:75], v[44:47], a[248:255], v1
  s_waitcnt vmcnt(0)
  v_smfmac_f32_16x16x64_bf16 v[52:55], v[48:51], v[80:87], v1
  v_max3_u32 v76, v76, v48, v50
  v_smfmac_f32_16x16x64_bf16 v[56:59], v[48:51], v[88:95], v1
  v_cmp_eq_u32 vcc, -1, v76
  v_smfmac_f32_16x16x64_bf16 v[60:63], v[48:51], v[96:103], v1
  v_smfmac_f32_16x16x64_bf16 v[72:75], v[48:51], v[104:111], v1
  s_cbranch_vccnz L_pa_poll
  ds_read_b128 v[16:19], v4 offset:0
  ds_read_b128 v[20:23], v4 offset:1024
  ds_read_b128 v[24:27], v4 offset:2048
  ds_read_b128 v[28:31], v4 offset:3072
  v_pk_add_f32 v[52:53], v[52:53], v[54:55]
  v_pk_add_f32 v[60:61], v[60:61], v[62:63]
  v_cvt_pk_bf16_f32 v76, v52, v53
  v_cvt_pk_bf16_f32 v77, v60, v61
  ds_write_b64 v6, v[76:77] offset:0
  v_pk_add_f32 v[56:57], v[56:57], v[58:59]
  v_pk_add_f32 v[72:73], v[72:73], v[74:75]
  v_cvt_pk_bf16_f32 v78, v56, v57
  v_cvt_pk_bf16_f32 v79, v72, v73
  ds_write_b64 v6, v[78:79] offset:512
  ds_read_b128 v[32:35], v5 offset:0
  ds_read_b128 v[36:39], v5 offset:4096
  ds_read_b128 v[40:43], v5 offset:1024
  ds_read_b128 v[44:47], v5 offset:5120
  s_and_b32 s37, s30, 1
  s_lshl_b32 s37, s37, 10
  v_subrev_u32 v11, s37, v6
  s_waitcnt lgkmcnt(4)
  s_barrier
  ds_read_b64_tr_b16 v[48:49], v7 offset:0
  ds_read_b64_tr_b16 v[50:51], v7 offset:512
  ds_read_b64_tr_b16 v[52:53], v7 offset:1024
  ds_read_b64_tr_b16 v[54:55], v7 offset:1536
  ds_read_b64_tr_b16 v[56:57], v7 offset:2048
  ds_read_b64_tr_b16 v[58:59], v7 offset:2560
  ds_read_b64_tr_b16 v[60:61], v7 offset:3072
  ds_read_b64_tr_b16 v[62:63], v7 offset:3584
  ds_read_b32 v12, v11 offset:4
  ds_read_b32 v13, v11 offset:516
  ds_read_b32 v14, v11 offset:1028
  ds_read_b32 v15, v11 offset:1540
  s_waitcnt lgkmcnt(10)
  v_mfma_f32_16x16x32_bf16 v[72:75], v[48:51], v[16:19], 0
  s_waitcnt lgkmcnt(8)
  v_mfma_f32_16x16x32_bf16 v[72:75], v[52:55], v[20:23], v[72:75]
  s_waitcnt lgkmcnt(6)
  v_mfma_f32_16x16x32_bf16 v[72:75], v[56:59], v[24:27], v[72:75]
  s_waitcnt lgkmcnt(4)
  v_mfma_f32_16x16x32_bf16 v[72:75], v[60:63], v[28:31], v[72:75]
  v_max3_f32 v76, v64, v65, v66
  v_max3_f32 v76, v76, v67, v68
  v_max3_f32 v76, v76, v69, v70
  v_max_f32 v76, v76, v71
  s_nop 2
  v_max3_f32 v76, v76, v72, v73
  v_mov_b32 v77, v76
  s_nop 1
  v_permlane16_swap_b32 v77, v76
  v_max_f32 v76, v76, v77
  v_mov_b32 v77, v76
  s_nop 1
  v_permlane32_swap_b32 v77, v76
  v_max_f32 v76, v76, v77
  v_mul_f32 v76, s48, v76
  v_fma_f32 v64, v64, s48, -v76
  v_fma_f32 v65, v65, s48, -v76
  v_fma_f32 v66, v66, s48, -v76
  v_fma_f32 v67, v67, s48, -v76
  v_fma_f32 v68, v68, s48, -v76
  v_fma_f32 v69, v69, s48, -v76
  v_fma_f32 v70, v70, s48, -v76
  v_fma_f32 v71, v71, s48, -v76
  v_fma_f32 v72, v72, s48, -v76
  v_fma_f32 v73, v73, s48, -v76
  v_exp_f32 v64, v64
  v_exp_f32 v65, v65
  v_exp_f32 v66, v66
  v_exp_f32 v67, v67
  v_exp_f32 v68, v68
  v_exp_f32 v69, v69
  v_exp_f32 v70, v70
  v_exp_f32 v71, v71
  v_exp_f32 v72, v72
  v_exp_f32 v73, v73
  v_add_f32 v76, v64, v65
  v_add_f32 v76, v76, v66
  v_add_f32 v76, v76, v67
  v_add_f32 v76, v76, v68
  v_add_f32 v76, v76, v69
  v_add_f32 v76, v76, v70
  v_add_f32 v76, v76, v71
  v_add_f32 v76, v76, v72
  v_add_f32 v76, v76, v73
  v_mov_b32 v77, v76
  s_nop 1
  v_permlane16_swap_b32 v77, v76
  v_add_f32 v76, v76, v77
  v_mov_b32 v77, v76
  s_nop 1
  v_permlane32_swap_b32 v77, v76
  v_add_f32 v76, v76, v77
  v_rcp_f32 v76, v76
  s_nop 0
  v_mul_f32 v64, v64, v76
  v_mul_f32 v65, v65, v76
  v_mul_f32 v66, v66, v76
  v_mul_f32 v67, v67, v76
  v_mul_f32 v68, v68, v76
  v_mul_f32 v69, v69, v76
  v_mul_f32 v70, v70, v76
  v_mul_f32 v71, v71, v76
  v_mul_f32 v72, v72, v76
  v_mul_f32 v73, v73, v76
  v_cvt_pk_bf16_f32 v16, v64, v65
  v_cvt_pk_bf16_f32 v17, v66, v67
  v_cvt_pk_bf16_f32 v18, v68, v69
  v_cvt_pk_bf16_f32 v19, v70, v71
  v_cvt_pk_bf16_f32 v20, v72, v73
  v_mov_b32 v21, 0
  v_mov_b32 v22, 0
  v_mov_b32 v23, v20
  v_mfma_f32_16x16x32_bf16 v[48:51], v[32:35], v[16:19], 0
  v_mfma_f32_16x16x32_bf16 v[52:55], v[36:39], v[16:19], 0
  v_mfma_f32_16x16x32_bf16 v[56:59], v[40:43], v[16:19], 0
  v_mfma_f32_16x16x32_bf16 v[60:63], v[44:47], v[16:19], 0
  s_waitcnt lgkmcnt(2)
  v_mfma_f32_16x16x16_bf16 v[48:51], v[12:13], v[20:21], v[48:51]
  v_mfma_f32_16x16x16_bf16 v[52:55], v[12:13], v[22:23], v[52:55]
  s_waitcnt lgkmcnt(0)
  v_mfma_f32_16x16x16_bf16 v[56:59], v[14:15], v[20:21], v[56:59]
  v_mfma_f32_16x16x16_bf16 v[60:63], v[14:15], v[22:23], v[60:63]
  v_cvt_pk_bf16_f32 v24, v48, v49
  v_cvt_pk_bf16_f32 v25, v50, v51
  v_cvt_pk_bf16_f32 v26, v52, v53
  v_cvt_pk_bf16_f32 v27, v54, v55
  buffer_store_dwordx4 v[24:27], v0, s[4:7], s46 offen offset:0 sc1
  v_cvt_pk_bf16_f32 v28, v56, v57
  v_cvt_pk_bf16_f32 v29, v58, v59
  v_cvt_pk_bf16_f32 v30, v60, v61
  v_cvt_pk_bf16_f32 v31, v62, v63
  buffer_store_dwordx4 v[28:31], v0, s[4:7], s46 offen offset:1024 sc1
  s_barrier
  s_add_u32 s45, s45, 36864
  s_add_u32 s46, s46, 1048576
  s_cmp_eq_u32 s41, 0
  s_cselect_b32 s37, 1, -1
  s_mul_i32 s37, s37, 24576
  s_add_u32 s41, s41, s37
  v_add_u32 v4, s37, v4
  v_add_u32 v5, s37, v5
  s_cmp_lt_u32 s42, 16
  s_cbranch_scc1 L_pa_proj
  s_add_u32 s42, s42, 1
  s_cmp_eq_u32 s42, 17
  s_cbranch_scc1 L_pa_att
  s_branch L_exit
.p2align 6
L_o:
  s_lshl_b32 s34, s29, 6
  s_sub_u32 s37, s28, 5
L_o2:
  s_mov_b32 s12, s74
  s_mov_b32 s13, s75
  s_mov_b32 s14, 0x480000
  s_mov_b32 s15, 0x20000
  s_mov_b32 s16, s64
  s_mov_b32 s17, s65
  s_mov_b32 s18, 0x240000
  s_mov_b32 s19, 0x20000
  s_mov_b32 s20, s90
  s_mov_b32 s21, s91
  s_mov_b32 s22, 0x240000
  s_mov_b32 s23, 0x20000
  v_mov_b32 v15, v0
  v_and_b32 v14, 15, v15
  v_lshrrev_b32 v13, 4, v15
  v_lshlrev_b32 v1, 4, v15
  s_mul_i32 s35, s30, 36864
  s_add_u32 s35, s35, 16384
  v_lshrrev_b32 v12, 2, v15
  v_mul_u32_u24 v5, 1152, v12
  v_and_b32 v11, 3, v15
  v_lshl_add_u32 v5, v11, 4, v5
  s_mul_i32 s36, s30, 1179648
  s_add_u32 s36, s36, s34
  v_add_u32 v5, s36, v5
  v_lshrrev_b32 v12, 2, v14
  v_lshl_add_u32 v12, v13, 2, v12
  v_lshlrev_b32 v12, 6, v12
  v_and_b32 v11, 3, v14
  v_lshl_add_u32 v6, v11, 4, v12
  v_add_u32 v6, s35, v6
  v_mul_u32_u24 v2, 1152, v14
  v_lshl_add_u32 v2, v13, 4, v2
  v_add_u32 v2, s34, v2
  s_lshl_b32 s36, s30, 11
  v_add_u32 v4, s36, v1
  s_mov_b32 s41, 0
  v_and_b32 v7, 7, v15
  s_lshl_b32 s36, s30, 3
  v_add_lshl_u32 v7, v7, s36, 8
  v_and_b32 v8, 31, v15
  v_lshlrev_b32 v8, 10, v8
  v_lshrrev_b32 v12, 5, v15
  v_mul_u32_u24 v12, 1008, v12
  v_add_u32 v8, v8, v12
  s_add_u32 m0, s35, 0
  s_mov_b32 s36, 0
  buffer_load_dwordx4 v5, s[12:15], s36 offen lds
  s_add_u32 m0, s35, 1024
  s_mov_b32 s36, 18432
  buffer_load_dwordx4 v5, s[12:15], s36 offen lds
  s_add_u32 m0, s35, 2048
  s_mov_b32 s36, 36864
  buffer_load_dwordx4 v5, s[12:15], s36 offen lds
  s_add_u32 m0, s35, 3072
  s_mov_b32 s36, 55296
  buffer_load_dwordx4 v5, s[12:15], s36 offen lds
  s_add_u32 m0, s35, 4096
  s_mov_b32 s36, 73728
  buffer_load_dwordx4 v5, s[12:15], s36 offen lds
  s_add_u32 m0, s35, 5120
  s_mov_b32 s36, 92160
  buffer_load_dwordx4 v5, s[12:15], s36 offen lds
  s_add_u32 m0, s35, 6144
  s_mov_b32 s36, 110592
  buffer_load_dwordx4 v5, s[12:15], s36 offen lds
  s_add_u32 m0, s35, 7168
  s_mov_b32 s36, 129024
  buffer_load_dwordx4 v5, s[12:15], s36 offen lds
  s_add_u32 m0, s35, 8192
  s_mov_b32 s36, 147456
  buffer_load_dwordx4 v5, s[12:15], s36 offen lds
  s_add_u32 m0, s35, 9216
  s_mov_b32 s36, 165888
  buffer_load_dwordx4 v5, s[12:15], s36 offen lds
  s_add_u32 m0, s35, 10240
  s_mov_b32 s36, 184320
  buffer_load_dwordx4 v5, s[12:15], s36 offen lds
  s_add_u32 m0, s35, 11264
  s_mov_b32 s36, 202752
  buffer_load_dwordx4 v5, s[12:15], s36 offen lds
  s_add_u32 m0, s35, 12288
  s_mov_b32 s36, 221184
  buffer_load_dwordx4 v5, s[12:15], s36 offen lds
  s_add_u32 m0, s35, 13312
  s_mov_b32 s36, 239616
  buffer_load_dwordx4 v5, s[12:15], s36 offen lds
  s_add_u32 m0, s35, 14336
  s_mov_b32 s36, 258048
  buffer_load_dwordx4 v5, s[12:15], s36 offen lds
  s_add_u32 m0, s35, 15360
  s_mov_b32 s36, 276480
  buffer_load_dwordx4 v5, s[12:15], s36 offen lds
  s_add_u32 m0, s35, 16384
  s_mov_b32 s36, 294912
  buffer_load_dwordx4 v5, s[12:15], s36 offen lds
  s_add_u32 m0, s35, 17408
  s_mov_b32 s36, 313344
  buffer_load_dwordx4 v5, s[12:15], s36 offen lds
  s_add_u32 m0, s35, 18432
  s_mov_b32 s36, 331776
  buffer_load_dwordx4 v5, s[12:15], s36 offen lds
  s_add_u32 m0, s35, 19456
  s_mov_b32 s36, 350208
  buffer_load_dwordx4 v5, s[12:15], s36 offen lds
  s_add_u32 m0, s35, 20480
  s_mov_b32 s36, 368640
  buffer_load_dwordx4 v5, s[12:15], s36 offen lds
  s_add_u32 m0, s35, 21504
  s_mov_b32 s36, 387072
  buffer_load_dwordx4 v5, s[12:15], s36 offen lds
  s_add_u32 m0, s35, 22528
  s_mov_b32 s36, 405504
  buffer_load_dwordx4 v5, s[12:15], s36 offen lds
  s_add_u32 m0, s35, 23552
  s_mov_b32 s36, 423936
  buffer_load_dwordx4 v5, s[12:15], s36 offen lds
  s_add_u32 m0, s35, 24576
  s_mov_b32 s36, 442368
  buffer_load_dwordx4 v5, s[12:15], s36 offen lds
  s_add_u32 m0, s35, 25600
  s_mov_b32 s36, 460800
  buffer_load_dwordx4 v5, s[12:15], s36 offen lds
  s_add_u32 m0, s35, 26624
  s_mov_b32 s36, 479232
  buffer_load_dwordx4 v5, s[12:15], s36 offen lds
  s_add_u32 m0, s35, 27648
  s_mov_b32 s36, 497664
  buffer_load_dwordx4 v5, s[12:15], s36 offen lds
  s_add_u32 m0, s35, 28672
  s_mov_b32 s36, 516096
  buffer_load_dwordx4 v5, s[12:15], s36 offen lds
  s_add_u32 m0, s35, 29696
  s_mov_b32 s36, 534528
  buffer_load_dwordx4 v5, s[12:15], s36 offen lds
  s_add_u32 m0, s35, 30720
  s_mov_b32 s36, 552960
  buffer_load_dwordx4 v5, s[12:15], s36 offen lds
  s_add_u32 m0, s35, 31744
  s_mov_b32 s36, 571392
  buffer_load_dwordx4 v5, s[12:15], s36 offen lds
  s_add_u32 m0, s35, 32768
  s_mov_b32 s36, 589824
  buffer_load_dwordx4 v5, s[12:15], s36 offen lds
  s_add_u32 m0, s35, 33792
  s_mov_b32 s36, 608256
  buffer_load_dwordx4 v5, s[12:15], s36 offen lds
  s_add_u32 m0, s35, 34816
  s_mov_b32 s36, 626688
  buffer_load_dwordx4 v5, s[12:15], s36 offen lds
  s_add_u32 m0, s35, 35840
  s_mov_b32 s36, 645120
  buffer_load_dwordx4 v5, s[12:15], s36 offen lds
  s_waitcnt vmcnt(32)
  ds_read_b64_tr_b16 a[0:1], v6 offset:0
  ds_read_b64_tr_b16 a[2:3], v6 offset:1024
  ds_read_b64_tr_b16 a[4:5], v6 offset:2048
  ds_read_b64_tr_b16 a[6:7], v6 offset:3072
  ds_read_b64_tr_b16 a[8:9], v6 offset:8
  ds_read_b64_tr_b16 a[10:11], v6 offset:1032
  ds_read_b64_tr_b16 a[12:13], v6 offset:2056
  ds_read_b64_tr_b16 a[14:15], v6 offset:3080
  s_waitcnt lgkmcnt(0)
  s_add_u32 m0, s35, 0
  s_mov_b32 s36, 663552
  buffer_load_dwordx4 v5, s[12:15], s36 offen lds
  s_add_u32 m0, s35, 1024
  s_mov_b32 s36, 681984
  buffer_load_dwordx4 v5, s[12:15], s36 offen lds
  s_add_u32 m0, s35, 2048
  s_mov_b32 s36, 700416
  buffer_load_dwordx4 v5, s[12:15], s36 offen lds
  s_add_u32 m0, s35, 3072
  s_mov_b32 s36, 718848
  buffer_load_dwordx4 v5, s[12:15], s36 offen lds
  s_waitcnt vmcnt(32)
  ds_read_b64_tr_b16 a[16:17], v6 offset:4096
  ds_read_b64_tr_b16 a[18:19], v6 offset:5120
  ds_read_b64_tr_b16 a[20:21], v6 offset:6144
  ds_read_b64_tr_b16 a[22:23], v6 offset:7168
  ds_read_b64_tr_b16 a[24:25], v6 offset:4104
  ds_read_b64_tr_b16 a[26:27], v6 offset:5128
  ds_read_b64_tr_b16 a[28:29], v6 offset:6152
  ds_read_b64_tr_b16 a[30:31], v6 offset:7176
  s_waitcnt lgkmcnt(0)
  s_add_u32 m0, s35, 4096
  s_mov_b32 s36, 737280
  buffer_load_dwordx4 v5, s[12:15], s36 offen lds
  s_add_u32 m0, s35, 5120
  s_mov_b32 s36, 755712
  buffer_load_dwordx4 v5, s[12:15], s36 offen lds
  s_add_u32 m0, s35, 6144
  s_mov_b32 s36, 774144
  buffer_load_dwordx4 v5, s[12:15], s36 offen lds
  s_add_u32 m0, s35, 7168
  s_mov_b32 s36, 792576
  buffer_load_dwordx4 v5, s[12:15], s36 offen lds
  s_waitcnt vmcnt(32)
  ds_read_b64_tr_b16 a[32:33], v6 offset:8192
  ds_read_b64_tr_b16 a[34:35], v6 offset:9216
  ds_read_b64_tr_b16 a[36:37], v6 offset:10240
  ds_read_b64_tr_b16 a[38:39], v6 offset:11264
  ds_read_b64_tr_b16 a[40:41], v6 offset:8200
  ds_read_b64_tr_b16 a[42:43], v6 offset:9224
  ds_read_b64_tr_b16 a[44:45], v6 offset:10248
  ds_read_b64_tr_b16 a[46:47], v6 offset:11272
  s_waitcnt lgkmcnt(0)
  s_add_u32 m0, s35, 8192
  s_mov_b32 s36, 811008
  buffer_load_dwordx4 v5, s[12:15], s36 offen lds
  s_add_u32 m0, s35, 9216
  s_mov_b32 s36, 829440
  buffer_load_dwordx4 v5, s[12:15], s36 offen lds
  s_add_u32 m0, s35, 10240
  s_mov_b32 s36, 847872
  buffer_load_dwordx4 v5, s[12:15], s36 offen lds
  s_add_u32 m0, s35, 11264
  s_mov_b32 s36, 866304
  buffer_load_dwordx4 v5, s[12:15], s36 offen lds
  s_waitcnt vmcnt(32)
  ds_read_b64_tr_b16 a[48:49], v6 offset:12288
  ds_read_b64_tr_b16 a[50:51], v6 offset:13312
  ds_read_b64_tr_b16 a[52:53], v6 offset:14336
  ds_read_b64_tr_b16 a[54:55], v6 offset:15360
  ds_read_b64_tr_b16 a[56:57], v6 offset:12296
  ds_read_b64_tr_b16 a[58:59], v6 offset:13320
  ds_read_b64_tr_b16 a[60:61], v6 offset:14344
  ds_read_b64_tr_b16 a[62:63], v6 offset:15368
  s_waitcnt lgkmcnt(0)
  s_add_u32 m0, s35, 12288
  s_mov_b32 s36, 884736
  buffer_load_dwordx4 v5, s[12:15], s36 offen lds
  s_add_u32 m0, s35, 13312
  s_mov_b32 s36, 903168
  buffer_load_dwordx4 v5, s[12:15], s36 offen lds
  s_add_u32 m0, s35, 14336
  s_mov_b32 s36, 921600
  buffer_load_dwordx4 v5, s[12:15], s36 offen lds
  s_add_u32 m0, s35, 15360
  s_mov_b32 s36, 940032
  buffer_load_dwordx4 v5, s[12:15], s36 offen lds
  s_waitcnt vmcnt(32)
  ds_read_b64_tr_b16 a[64:65], v6 offset:16384
  ds_read_b64_tr_b16 a[66:67], v6 offset:17408
  ds_read_b64_tr_b16 a[68:69], v6 offset:18432
  ds_read_b64_tr_b16 a[70:71], v6 offset:19456
  ds_read_b64_tr_b16 a[72:73], v6 offset:16392
  ds_read_b64_tr_b16 a[74:75], v6 offset:17416
  ds_read_b64_tr_b16 a[76:77], v6 offset:18440
  ds_read_b64_tr_b16 a[78:79], v6 offset:19464
  s_waitcnt lgkmcnt(0)
  s_add_u32 m0, s35, 16384
  s_mov_b32 s36, 958464
  buffer_load_dwordx4 v5, s[12:15], s36 offen lds
  s_add_u32 m0, s35, 17408
  s_mov_b32 s36, 976896
  buffer_load_dwordx4 v5, s[12:15], s36 offen lds
  s_add_u32 m0, s35, 18432
  s_mov_b32 s36, 995328
  buffer_load_dwordx4 v5, s[12:15], s36 offen lds
  s_add_u32 m0, s35, 19456
  s_mov_b32 s36, 1013760
  buffer_load_dwordx4 v5, s[12:15], s36 offen lds
  s_waitcnt vmcnt(32)
  ds_read_b64_tr_b16 a[80:81], v6 offset:20480
  ds_read_b64_tr_b16 a[82:83], v6 offset:21504
  ds_read_b64_tr_b16 a[84:85], v6 offset:22528
  ds_read_b64_tr_b16 a[86:87], v6 offset:23552
  ds_read_b64_tr_b16 a[88:89], v6 offset:20488
  ds_read_b64_tr_b16 a[90:91], v6 offset:21512
  ds_read_b64_tr_b16 a[92:93], v6 offset:22536
  ds_read_b64_tr_b16 a[94:95], v6 offset:23560
  s_waitcnt lgkmcnt(0)
  s_add_u32 m0, s35, 20480
  s_mov_b32 s36, 1032192
  buffer_load_dwordx4 v5, s[12:15], s36 offen lds
  s_add_u32 m0, s35, 21504
  s_mov_b32 s36, 1050624
  buffer_load_dwordx4 v5, s[12:15], s36 offen lds
  s_add_u32 m0, s35, 22528
  s_mov_b32 s36, 1069056
  buffer_load_dwordx4 v5, s[12:15], s36 offen lds
  s_add_u32 m0, s35, 23552
  s_mov_b32 s36, 1087488
  buffer_load_dwordx4 v5, s[12:15], s36 offen lds
  s_waitcnt vmcnt(32)
  ds_read_b64_tr_b16 a[96:97], v6 offset:24576
  ds_read_b64_tr_b16 a[98:99], v6 offset:25600
  ds_read_b64_tr_b16 a[100:101], v6 offset:26624
  ds_read_b64_tr_b16 a[102:103], v6 offset:27648
  ds_read_b64_tr_b16 a[104:105], v6 offset:24584
  ds_read_b64_tr_b16 a[106:107], v6 offset:25608
  ds_read_b64_tr_b16 a[108:109], v6 offset:26632
  ds_read_b64_tr_b16 a[110:111], v6 offset:27656
  s_waitcnt lgkmcnt(0)
  s_add_u32 m0, s35, 24576
  s_mov_b32 s36, 1105920
  buffer_load_dwordx4 v5, s[12:15], s36 offen lds
  s_add_u32 m0, s35, 25600
  s_mov_b32 s36, 1124352
  buffer_load_dwordx4 v5, s[12:15], s36 offen lds
  s_add_u32 m0, s35, 26624
  s_mov_b32 s36, 1142784
  buffer_load_dwordx4 v5, s[12:15], s36 offen lds
  s_add_u32 m0, s35, 27648
  s_mov_b32 s36, 1161216
  buffer_load_dwordx4 v5, s[12:15], s36 offen lds
  s_waitcnt vmcnt(32)
  ds_read_b64_tr_b16 a[112:113], v6 offset:28672
  ds_read_b64_tr_b16 a[114:115], v6 offset:29696
  ds_read_b64_tr_b16 a[116:117], v6 offset:30720
  ds_read_b64_tr_b16 a[118:119], v6 offset:31744
  ds_read_b64_tr_b16 a[120:121], v6 offset:28680
  ds_read_b64_tr_b16 a[122:123], v6 offset:29704
  ds_read_b64_tr_b16 a[124:125], v6 offset:30728
  ds_read_b64_tr_b16 a[126:127], v6 offset:31752
  s_waitcnt lgkmcnt(0)
  s_waitcnt vmcnt(28)
  ds_read_b64_tr_b16 a[128:129], v6 offset:32768
  ds_read_b64_tr_b16 a[130:131], v6 offset:33792
  ds_read_b64_tr_b16 a[132:133], v6 offset:34816
  ds_read_b64_tr_b16 a[134:135], v6 offset:35840
  ds_read_b64_tr_b16 a[136:137], v6 offset:32776
  ds_read_b64_tr_b16 a[138:139], v6 offset:33800
  ds_read_b64_tr_b16 a[140:141], v6 offset:34824
  ds_read_b64_tr_b16 a[142:143], v6 offset:35848
  s_waitcnt lgkmcnt(0)
  s_waitcnt vmcnt(24)
  ds_read_b64_tr_b16 a[144:145], v6 offset:0
  ds_read_b64_tr_b16 a[146:147], v6 offset:1024
  ds_read_b64_tr_b16 a[148:149], v6 offset:2048
  ds_read_b64_tr_b16 a[150:151], v6 offset:3072
  ds_read_b64_tr_b16 a[152:153], v6 offset:8
  ds_read_b64_tr_b16 a[154:155], v6 offset:1032
  ds_read_b64_tr_b16 a[156:157], v6 offset:2056
  ds_read_b64_tr_b16 a[158:159], v6 offset:3080
  s_waitcnt lgkmcnt(0)
  s_waitcnt vmcnt(20)
  ds_read_b64_tr_b16 a[160:161], v6 offset:4096
  ds_read_b64_tr_b16 a[162:163], v6 offset:5120
  ds_read_b64_tr_b16 a[164:165], v6 offset:6144
  ds_read_b64_tr_b16 a[166:167], v6 offset:7168
  ds_read_b64_tr_b16 a[168:169], v6 offset:4104
  ds_read_b64_tr_b16 a[170:171], v6 offset:5128
  ds_read_b64_tr_b16 a[172:173], v6 offset:6152
  ds_read_b64_tr_b16 a[174:175], v6 offset:7176
  s_waitcnt lgkmcnt(0)
  s_waitcnt vmcnt(16)
  ds_read_b64_tr_b16 a[176:177], v6 offset:8192
  ds_read_b64_tr_b16 a[178:179], v6 offset:9216
  ds_read_b64_tr_b16 a[180:181], v6 offset:10240
  ds_read_b64_tr_b16 a[182:183], v6 offset:11264
  ds_read_b64_tr_b16 a[184:185], v6 offset:8200
  ds_read_b64_tr_b16 a[186:187], v6 offset:9224
  ds_read_b64_tr_b16 a[188:189], v6 offset:10248
  ds_read_b64_tr_b16 a[190:191], v6 offset:11272
  s_waitcnt lgkmcnt(0)
  s_waitcnt vmcnt(12)
  ds_read_b64_tr_b16 a[192:193], v6 offset:12288
  ds_read_b64_tr_b16 a[194:195], v6 offset:13312
  ds_read_b64_tr_b16 a[196:197], v6 offset:14336
  ds_read_b64_tr_b16 a[198:199], v6 offset:15360
  ds_read_b64_tr_b16 a[200:201], v6 offset:12296
  ds_read_b64_tr_b16 a[202:203], v6 offset:13320
  ds_read_b64_tr_b16 a[204:205], v6 offset:14344
  ds_read_b64_tr_b16 a[206:207], v6 offset:15368
  s_waitcnt lgkmcnt(0)
  s_waitcnt vmcnt(8)
  ds_read_b64_tr_b16 a[208:209], v6 offset:16384
  ds_read_b64_tr_b16 a[210:211], v6 offset:17408
  ds_read_b64_tr_b16 a[212:213], v6 offset:18432
  ds_read_b64_tr_b16 a[214:215], v6 offset:19456
  ds_read_b64_tr_b16 a[216:217], v6 offset:16392
  ds_read_b64_tr_b16 a[218:219], v6 offset:17416
  ds_read_b64_tr_b16 a[220:221], v6 offset:18440
  ds_read_b64_tr_b16 a[222:223], v6 offset:19464
  s_waitcnt lgkmcnt(0)
  s_waitcnt vmcnt(4)
  ds_read_b64_tr_b16 a[224:225], v6 offset:20480
  ds_read_b64_tr_b16 a[226:227], v6 offset:21504
  ds_read_b64_tr_b16 a[228:229], v6 offset:22528
  ds_read_b64_tr_b16 a[230:231], v6 offset:23552
  ds_read_b64_tr_b16 a[232:233], v6 offset:20488
  ds_read_b64_tr_b16 a[234:235], v6 offset:21512
  ds_read_b64_tr_b16 a[236:237], v6 offset:22536
  ds_read_b64_tr_b16 a[238:239], v6 offset:23560
  s_waitcnt lgkmcnt(0)
  s_waitcnt vmcnt(0)
  ds_read_b64_tr_b16 a[240:241], v6 offset:24576
  ds_read_b64_tr_b16 a[242:243], v6 offset:25600
  ds_read_b64_tr_b16 a[244:245], v6 offset:26624
  ds_read_b64_tr_b16 a[246:247], v6 offset:27648
  ds_read_b64_tr_b16 a[248:249], v6 offset:24584
  ds_read_b64_tr_b16 a[250:251], v6 offset:25608
  ds_read_b64_tr_b16 a[252:253], v6 offset:26632
  ds_read_b64_tr_b16 a[254:255], v6 offset:27656
  s_waitcnt lgkmcnt(0)
  s_waitcnt vmcnt(0) lgkmcnt(0)
  v_mov_b32 v16, 64
L_o_init:
  buffer_load_dword v17, v16, s[8:11], 0 offen sc1
  s_sub_u32 s31, s31, 1
  s_cbranch_scc1 L_exit
  s_waitcnt vmcnt(0)
  v_readfirstlane_b32 s33, v17
  s_nop 0
  s_cmp_ge_u32 s33, 6
  s_cbranch_scc1 L_o_init_ok
  s_sleep 2
  s_branch L_o_init
L_o_init_ok:
  v_mov_b32 v16, 88
L_o_mod:
  buffer_load_dword v17, v16, s[8:11], 0 offen sc1
  s_sub_u32 s31, s31, 1
  s_cbranch_scc1 L_exit
  s_waitcnt vmcnt(0)
  v_readfirstlane_b32 s33, v17
  s_nop 0
  s_cmp_ge_u32 s33, 36
  s_cbranch_scc1 L_o_mod_ok
  s_sleep 2
  s_branch L_o_mod
L_o_mod_ok:
  v_lshlrev_b32 v16, 2, v15
  s_mov_b32 s36, 0x74000
  buffer_load_dword v17, v16, s[4:7], s36 offen sc1
  s_waitcnt vmcnt(0)
  v_readlane_b32 s44, v17, 0
  v_readlane_b32 s45, v17, 1
  v_readlane_b32 s46, v17, 2
  v_readlane_b32 s47, v17, 3
  v_readlane_b32 s48, v17, 4
  v_readlane_b32 s49, v17, 5
  v_readlane_b32 s50, v17, 6
  v_readlane_b32 s51, v17, 7
L_o_task:
  s_lshl_b32 s38, s37, 17
  s_lshl_b32 s36, s30, 15
  s_add_u32 s38, s38, s36
  s_add_u32 s38, s38, 0x3000000
  s_lshr_b32 s39, s37, 1
  s_lshl_b32 s39, s39, 2
  s_add_u32 s39, s39, 0x60000
  s_mul_i32 s40, s37, 18432
  s_lshl_b32 s36, s37, 4
  v_add_u32 v3, s36, v14
  buffer_load_dwordx4 v[16:19], v2, s[16:19], s40 offen
  v_lshlrev_b32 v12, 2, v3
  s_mov_b32 s36, 0x70000
  buffer_load_dword v24, v12, s[4:7], s36 offen sc1
  v_mov_b32 v12, 0x40000000
  v_lshlrev_b32 v11, 4, v13
  v_add_u32 v11, s34, v11
  v_cmp_eq_u32 vcc, s44, v3
  s_nop 1
  v_cndmask_b32 v12, v12, v11, vcc
  v_add_u32 v11, 1152, v11
  v_cmp_eq_u32 vcc, s45, v3
  s_nop 1
  v_cndmask_b32 v12, v12, v11, vcc
  v_add_u32 v11, 1152, v11
  v_cmp_eq_u32 vcc, s46, v3
  s_nop 1
  v_cndmask_b32 v12, v12, v11, vcc
  v_add_u32 v11, 1152, v11
  v_cmp_eq_u32 vcc, s47, v3
  s_nop 1
  v_cndmask_b32 v12, v12, v11, vcc
  v_add_u32 v11, 1152, v11
  v_cmp_eq_u32 vcc, s48, v3
  s_nop 1
  v_cndmask_b32 v12, v12, v11, vcc
  v_add_u32 v11, 1152, v11
  v_cmp_eq_u32 vcc, s49, v3
  s_nop 1
  v_cndmask_b32 v12, v12, v11, vcc
  v_add_u32 v11, 1152, v11
  v_cmp_eq_u32 vcc, s50, v3
  s_nop 1
  v_cndmask_b32 v12, v12, v11, vcc
  v_add_u32 v11, 1152, v11
  v_cmp_eq_u32 vcc, s51, v3
  s_nop 1
  v_cndmask_b32 v12, v12, v11, vcc
  v_add_u32 v11, 1152, v11
  s_mov_b32 s36, 0x75000
  buffer_load_dwordx4 v[20:23], v12, s[4:7], s36 offen sc1
L_o_pre:
  buffer_load_dword v10, v7, s[4:7], s39 offen sc1
  s_sub_u32 s31, s31, 1
  s_cbranch_scc1 L_exit
  s_waitcnt vmcnt(0)
  v_cmp_gt_u32 vcc, 2, v10
  s_cbranch_vccnz L_o_pre
  v_lshlrev_b32 v192, 16, v16
  v_and_b32 v193, 0xffff0000, v16
  v_lshlrev_b32 v200, 16, v20
  v_and_b32 v201, 0xffff0000, v20
  v_add_f32 v192, v192, v200
  v_add_f32 v193, v193, v201
  v_lshlrev_b32 v194, 16, v17
  v_and_b32 v195, 0xffff0000, v17
  v_lshlrev_b32 v200, 16, v21
  v_and_b32 v201, 0xffff0000, v21
  v_add_f32 v194, v194, v200
  v_add_f32 v195, v195, v201
  v_lshlrev_b32 v196, 16, v18
  v_and_b32 v197, 0xffff0000, v18
  v_lshlrev_b32 v200, 16, v22
  v_and_b32 v201, 0xffff0000, v22
  v_add_f32 v196, v196, v200
  v_add_f32 v197, v197, v201
  v_lshlrev_b32 v198, 16, v19
  v_and_b32 v199, 0xffff0000, v19
  v_lshlrev_b32 v200, 16, v23
  v_and_b32 v201, 0xffff0000, v23
  v_add_f32 v198, v198, v200
  v_add_f32 v199, v199, v201
  v_sub_f32 v25, 1.0, v24
  v_cvt_pk_bf16_f32 v200, v192, v193
  v_lshlrev_b32 v192, 16, v200
  v_and_b32 v193, 0xffff0000, v200
  v_cvt_pk_bf16_f32 v200, v194, v195
  v_lshlrev_b32 v194, 16, v200
  v_and_b32 v195, 0xffff0000, v200
  v_cvt_pk_bf16_f32 v200, v196, v197
  v_lshlrev_b32 v196, 16, v200
  v_and_b32 v197, 0xffff0000, v200
  v_cvt_pk_bf16_f32 v200, v198, v199
  v_lshlrev_b32 v198, 16, v200
  v_and_b32 v199, 0xffff0000, v200
  v_cvt_pk_bf16_f32 v200, v24, v25
  v_lshlrev_b32 v24, 16, v200
  v_and_b32 v25, 0xffff0000, v200
  v_mul_f32 v192, v192, v25
  v_mul_f32 v193, v193, v25
  v_mul_f32 v194, v194, v25
  v_mul_f32 v195, v195, v25
  v_mul_f32 v196, v196, v25
  v_mul_f32 v197, v197, v25
  v_mul_f32 v198, v198, v25
  v_mul_f32 v199, v199, v25
  v_cvt_pk_bf16_f32 v200, v192, v193
  v_lshlrev_b32 v192, 16, v200
  v_and_b32 v193, 0xffff0000, v200
  v_cvt_pk_bf16_f32 v200, v194, v195
  v_lshlrev_b32 v194, 16, v200
  v_and_b32 v195, 0xffff0000, v200
  v_cvt_pk_bf16_f32 v200, v196, v197
  v_lshlrev_b32 v196, 16, v200
  v_and_b32 v197, 0xffff0000, v200
  v_cvt_pk_bf16_f32 v200, v198, v199
  v_lshlrev_b32 v198, 16, v200
  v_and_b32 v199, 0xffff0000, v200
  s_branch L_o_ns
L_o_poll:
  s_cmp_ge_u32 s37, 123
  s_cbranch_scc1 L_o_ns
  s_sleep 8
L_o_ns:
  buffer_load_dword v10, v8, s[4:7], s38 offen sc1
  s_sub_u32 s31, s31, 1
  s_cbranch_scc1 L_exit
  s_waitcnt vmcnt(0)
  v_cmp_eq_u32 vcc, -1, v10
  s_cbranch_vccnz L_o_poll
  s_mov_b32 s36, s38
  buffer_load_dwordx4 v[64:67], v1, s[4:7], s36 offen offset:0 sc1
  buffer_load_dwordx4 v[68:71], v1, s[4:7], s36 offen offset:1024 sc1
  buffer_load_dwordx4 v[72:75], v1, s[4:7], s36 offen offset:2048 sc1
  buffer_load_dwordx4 v[76:79], v1, s[4:7], s36 offen offset:3072 sc1
  s_add_u32 s36, s36, 4096
  buffer_load_dwordx4 v[80:83], v1, s[4:7], s36 offen offset:0 sc1
  buffer_load_dwordx4 v[84:87], v1, s[4:7], s36 offen offset:1024 sc1
  buffer_load_dwordx4 v[88:91], v1, s[4:7], s36 offen offset:2048 sc1
  buffer_load_dwordx4 v[92:95], v1, s[4:7], s36 offen offset:3072 sc1
  s_add_u32 s36, s36, 4096
  buffer_load_dwordx4 v[96:99], v1, s[4:7], s36 offen offset:0 sc1
  buffer_load_dwordx4 v[100:103], v1, s[4:7], s36 offen offset:1024 sc1
  buffer_load_dwordx4 v[104:107], v1, s[4:7], s36 offen offset:2048 sc1
  buffer_load_dwordx4 v[108:111], v1, s[4:7], s36 offen offset:3072 sc1
  s_add_u32 s36, s36, 4096
  buffer_load_dwordx4 v[112:115], v1, s[4:7], s36 offen offset:0 sc1
  buffer_load_dwordx4 v[116:119], v1, s[4:7], s36 offen offset:1024 sc1
  buffer_load_dwordx4 v[120:123], v1, s[4:7], s36 offen offset:2048 sc1
  buffer_load_dwordx4 v[124:127], v1, s[4:7], s36 offen offset:3072 sc1
  s_add_u32 s36, s36, 4096
  buffer_load_dwordx4 v[128:131], v1, s[4:7], s36 offen offset:0 sc1
  buffer_load_dwordx4 v[132:135], v1, s[4:7], s36 offen offset:1024 sc1
  buffer_load_dwordx4 v[136:139], v1, s[4:7], s36 offen offset:2048 sc1
  buffer_load_dwordx4 v[140:143], v1, s[4:7], s36 offen offset:3072 sc1
  s_add_u32 s36, s36, 4096
  buffer_load_dwordx4 v[144:147], v1, s[4:7], s36 offen offset:0 sc1
  buffer_load_dwordx4 v[148:151], v1, s[4:7], s36 offen offset:1024 sc1
  buffer_load_dwordx4 v[152:155], v1, s[4:7], s36 offen offset:2048 sc1
  buffer_load_dwordx4 v[156:159], v1, s[4:7], s36 offen offset:3072 sc1
  s_add_u32 s36, s36, 4096
  buffer_load_dwordx4 v[160:163], v1, s[4:7], s36 offen offset:0 sc1
  buffer_load_dwordx4 v[164:167], v1, s[4:7], s36 offen offset:1024 sc1
  buffer_load_dwordx4 v[168:171], v1, s[4:7], s36 offen offset:2048 sc1
  buffer_load_dwordx4 v[172:175], v1, s[4:7], s36 offen offset:3072 sc1
  s_add_u32 s36, s36, 4096
  buffer_load_dwordx4 v[176:179], v1, s[4:7], s36 offen offset:0 sc1
  buffer_load_dwordx4 v[180:183], v1, s[4:7], s36 offen offset:1024 sc1
  buffer_load_dwordx4 v[184:187], v1, s[4:7], s36 offen offset:2048 sc1
  buffer_load_dwordx4 v[188:191], v1, s[4:7], s36 offen offset:3072 sc1
  s_waitcnt vmcnt(31)
  v_mfma_f32_16x16x32_bf16 v[32:35], a[0:3], v[64:67], 0
  v_max3_u32 v10, v10, v64, v67
  v_mfma_f32_16x16x32_bf16 v[36:39], a[8:11], v[64:67], 0
  s_waitcnt vmcnt(30)
  v_mfma_f32_16x16x32_bf16 v[32:35], a[4:7], v[68:71], v[32:35]
  v_max3_u32 v10, v10, v68, v71
  v_mfma_f32_16x16x32_bf16 v[36:39], a[12:15], v[68:71], v[36:39]
  s_waitcnt vmcnt(29)
  v_mfma_f32_16x16x32_bf16 v[32:35], a[16:19], v[72:75], v[32:35]
  v_max3_u32 v10, v10, v72, v75
  v_mfma_f32_16x16x32_bf16 v[36:39], a[24:27], v[72:75], v[36:39]
  s_waitcnt vmcnt(28)
  v_mfma_f32_16x16x32_bf16 v[32:35], a[20:23], v[76:79], v[32:35]
  v_max3_u32 v10, v10, v76, v79
  v_mfma_f32_16x16x32_bf16 v[36:39], a[28:31], v[76:79], v[36:39]
  s_waitcnt vmcnt(27)
  v_mfma_f32_16x16x32_bf16 v[32:35], a[32:35], v[80:83], v[32:35]
  v_max3_u32 v10, v10, v80, v83
  v_mfma_f32_16x16x32_bf16 v[36:39], a[40:43], v[80:83], v[36:39]
  s_waitcnt vmcnt(26)
  v_mfma_f32_16x16x32_bf16 v[32:35], a[36:39], v[84:87], v[32:35]
  v_max3_u32 v10, v10, v84, v87
  v_mfma_f32_16x16x32_bf16 v[36:39], a[44:47], v[84:87], v[36:39]
  s_waitcnt vmcnt(25)
  v_mfma_f32_16x16x32_bf16 v[32:35], a[48:51], v[88:91], v[32:35]
  v_max3_u32 v10, v10, v88, v91
  v_mfma_f32_16x16x32_bf16 v[36:39], a[56:59], v[88:91], v[36:39]
  s_waitcnt vmcnt(24)
  v_mfma_f32_16x16x32_bf16 v[32:35], a[52:55], v[92:95], v[32:35]
  v_max3_u32 v10, v10, v92, v95
  v_mfma_f32_16x16x32_bf16 v[36:39], a[60:63], v[92:95], v[36:39]
  s_waitcnt vmcnt(23)
  v_mfma_f32_16x16x32_bf16 v[32:35], a[64:67], v[96:99], v[32:35]
  v_max3_u32 v10, v10, v96, v99
  v_mfma_f32_16x16x32_bf16 v[36:39], a[72:75], v[96:99], v[36:39]
  s_waitcnt vmcnt(22)
  v_mfma_f32_16x16x32_bf16 v[32:35], a[68:71], v[100:103], v[32:35]
  v_max3_u32 v10, v10, v100, v103
  v_mfma_f32_16x16x32_bf16 v[36:39], a[76:79], v[100:103], v[36:39]
  s_waitcnt vmcnt(21)
  v_mfma_f32_16x16x32_bf16 v[32:35], a[80:83], v[104:107], v[32:35]
  v_max3_u32 v10, v10, v104, v107
  v_mfma_f32_16x16x32_bf16 v[36:39], a[88:91], v[104:107], v[36:39]
  s_waitcnt vmcnt(20)
  v_mfma_f32_16x16x32_bf16 v[32:35], a[84:87], v[108:111], v[32:35]
  v_max3_u32 v10, v10, v108, v111
  v_mfma_f32_16x16x32_bf16 v[36:39], a[92:95], v[108:111], v[36:39]
  s_waitcnt vmcnt(19)
  v_mfma_f32_16x16x32_bf16 v[32:35], a[96:99], v[112:115], v[32:35]
  v_max3_u32 v10, v10, v112, v115
  v_mfma_f32_16x16x32_bf16 v[36:39], a[104:107], v[112:115], v[36:39]
  s_waitcnt vmcnt(18)
  v_mfma_f32_16x16x32_bf16 v[32:35], a[100:103], v[116:119], v[32:35]
  v_max3_u32 v10, v10, v116, v119
  v_mfma_f32_16x16x32_bf16 v[36:39], a[108:111], v[116:119], v[36:39]
  s_waitcnt vmcnt(17)
  v_mfma_f32_16x16x32_bf16 v[32:35], a[112:115], v[120:123], v[32:35]
  v_max3_u32 v10, v10, v120, v123
  v_mfma_f32_16x16x32_bf16 v[36:39], a[120:123], v[120:123], v[36:39]
  s_waitcnt vmcnt(16)
  v_mfma_f32_16x16x32_bf16 v[32:35], a[116:119], v[124:127], v[32:35]
  v_max3_u32 v10, v10, v124, v127
  v_mfma_f32_16x16x32_bf16 v[36:39], a[124:127], v[124:127], v[36:39]
  s_waitcnt vmcnt(15)
  v_mfma_f32_16x16x32_bf16 v[32:35], a[128:131], v[128:131], v[32:35]
  v_max3_u32 v10, v10, v128, v131
  v_mfma_f32_16x16x32_bf16 v[36:39], a[136:139], v[128:131], v[36:39]
  s_waitcnt vmcnt(14)
  v_mfma_f32_16x16x32_bf16 v[32:35], a[132:135], v[132:135], v[32:35]
  v_max3_u32 v10, v10, v132, v135
  v_mfma_f32_16x16x32_bf16 v[36:39], a[140:143], v[132:135], v[36:39]
  s_waitcnt vmcnt(13)
  v_mfma_f32_16x16x32_bf16 v[32:35], a[144:147], v[136:139], v[32:35]
  v_max3_u32 v10, v10, v136, v139
  v_mfma_f32_16x16x32_bf16 v[36:39], a[152:155], v[136:139], v[36:39]
  s_waitcnt vmcnt(12)
  v_mfma_f32_16x16x32_bf16 v[32:35], a[148:151], v[140:143], v[32:35]
  v_max3_u32 v10, v10, v140, v143
  v_mfma_f32_16x16x32_bf16 v[36:39], a[156:159], v[140:143], v[36:39]
  s_waitcnt vmcnt(11)
  v_mfma_f32_16x16x32_bf16 v[32:35], a[160:163], v[144:147], v[32:35]
  v_max3_u32 v10, v10, v144, v147
  v_mfma_f32_16x16x32_bf16 v[36:39], a[168:171], v[144:147], v[36:39]
  s_waitcnt vmcnt(10)
  v_mfma_f32_16x16x32_bf16 v[32:35], a[164:167], v[148:151], v[32:35]
  v_max3_u32 v10, v10, v148, v151
  v_mfma_f32_16x16x32_bf16 v[36:39], a[172:175], v[148:151], v[36:39]
  s_waitcnt vmcnt(9)
  v_mfma_f32_16x16x32_bf16 v[32:35], a[176:179], v[152:155], v[32:35]
  v_max3_u32 v10, v10, v152, v155
  v_mfma_f32_16x16x32_bf16 v[36:39], a[184:187], v[152:155], v[36:39]
  s_waitcnt vmcnt(8)
  v_mfma_f32_16x16x32_bf16 v[32:35], a[180:183], v[156:159], v[32:35]
  v_max3_u32 v10, v10, v156, v159
  v_mfma_f32_16x16x32_bf16 v[36:39], a[188:191], v[156:159], v[36:39]
  s_waitcnt vmcnt(7)
  v_mfma_f32_16x16x32_bf16 v[32:35], a[192:195], v[160:163], v[32:35]
  v_max3_u32 v10, v10, v160, v163
  v_mfma_f32_16x16x32_bf16 v[36:39], a[200:203], v[160:163], v[36:39]
  s_waitcnt vmcnt(6)
  v_mfma_f32_16x16x32_bf16 v[32:35], a[196:199], v[164:167], v[32:35]
  v_max3_u32 v10, v10, v164, v167
  v_mfma_f32_16x16x32_bf16 v[36:39], a[204:207], v[164:167], v[36:39]
  s_waitcnt vmcnt(5)
  v_mfma_f32_16x16x32_bf16 v[32:35], a[208:211], v[168:171], v[32:35]
  v_max3_u32 v10, v10, v168, v171
  v_mfma_f32_16x16x32_bf16 v[36:39], a[216:219], v[168:171], v[36:39]
  s_waitcnt vmcnt(4)
  v_mfma_f32_16x16x32_bf16 v[32:35], a[212:215], v[172:175], v[32:35]
  v_max3_u32 v10, v10, v172, v175
  v_mfma_f32_16x16x32_bf16 v[36:39], a[220:223], v[172:175], v[36:39]
  s_waitcnt vmcnt(3)
  v_mfma_f32_16x16x32_bf16 v[32:35], a[224:227], v[176:179], v[32:35]
  v_max3_u32 v10, v10, v176, v179
  v_mfma_f32_16x16x32_bf16 v[36:39], a[232:235], v[176:179], v[36:39]
  s_waitcnt vmcnt(2)
  v_mfma_f32_16x16x32_bf16 v[32:35], a[228:231], v[180:183], v[32:35]
  v_max3_u32 v10, v10, v180, v183
  v_mfma_f32_16x16x32_bf16 v[36:39], a[236:239], v[180:183], v[36:39]
  s_waitcnt vmcnt(1)
  v_mfma_f32_16x16x32_bf16 v[32:35], a[240:243], v[184:187], v[32:35]
  v_max3_u32 v10, v10, v184, v187
  v_mfma_f32_16x16x32_bf16 v[36:39], a[248:251], v[184:187], v[36:39]
  s_waitcnt vmcnt(0)
  v_mfma_f32_16x16x32_bf16 v[32:35], a[244:247], v[188:191], v[32:35]
  v_max3_u32 v10, v10, v188, v191
  v_mfma_f32_16x16x32_bf16 v[36:39], a[252:255], v[188:191], v[36:39]
  v_cmp_eq_u32 vcc, -1, v10
  s_cbranch_vccnz L_o_poll
  v_add_u32 v12, s41, v4
  ds_write_b128 v12, v[32:35] offset:0
  s_nop 2
  ds_write_b128 v12, v[36:39] offset:1024
  s_waitcnt lgkmcnt(0)
  s_barrier
  s_cmp_lg_u32 s30, 0
  s_cbranch_scc1 L_o_next
  ds_read_b128 v[40:43], v12 offset:2048
  ds_read_b128 v[44:47], v12 offset:3072
  ds_read_b128 v[48:51], v12 offset:4096
  ds_read_b128 v[52:55], v12 offset:5120
  ds_read_b128 v[56:59], v12 offset:6144
  ds_read_b128 v[60:63], v12 offset:7168
  s_waitcnt lgkmcnt(5)
  v_pk_add_f32 v[32:33], v[32:33], v[40:41]
  v_pk_add_f32 v[34:35], v[34:35], v[42:43]
  s_waitcnt lgkmcnt(4)
  v_pk_add_f32 v[36:37], v[36:37], v[44:45]
  v_pk_add_f32 v[38:39], v[38:39], v[46:47]
  s_waitcnt lgkmcnt(3)
  v_pk_add_f32 v[32:33], v[32:33], v[48:49]
  v_pk_add_f32 v[34:35], v[34:35], v[50:51]
  s_waitcnt lgkmcnt(2)
  v_pk_add_f32 v[36:37], v[36:37], v[52:53]
  v_pk_add_f32 v[38:39], v[38:39], v[54:55]
  s_waitcnt lgkmcnt(1)
  v_pk_add_f32 v[32:33], v[32:33], v[56:57]
  v_pk_add_f32 v[34:35], v[34:35], v[58:59]
  s_waitcnt lgkmcnt(0)
  v_pk_add_f32 v[36:37], v[36:37], v[60:61]
  v_pk_add_f32 v[38:39], v[38:39], v[62:63]
  v_cvt_pk_bf16_f32 v72, v32, v33
  v_lshlrev_b32 v32, 16, v72
  v_and_b32 v33, 0xffff0000, v72
  v_cvt_pk_bf16_f32 v72, v34, v35
  v_lshlrev_b32 v34, 16, v72
  v_and_b32 v35, 0xffff0000, v72
  v_cvt_pk_bf16_f32 v72, v36, v37
  v_lshlrev_b32 v36, 16, v72
  v_and_b32 v37, 0xffff0000, v72
  v_cvt_pk_bf16_f32 v72, v38, v39
  v_lshlrev_b32 v38, 16, v72
  v_and_b32 v39, 0xffff0000, v72
  v_mul_f32 v32, v32, v24
  v_mul_f32 v33, v33, v24
  v_mul_f32 v34, v34, v24
  v_mul_f32 v35, v35, v24
  v_mul_f32 v36, v36, v24
  v_mul_f32 v37, v37, v24
  v_mul_f32 v38, v38, v24
  v_mul_f32 v39, v39, v24
  v_cvt_pk_bf16_f32 v72, v32, v33
  v_lshlrev_b32 v32, 16, v72
  v_and_b32 v33, 0xffff0000, v72
  v_cvt_pk_bf16_f32 v72, v34, v35
  v_lshlrev_b32 v34, 16, v72
  v_and_b32 v35, 0xffff0000, v72
  v_cvt_pk_bf16_f32 v72, v36, v37
  v_lshlrev_b32 v36, 16, v72
  v_and_b32 v37, 0xffff0000, v72
  v_cvt_pk_bf16_f32 v72, v38, v39
  v_lshlrev_b32 v38, 16, v72
  v_and_b32 v39, 0xffff0000, v72
  v_pk_add_f32 v[32:33], v[32:33], v[192:193]
  v_pk_add_f32 v[34:35], v[34:35], v[194:195]
  v_pk_add_f32 v[36:37], v[36:37], v[196:197]
  v_pk_add_f32 v[38:39], v[38:39], v[198:199]
  v_cvt_pk_bf16_f32 v28, v32, v33
  v_cvt_pk_bf16_f32 v29, v34, v35
  v_cvt_pk_bf16_f32 v30, v36, v37
  v_cvt_pk_bf16_f32 v31, v38, v39
  buffer_store_dwordx4 v[28:31], v2, s[20:23], s40 offen
L_o_next:
  s_xor_b32 s41, s41, 8192
  s_add_u32 s37, s37, 5
  s_cmp_lt_u32 s37, 128
  s_cbranch_scc1 L_o_task
  s_branch L_exit
.p2align 6
L_mod:
  s_mov_b32 s12, s80
  s_mov_b32 s13, s81
  s_mov_b32 s14, 0x480
  s_mov_b32 s15, 0x20000
  s_mov_b32 s16, s88
  s_mov_b32 s17, s89
  s_mov_b32 s18, 0x480
  s_mov_b32 s19, 0x20000
  s_mov_b32 s24, s64
  s_mov_b32 s25, s65
  s_mov_b32 s26, 0x240000
  s_mov_b32 s27, 0x20000
  v_mov_b32 v15, v0
  v_and_b32 v14, 15, v15
  v_lshrrev_b32 v13, 4, v15
  s_sub_u32 s34, s28, 5
  s_mul_i32 s34, s34, 12
  s_add_u32 s34, s34, s29
  s_sub_u32 s34, s34, 18
  v_lshlrev_b32 v1, 4, v15
  v_lshlrev_b32 v7, 3, v15
  v_mov_b32 v2, 0x4444
  v_mov_b32 v12, 0xeeee
  v_and_b32 v11, 2, v15
  v_cmp_ne_u32 vcc, 0, v11
  s_nop 1
  v_cndmask_b32 v2, v2, v12, vcc
  s_lshl_b32 s33, s30, 6
  v_or_b32 v3, s33, v15
  v_min_u32 v3, 1, v3
  v_lshlrev_b32 v3, 30, v3
  s_cmp_ge_u32 s34, 32
  s_cbranch_scc1 L_mod_w
  v_mul_u32_u24 v12, 1152, v14
  v_lshl_add_u32 v12, v13, 4, v12
  v_lshlrev_b32 v11, 4, v13
  s_lshl_b32 s36, s34, 2
  s_add_u32 s36, s36, s30
  s_mul_i32 s33, s36, 18432
  buffer_load_dwordx4 v[16:19], v12, s[24:27], s33 offen offset:0
  buffer_load_dwordx4 v[88:91], v11, s[12:15], 0 offen offset:0
  buffer_load_dwordx4 v[160:163], v11, s[16:19], 0 offen offset:0
  buffer_load_dwordx4 v[20:23], v12, s[24:27], s33 offen offset:64
  buffer_load_dwordx4 v[92:95], v11, s[12:15], 0 offen offset:64
  buffer_load_dwordx4 v[164:167], v11, s[16:19], 0 offen offset:64
  buffer_load_dwordx4 v[24:27], v12, s[24:27], s33 offen offset:128
  buffer_load_dwordx4 v[96:99], v11, s[12:15], 0 offen offset:128
  buffer_load_dwordx4 v[168:171], v11, s[16:19], 0 offen offset:128
  buffer_load_dwordx4 v[28:31], v12, s[24:27], s33 offen offset:192
  buffer_load_dwordx4 v[100:103], v11, s[12:15], 0 offen offset:192
  buffer_load_dwordx4 v[172:175], v11, s[16:19], 0 offen offset:192
  buffer_load_dwordx4 v[32:35], v12, s[24:27], s33 offen offset:256
  buffer_load_dwordx4 v[104:107], v11, s[12:15], 0 offen offset:256
  buffer_load_dwordx4 v[176:179], v11, s[16:19], 0 offen offset:256
  buffer_load_dwordx4 v[36:39], v12, s[24:27], s33 offen offset:320
  buffer_load_dwordx4 v[108:111], v11, s[12:15], 0 offen offset:320
  buffer_load_dwordx4 v[180:183], v11, s[16:19], 0 offen offset:320
  buffer_load_dwordx4 v[40:43], v12, s[24:27], s33 offen offset:384
  buffer_load_dwordx4 v[112:115], v11, s[12:15], 0 offen offset:384
  buffer_load_dwordx4 v[184:187], v11, s[16:19], 0 offen offset:384
  buffer_load_dwordx4 v[44:47], v12, s[24:27], s33 offen offset:448
  buffer_load_dwordx4 v[116:119], v11, s[12:15], 0 offen offset:448
  buffer_load_dwordx4 v[188:191], v11, s[16:19], 0 offen offset:448
  buffer_load_dwordx4 v[48:51], v12, s[24:27], s33 offen offset:512
  buffer_load_dwordx4 v[120:123], v11, s[12:15], 0 offen offset:512
  buffer_load_dwordx4 v[192:195], v11, s[16:19], 0 offen offset:512
  buffer_load_dwordx4 v[52:55], v12, s[24:27], s33 offen offset:576
  buffer_load_dwordx4 v[124:127], v11, s[12:15], 0 offen offset:576
  buffer_load_dwordx4 v[196:199], v11, s[16:19], 0 offen offset:576
  buffer_load_dwordx4 v[56:59], v12, s[24:27], s33 offen offset:640
  buffer_load_dwordx4 v[128:131], v11, s[12:15], 0 offen offset:640
  buffer_load_dwordx4 v[200:203], v11, s[16:19], 0 offen offset:640
  buffer_load_dwordx4 v[60:63], v12, s[24:27], s33 offen offset:704
  buffer_load_dwordx4 v[132:135], v11, s[12:15], 0 offen offset:704
  buffer_load_dwordx4 v[204:207], v11, s[16:19], 0 offen offset:704
  buffer_load_dwordx4 v[64:67], v12, s[24:27], s33 offen offset:768
  buffer_load_dwordx4 v[136:139], v11, s[12:15], 0 offen offset:768
  buffer_load_dwordx4 v[208:211], v11, s[16:19], 0 offen offset:768
  buffer_load_dwordx4 v[68:71], v12, s[24:27], s33 offen offset:832
  buffer_load_dwordx4 v[140:143], v11, s[12:15], 0 offen offset:832
  buffer_load_dwordx4 v[212:215], v11, s[16:19], 0 offen offset:832
  buffer_load_dwordx4 v[72:75], v12, s[24:27], s33 offen offset:896
  buffer_load_dwordx4 v[144:147], v11, s[12:15], 0 offen offset:896
  buffer_load_dwordx4 v[216:219], v11, s[16:19], 0 offen offset:896
  buffer_load_dwordx4 v[76:79], v12, s[24:27], s33 offen offset:960
  buffer_load_dwordx4 v[148:151], v11, s[12:15], 0 offen offset:960
  buffer_load_dwordx4 v[220:223], v11, s[16:19], 0 offen offset:960
  buffer_load_dwordx4 v[80:83], v12, s[24:27], s33 offen offset:1024
  buffer_load_dwordx4 v[152:155], v11, s[12:15], 0 offen offset:1024
  buffer_load_dwordx4 v[224:227], v11, s[16:19], 0 offen offset:1024
  buffer_load_dwordx4 v[84:87], v12, s[24:27], s33 offen offset:1088
  buffer_load_dwordx4 v[156:159], v11, s[12:15], 0 offen offset:1088
  buffer_load_dwordx4 v[228:231], v11, s[16:19], 0 offen offset:1088
  v_mov_b32 v232, 0x3f803f80
  v_mov_b32 v233, 0x3f803f80
  v_mov_b32 v234, 0x3f803f80
  v_mov_b32 v235, 0x3f803f80
  s_waitcnt vmcnt(52)
  v_mfma_f32_16x16x32_bf16 v[236:239], v[88:91], v[16:19], 0
  v_lshlrev_b32 v244, 16, v16
  s_waitcnt vmcnt(51)
  v_lshlrev_b32 v245, 16, v160
  v_and_b32 v246, 0xffff0000, v16
  v_and_b32 v247, 0xffff0000, v160
  v_mul_f32 v244, v244, v245
  v_mul_f32 v246, v246, v247
  v_cvt_pk_bf16_f32 v160, v244, v246
  v_lshlrev_b32 v244, 16, v17
  v_lshlrev_b32 v245, 16, v161
  v_and_b32 v246, 0xffff0000, v17
  v_and_b32 v247, 0xffff0000, v161
  v_mul_f32 v244, v244, v245
  v_mul_f32 v246, v246, v247
  v_cvt_pk_bf16_f32 v161, v244, v246
  v_lshlrev_b32 v244, 16, v18
  v_lshlrev_b32 v245, 16, v162
  v_and_b32 v246, 0xffff0000, v18
  v_and_b32 v247, 0xffff0000, v162
  v_mul_f32 v244, v244, v245
  v_mul_f32 v246, v246, v247
  v_cvt_pk_bf16_f32 v162, v244, v246
  v_lshlrev_b32 v244, 16, v19
  v_lshlrev_b32 v245, 16, v163
  v_and_b32 v246, 0xffff0000, v19
  v_and_b32 v247, 0xffff0000, v163
  v_mul_f32 v244, v244, v245
  v_mul_f32 v246, v246, v247
  v_cvt_pk_bf16_f32 v163, v244, v246
  s_nop 1
  v_mfma_f32_16x16x32_bf16 v[240:243], v[232:235], v[160:163], 0
  s_waitcnt vmcnt(49)
  v_mfma_f32_16x16x32_bf16 v[236:239], v[92:95], v[20:23], v[236:239]
  v_lshlrev_b32 v244, 16, v20
  s_waitcnt vmcnt(48)
  v_lshlrev_b32 v245, 16, v164
  v_and_b32 v246, 0xffff0000, v20
  v_and_b32 v247, 0xffff0000, v164
  v_mul_f32 v244, v244, v245
  v_mul_f32 v246, v246, v247
  v_cvt_pk_bf16_f32 v164, v244, v246
  v_lshlrev_b32 v244, 16, v21
  v_lshlrev_b32 v245, 16, v165
  v_and_b32 v246, 0xffff0000, v21
  v_and_b32 v247, 0xffff0000, v165
  v_mul_f32 v244, v244, v245
  v_mul_f32 v246, v246, v247
  v_cvt_pk_bf16_f32 v165, v244, v246
  v_lshlrev_b32 v244, 16, v22
  v_lshlrev_b32 v245, 16, v166
  v_and_b32 v246, 0xffff0000, v22
  v_and_b32 v247, 0xffff0000, v166
  v_mul_f32 v244, v244, v245
  v_mul_f32 v246, v246, v247
  v_cvt_pk_bf16_f32 v166, v244, v246
  v_lshlrev_b32 v244, 16, v23
  v_lshlrev_b32 v245, 16, v167
  v_and_b32 v246, 0xffff0000, v23
  v_and_b32 v247, 0xffff0000, v167
  v_mul_f32 v244, v244, v245
  v_mul_f32 v246, v246, v247
  v_cvt_pk_bf16_f32 v167, v244, v246
  s_nop 1
  v_mfma_f32_16x16x32_bf16 v[240:243], v[232:235], v[164:167], v[240:243]
  s_waitcnt vmcnt(46)
  v_mfma_f32_16x16x32_bf16 v[236:239], v[96:99], v[24:27], v[236:239]
  v_lshlrev_b32 v244, 16, v24
  s_waitcnt vmcnt(45)
  v_lshlrev_b32 v245, 16, v168
  v_and_b32 v246, 0xffff0000, v24
  v_and_b32 v247, 0xffff0000, v168
  v_mul_f32 v244, v244, v245
  v_mul_f32 v246, v246, v247
  v_cvt_pk_bf16_f32 v168, v244, v246
  v_lshlrev_b32 v244, 16, v25
  v_lshlrev_b32 v245, 16, v169
  v_and_b32 v246, 0xffff0000, v25
  v_and_b32 v247, 0xffff0000, v169
  v_mul_f32 v244, v244, v245
  v_mul_f32 v246, v246, v247
  v_cvt_pk_bf16_f32 v169, v244, v246
  v_lshlrev_b32 v244, 16, v26
  v_lshlrev_b32 v245, 16, v170
  v_and_b32 v246, 0xffff0000, v26
  v_and_b32 v247, 0xffff0000, v170
  v_mul_f32 v244, v244, v245
  v_mul_f32 v246, v246, v247
  v_cvt_pk_bf16_f32 v170, v244, v246
  v_lshlrev_b32 v244, 16, v27
  v_lshlrev_b32 v245, 16, v171
  v_and_b32 v246, 0xffff0000, v27
  v_and_b32 v247, 0xffff0000, v171
  v_mul_f32 v244, v244, v245
  v_mul_f32 v246, v246, v247
  v_cvt_pk_bf16_f32 v171, v244, v246
  s_nop 1
  v_mfma_f32_16x16x32_bf16 v[240:243], v[232:235], v[168:171], v[240:243]
  s_waitcnt vmcnt(43)
  v_mfma_f32_16x16x32_bf16 v[236:239], v[100:103], v[28:31], v[236:239]
  v_lshlrev_b32 v244, 16, v28
  s_waitcnt vmcnt(42)
  v_lshlrev_b32 v245, 16, v172
  v_and_b32 v246, 0xffff0000, v28
  v_and_b32 v247, 0xffff0000, v172
  v_mul_f32 v244, v244, v245
  v_mul_f32 v246, v246, v247
  v_cvt_pk_bf16_f32 v172, v244, v246
  v_lshlrev_b32 v244, 16, v29
  v_lshlrev_b32 v245, 16, v173
  v_and_b32 v246, 0xffff0000, v29
  v_and_b32 v247, 0xffff0000, v173
  v_mul_f32 v244, v244, v245
  v_mul_f32 v246, v246, v247
  v_cvt_pk_bf16_f32 v173, v244, v246
  v_lshlrev_b32 v244, 16, v30
  v_lshlrev_b32 v245, 16, v174
  v_and_b32 v246, 0xffff0000, v30
  v_and_b32 v247, 0xffff0000, v174
  v_mul_f32 v244, v244, v245
  v_mul_f32 v246, v246, v247
  v_cvt_pk_bf16_f32 v174, v244, v246
  v_lshlrev_b32 v244, 16, v31
  v_lshlrev_b32 v245, 16, v175
  v_and_b32 v246, 0xffff0000, v31
  v_and_b32 v247, 0xffff0000, v175
  v_mul_f32 v244, v244, v245
  v_mul_f32 v246, v246, v247
  v_cvt_pk_bf16_f32 v175, v244, v246
  s_nop 1
  v_mfma_f32_16x16x32_bf16 v[240:243], v[232:235], v[172:175], v[240:243]
  s_waitcnt vmcnt(40)
  v_mfma_f32_16x16x32_bf16 v[236:239], v[104:107], v[32:35], v[236:239]
  v_lshlrev_b32 v244, 16, v32
  s_waitcnt vmcnt(39)
  v_lshlrev_b32 v245, 16, v176
  v_and_b32 v246, 0xffff0000, v32
  v_and_b32 v247, 0xffff0000, v176
  v_mul_f32 v244, v244, v245
  v_mul_f32 v246, v246, v247
  v_cvt_pk_bf16_f32 v176, v244, v246
  v_lshlrev_b32 v244, 16, v33
  v_lshlrev_b32 v245, 16, v177
  v_and_b32 v246, 0xffff0000, v33
  v_and_b32 v247, 0xffff0000, v177
  v_mul_f32 v244, v244, v245
  v_mul_f32 v246, v246, v247
  v_cvt_pk_bf16_f32 v177, v244, v246
  v_lshlrev_b32 v244, 16, v34
  v_lshlrev_b32 v245, 16, v178
  v_and_b32 v246, 0xffff0000, v34
  v_and_b32 v247, 0xffff0000, v178
  v_mul_f32 v244, v244, v245
  v_mul_f32 v246, v246, v247
  v_cvt_pk_bf16_f32 v178, v244, v246
  v_lshlrev_b32 v244, 16, v35
  v_lshlrev_b32 v245, 16, v179
  v_and_b32 v246, 0xffff0000, v35
  v_and_b32 v247, 0xffff0000, v179
  v_mul_f32 v244, v244, v245
  v_mul_f32 v246, v246, v247
  v_cvt_pk_bf16_f32 v179, v244, v246
  s_nop 1
  v_mfma_f32_16x16x32_bf16 v[240:243], v[232:235], v[176:179], v[240:243]
  s_waitcnt vmcnt(37)
  v_mfma_f32_16x16x32_bf16 v[236:239], v[108:111], v[36:39], v[236:239]
  v_lshlrev_b32 v244, 16, v36
  s_waitcnt vmcnt(36)
  v_lshlrev_b32 v245, 16, v180
  v_and_b32 v246, 0xffff0000, v36
  v_and_b32 v247, 0xffff0000, v180
  v_mul_f32 v244, v244, v245
  v_mul_f32 v246, v246, v247
  v_cvt_pk_bf16_f32 v180, v244, v246
  v_lshlrev_b32 v244, 16, v37
  v_lshlrev_b32 v245, 16, v181
  v_and_b32 v246, 0xffff0000, v37
  v_and_b32 v247, 0xffff0000, v181
  v_mul_f32 v244, v244, v245
  v_mul_f32 v246, v246, v247
  v_cvt_pk_bf16_f32 v181, v244, v246
  v_lshlrev_b32 v244, 16, v38
  v_lshlrev_b32 v245, 16, v182
  v_and_b32 v246, 0xffff0000, v38
  v_and_b32 v247, 0xffff0000, v182
  v_mul_f32 v244, v244, v245
  v_mul_f32 v246, v246, v247
  v_cvt_pk_bf16_f32 v182, v244, v246
  v_lshlrev_b32 v244, 16, v39
  v_lshlrev_b32 v245, 16, v183
  v_and_b32 v246, 0xffff0000, v39
  v_and_b32 v247, 0xffff0000, v183
  v_mul_f32 v244, v244, v245
  v_mul_f32 v246, v246, v247
  v_cvt_pk_bf16_f32 v183, v244, v246
  s_nop 1
  v_mfma_f32_16x16x32_bf16 v[240:243], v[232:235], v[180:183], v[240:243]
  s_waitcnt vmcnt(34)
  v_mfma_f32_16x16x32_bf16 v[236:239], v[112:115], v[40:43], v[236:239]
  v_lshlrev_b32 v244, 16, v40
  s_waitcnt vmcnt(33)
  v_lshlrev_b32 v245, 16, v184
  v_and_b32 v246, 0xffff0000, v40
  v_and_b32 v247, 0xffff0000, v184
  v_mul_f32 v244, v244, v245
  v_mul_f32 v246, v246, v247
  v_cvt_pk_bf16_f32 v184, v244, v246
  v_lshlrev_b32 v244, 16, v41
  v_lshlrev_b32 v245, 16, v185
  v_and_b32 v246, 0xffff0000, v41
  v_and_b32 v247, 0xffff0000, v185
  v_mul_f32 v244, v244, v245
  v_mul_f32 v246, v246, v247
  v_cvt_pk_bf16_f32 v185, v244, v246
  v_lshlrev_b32 v244, 16, v42
  v_lshlrev_b32 v245, 16, v186
  v_and_b32 v246, 0xffff0000, v42
  v_and_b32 v247, 0xffff0000, v186
  v_mul_f32 v244, v244, v245
  v_mul_f32 v246, v246, v247
  v_cvt_pk_bf16_f32 v186, v244, v246
  v_lshlrev_b32 v244, 16, v43
  v_lshlrev_b32 v245, 16, v187
  v_and_b32 v246, 0xffff0000, v43
  v_and_b32 v247, 0xffff0000, v187
  v_mul_f32 v244, v244, v245
  v_mul_f32 v246, v246, v247
  v_cvt_pk_bf16_f32 v187, v244, v246
  s_nop 1
  v_mfma_f32_16x16x32_bf16 v[240:243], v[232:235], v[184:187], v[240:243]
  s_waitcnt vmcnt(31)
  v_mfma_f32_16x16x32_bf16 v[236:239], v[116:119], v[44:47], v[236:239]
  v_lshlrev_b32 v244, 16, v44
  s_waitcnt vmcnt(30)
  v_lshlrev_b32 v245, 16, v188
  v_and_b32 v246, 0xffff0000, v44
  v_and_b32 v247, 0xffff0000, v188
  v_mul_f32 v244, v244, v245
  v_mul_f32 v246, v246, v247
  v_cvt_pk_bf16_f32 v188, v244, v246
  v_lshlrev_b32 v244, 16, v45
  v_lshlrev_b32 v245, 16, v189
  v_and_b32 v246, 0xffff0000, v45
  v_and_b32 v247, 0xffff0000, v189
  v_mul_f32 v244, v244, v245
  v_mul_f32 v246, v246, v247
  v_cvt_pk_bf16_f32 v189, v244, v246
  v_lshlrev_b32 v244, 16, v46
  v_lshlrev_b32 v245, 16, v190
  v_and_b32 v246, 0xffff0000, v46
  v_and_b32 v247, 0xffff0000, v190
  v_mul_f32 v244, v244, v245
  v_mul_f32 v246, v246, v247
  v_cvt_pk_bf16_f32 v190, v244, v246
  v_lshlrev_b32 v244, 16, v47
  v_lshlrev_b32 v245, 16, v191
  v_and_b32 v246, 0xffff0000, v47
  v_and_b32 v247, 0xffff0000, v191
  v_mul_f32 v244, v244, v245
  v_mul_f32 v246, v246, v247
  v_cvt_pk_bf16_f32 v191, v244, v246
  s_nop 1
  v_mfma_f32_16x16x32_bf16 v[240:243], v[232:235], v[188:191], v[240:243]
  s_waitcnt vmcnt(28)
  v_mfma_f32_16x16x32_bf16 v[236:239], v[120:123], v[48:51], v[236:239]
  v_lshlrev_b32 v244, 16, v48
  s_waitcnt vmcnt(27)
  v_lshlrev_b32 v245, 16, v192
  v_and_b32 v246, 0xffff0000, v48
  v_and_b32 v247, 0xffff0000, v192
  v_mul_f32 v244, v244, v245
  v_mul_f32 v246, v246, v247
  v_cvt_pk_bf16_f32 v192, v244, v246
  v_lshlrev_b32 v244, 16, v49
  v_lshlrev_b32 v245, 16, v193
  v_and_b32 v246, 0xffff0000, v49
  v_and_b32 v247, 0xffff0000, v193
  v_mul_f32 v244, v244, v245
  v_mul_f32 v246, v246, v247
  v_cvt_pk_bf16_f32 v193, v244, v246
  v_lshlrev_b32 v244, 16, v50
  v_lshlrev_b32 v245, 16, v194
  v_and_b32 v246, 0xffff0000, v50
  v_and_b32 v247, 0xffff0000, v194
  v_mul_f32 v244, v244, v245
  v_mul_f32 v246, v246, v247
  v_cvt_pk_bf16_f32 v194, v244, v246
  v_lshlrev_b32 v244, 16, v51
  v_lshlrev_b32 v245, 16, v195
  v_and_b32 v246, 0xffff0000, v51
  v_and_b32 v247, 0xffff0000, v195
  v_mul_f32 v244, v244, v245
  v_mul_f32 v246, v246, v247
  v_cvt_pk_bf16_f32 v195, v244, v246
  s_nop 1
  v_mfma_f32_16x16x32_bf16 v[240:243], v[232:235], v[192:195], v[240:243]
  s_waitcnt vmcnt(25)
  v_mfma_f32_16x16x32_bf16 v[236:239], v[124:127], v[52:55], v[236:239]
  v_lshlrev_b32 v244, 16, v52
  s_waitcnt vmcnt(24)
  v_lshlrev_b32 v245, 16, v196
  v_and_b32 v246, 0xffff0000, v52
  v_and_b32 v247, 0xffff0000, v196
  v_mul_f32 v244, v244, v245
  v_mul_f32 v246, v246, v247
  v_cvt_pk_bf16_f32 v196, v244, v246
  v_lshlrev_b32 v244, 16, v53
  v_lshlrev_b32 v245, 16, v197
  v_and_b32 v246, 0xffff0000, v53
  v_and_b32 v247, 0xffff0000, v197
  v_mul_f32 v244, v244, v245
  v_mul_f32 v246, v246, v247
  v_cvt_pk_bf16_f32 v197, v244, v246
  v_lshlrev_b32 v244, 16, v54
  v_lshlrev_b32 v245, 16, v198
  v_and_b32 v246, 0xffff0000, v54
  v_and_b32 v247, 0xffff0000, v198
  v_mul_f32 v244, v244, v245
  v_mul_f32 v246, v246, v247
  v_cvt_pk_bf16_f32 v198, v244, v246
  v_lshlrev_b32 v244, 16, v55
  v_lshlrev_b32 v245, 16, v199
  v_and_b32 v246, 0xffff0000, v55
  v_and_b32 v247, 0xffff0000, v199
  v_mul_f32 v244, v244, v245
  v_mul_f32 v246, v246, v247
  v_cvt_pk_bf16_f32 v199, v244, v246
  s_nop 1
  v_mfma_f32_16x16x32_bf16 v[240:243], v[232:235], v[196:199], v[240:243]
  s_waitcnt vmcnt(22)
  v_mfma_f32_16x16x32_bf16 v[236:239], v[128:131], v[56:59], v[236:239]
  v_lshlrev_b32 v244, 16, v56
  s_waitcnt vmcnt(21)
  v_lshlrev_b32 v245, 16, v200
  v_and_b32 v246, 0xffff0000, v56
  v_and_b32 v247, 0xffff0000, v200
  v_mul_f32 v244, v244, v245
  v_mul_f32 v246, v246, v247
  v_cvt_pk_bf16_f32 v200, v244, v246
  v_lshlrev_b32 v244, 16, v57
  v_lshlrev_b32 v245, 16, v201
  v_and_b32 v246, 0xffff0000, v57
  v_and_b32 v247, 0xffff0000, v201
  v_mul_f32 v244, v244, v245
  v_mul_f32 v246, v246, v247
  v_cvt_pk_bf16_f32 v201, v244, v246
  v_lshlrev_b32 v244, 16, v58
  v_lshlrev_b32 v245, 16, v202
  v_and_b32 v246, 0xffff0000, v58
  v_and_b32 v247, 0xffff0000, v202
  v_mul_f32 v244, v244, v245
  v_mul_f32 v246, v246, v247
  v_cvt_pk_bf16_f32 v202, v244, v246
  v_lshlrev_b32 v244, 16, v59
  v_lshlrev_b32 v245, 16, v203
  v_and_b32 v246, 0xffff0000, v59
  v_and_b32 v247, 0xffff0000, v203
  v_mul_f32 v244, v244, v245
  v_mul_f32 v246, v246, v247
  v_cvt_pk_bf16_f32 v203, v244, v246
  s_nop 1
  v_mfma_f32_16x16x32_bf16 v[240:243], v[232:235], v[200:203], v[240:243]
  s_waitcnt vmcnt(19)
  v_mfma_f32_16x16x32_bf16 v[236:239], v[132:135], v[60:63], v[236:239]
  v_lshlrev_b32 v244, 16, v60
  s_waitcnt vmcnt(18)
  v_lshlrev_b32 v245, 16, v204
  v_and_b32 v246, 0xffff0000, v60
  v_and_b32 v247, 0xffff0000, v204
  v_mul_f32 v244, v244, v245
  v_mul_f32 v246, v246, v247
  v_cvt_pk_bf16_f32 v204, v244, v246
  v_lshlrev_b32 v244, 16, v61
  v_lshlrev_b32 v245, 16, v205
  v_and_b32 v246, 0xffff0000, v61
  v_and_b32 v247, 0xffff0000, v205
  v_mul_f32 v244, v244, v245
  v_mul_f32 v246, v246, v247
  v_cvt_pk_bf16_f32 v205, v244, v246
  v_lshlrev_b32 v244, 16, v62
  v_lshlrev_b32 v245, 16, v206
  v_and_b32 v246, 0xffff0000, v62
  v_and_b32 v247, 0xffff0000, v206
  v_mul_f32 v244, v244, v245
  v_mul_f32 v246, v246, v247
  v_cvt_pk_bf16_f32 v206, v244, v246
  v_lshlrev_b32 v244, 16, v63
  v_lshlrev_b32 v245, 16, v207
  v_and_b32 v246, 0xffff0000, v63
  v_and_b32 v247, 0xffff0000, v207
  v_mul_f32 v244, v244, v245
  v_mul_f32 v246, v246, v247
  v_cvt_pk_bf16_f32 v207, v244, v246
  s_nop 1
  v_mfma_f32_16x16x32_bf16 v[240:243], v[232:235], v[204:207], v[240:243]
  s_waitcnt vmcnt(16)
  v_mfma_f32_16x16x32_bf16 v[236:239], v[136:139], v[64:67], v[236:239]
  v_lshlrev_b32 v244, 16, v64
  s_waitcnt vmcnt(15)
  v_lshlrev_b32 v245, 16, v208
  v_and_b32 v246, 0xffff0000, v64
  v_and_b32 v247, 0xffff0000, v208
  v_mul_f32 v244, v244, v245
  v_mul_f32 v246, v246, v247
  v_cvt_pk_bf16_f32 v208, v244, v246
  v_lshlrev_b32 v244, 16, v65
  v_lshlrev_b32 v245, 16, v209
  v_and_b32 v246, 0xffff0000, v65
  v_and_b32 v247, 0xffff0000, v209
  v_mul_f32 v244, v244, v245
  v_mul_f32 v246, v246, v247
  v_cvt_pk_bf16_f32 v209, v244, v246
  v_lshlrev_b32 v244, 16, v66
  v_lshlrev_b32 v245, 16, v210
  v_and_b32 v246, 0xffff0000, v66
  v_and_b32 v247, 0xffff0000, v210
  v_mul_f32 v244, v244, v245
  v_mul_f32 v246, v246, v247
  v_cvt_pk_bf16_f32 v210, v244, v246
  v_lshlrev_b32 v244, 16, v67
  v_lshlrev_b32 v245, 16, v211
  v_and_b32 v246, 0xffff0000, v67
  v_and_b32 v247, 0xffff0000, v211
  v_mul_f32 v244, v244, v245
  v_mul_f32 v246, v246, v247
  v_cvt_pk_bf16_f32 v211, v244, v246
  s_nop 1
  v_mfma_f32_16x16x32_bf16 v[240:243], v[232:235], v[208:211], v[240:243]
  s_waitcnt vmcnt(13)
  v_mfma_f32_16x16x32_bf16 v[236:239], v[140:143], v[68:71], v[236:239]
  v_lshlrev_b32 v244, 16, v68
  s_waitcnt vmcnt(12)
  v_lshlrev_b32 v245, 16, v212
  v_and_b32 v246, 0xffff0000, v68
  v_and_b32 v247, 0xffff0000, v212
  v_mul_f32 v244, v244, v245
  v_mul_f32 v246, v246, v247
  v_cvt_pk_bf16_f32 v212, v244, v246
  v_lshlrev_b32 v244, 16, v69
  v_lshlrev_b32 v245, 16, v213
  v_and_b32 v246, 0xffff0000, v69
  v_and_b32 v247, 0xffff0000, v213
  v_mul_f32 v244, v244, v245
  v_mul_f32 v246, v246, v247
  v_cvt_pk_bf16_f32 v213, v244, v246
  v_lshlrev_b32 v244, 16, v70
  v_lshlrev_b32 v245, 16, v214
  v_and_b32 v246, 0xffff0000, v70
  v_and_b32 v247, 0xffff0000, v214
  v_mul_f32 v244, v244, v245
  v_mul_f32 v246, v246, v247
  v_cvt_pk_bf16_f32 v214, v244, v246
  v_lshlrev_b32 v244, 16, v71
  v_lshlrev_b32 v245, 16, v215
  v_and_b32 v246, 0xffff0000, v71
  v_and_b32 v247, 0xffff0000, v215
  v_mul_f32 v244, v244, v245
  v_mul_f32 v246, v246, v247
  v_cvt_pk_bf16_f32 v215, v244, v246
  s_nop 1
  v_mfma_f32_16x16x32_bf16 v[240:243], v[232:235], v[212:215], v[240:243]
  s_waitcnt vmcnt(10)
  v_mfma_f32_16x16x32_bf16 v[236:239], v[144:147], v[72:75], v[236:239]
  v_lshlrev_b32 v244, 16, v72
  s_waitcnt vmcnt(9)
  v_lshlrev_b32 v245, 16, v216
  v_and_b32 v246, 0xffff0000, v72
  v_and_b32 v247, 0xffff0000, v216
  v_mul_f32 v244, v244, v245
  v_mul_f32 v246, v246, v247
  v_cvt_pk_bf16_f32 v216, v244, v246
  v_lshlrev_b32 v244, 16, v73
  v_lshlrev_b32 v245, 16, v217
  v_and_b32 v246, 0xffff0000, v73
  v_and_b32 v247, 0xffff0000, v217
  v_mul_f32 v244, v244, v245
  v_mul_f32 v246, v246, v247
  v_cvt_pk_bf16_f32 v217, v244, v246
  v_lshlrev_b32 v244, 16, v74
  v_lshlrev_b32 v245, 16, v218
  v_and_b32 v246, 0xffff0000, v74
  v_and_b32 v247, 0xffff0000, v218
  v_mul_f32 v244, v244, v245
  v_mul_f32 v246, v246, v247
  v_cvt_pk_bf16_f32 v218, v244, v246
  v_lshlrev_b32 v244, 16, v75
  v_lshlrev_b32 v245, 16, v219
  v_and_b32 v246, 0xffff0000, v75
  v_and_b32 v247, 0xffff0000, v219
  v_mul_f32 v244, v244, v245
  v_mul_f32 v246, v246, v247
  v_cvt_pk_bf16_f32 v219, v244, v246
  s_nop 1
  v_mfma_f32_16x16x32_bf16 v[240:243], v[232:235], v[216:219], v[240:243]
  s_waitcnt vmcnt(7)
  v_mfma_f32_16x16x32_bf16 v[236:239], v[148:151], v[76:79], v[236:239]
  v_lshlrev_b32 v244, 16, v76
  s_waitcnt vmcnt(6)
  v_lshlrev_b32 v245, 16, v220
  v_and_b32 v246, 0xffff0000, v76
  v_and_b32 v247, 0xffff0000, v220
  v_mul_f32 v244, v244, v245
  v_mul_f32 v246, v246, v247
  v_cvt_pk_bf16_f32 v220, v244, v246
  v_lshlrev_b32 v244, 16, v77
  v_lshlrev_b32 v245, 16, v221
  v_and_b32 v246, 0xffff0000, v77
  v_and_b32 v247, 0xffff0000, v221
  v_mul_f32 v244, v244, v245
  v_mul_f32 v246, v246, v247
  v_cvt_pk_bf16_f32 v221, v244, v246
  v_lshlrev_b32 v244, 16, v78
  v_lshlrev_b32 v245, 16, v222
  v_and_b32 v246, 0xffff0000, v78
  v_and_b32 v247, 0xffff0000, v222
  v_mul_f32 v244, v244, v245
  v_mul_f32 v246, v246, v247
  v_cvt_pk_bf16_f32 v222, v244, v246
  v_lshlrev_b32 v244, 16, v79
  v_lshlrev_b32 v245, 16, v223
  v_and_b32 v246, 0xffff0000, v79
  v_and_b32 v247, 0xffff0000, v223
  v_mul_f32 v244, v244, v245
  v_mul_f32 v246, v246, v247
  v_cvt_pk_bf16_f32 v223, v244, v246
  s_nop 1
  v_mfma_f32_16x16x32_bf16 v[240:243], v[232:235], v[220:223], v[240:243]
  s_waitcnt vmcnt(4)
  v_mfma_f32_16x16x32_bf16 v[236:239], v[152:155], v[80:83], v[236:239]
  v_lshlrev_b32 v244, 16, v80
  s_waitcnt vmcnt(3)
  v_lshlrev_b32 v245, 16, v224
  v_and_b32 v246, 0xffff0000, v80
  v_and_b32 v247, 0xffff0000, v224
  v_mul_f32 v244, v244, v245
  v_mul_f32 v246, v246, v247
  v_cvt_pk_bf16_f32 v224, v244, v246
  v_lshlrev_b32 v244, 16, v81
  v_lshlrev_b32 v245, 16, v225
  v_and_b32 v246, 0xffff0000, v81
  v_and_b32 v247, 0xffff0000, v225
  v_mul_f32 v244, v244, v245
  v_mul_f32 v246, v246, v247
  v_cvt_pk_bf16_f32 v225, v244, v246
  v_lshlrev_b32 v244, 16, v82
  v_lshlrev_b32 v245, 16, v226
  v_and_b32 v246, 0xffff0000, v82
  v_and_b32 v247, 0xffff0000, v226
  v_mul_f32 v244, v244, v245
  v_mul_f32 v246, v246, v247
  v_cvt_pk_bf16_f32 v226, v244, v246
  v_lshlrev_b32 v244, 16, v83
  v_lshlrev_b32 v245, 16, v227
  v_and_b32 v246, 0xffff0000, v83
  v_and_b32 v247, 0xffff0000, v227
  v_mul_f32 v244, v244, v245
  v_mul_f32 v246, v246, v247
  v_cvt_pk_bf16_f32 v227, v244, v246
  s_nop 1
  v_mfma_f32_16x16x32_bf16 v[240:243], v[232:235], v[224:227], v[240:243]
  s_waitcnt vmcnt(1)
  v_mfma_f32_16x16x32_bf16 v[236:239], v[156:159], v[84:87], v[236:239]
  v_lshlrev_b32 v244, 16, v84
  s_waitcnt vmcnt(0)
  v_lshlrev_b32 v245, 16, v228
  v_and_b32 v246, 0xffff0000, v84
  v_and_b32 v247, 0xffff0000, v228
  v_mul_f32 v244, v244, v245
  v_mul_f32 v246, v246, v247
  v_cvt_pk_bf16_f32 v228, v244, v246
  v_lshlrev_b32 v244, 16, v85
  v_lshlrev_b32 v245, 16, v229
  v_and_b32 v246, 0xffff0000, v85
  v_and_b32 v247, 0xffff0000, v229
  v_mul_f32 v244, v244, v245
  v_mul_f32 v246, v246, v247
  v_cvt_pk_bf16_f32 v229, v244, v246
  v_lshlrev_b32 v244, 16, v86
  v_lshlrev_b32 v245, 16, v230
  v_and_b32 v246, 0xffff0000, v86
  v_and_b32 v247, 0xffff0000, v230
  v_mul_f32 v244, v244, v245
  v_mul_f32 v246, v246, v247
  v_cvt_pk_bf16_f32 v230, v244, v246
  v_lshlrev_b32 v244, 16, v87
  v_lshlrev_b32 v245, 16, v231
  v_and_b32 v246, 0xffff0000, v87
  v_and_b32 v247, 0xffff0000, v231
  v_mul_f32 v244, v244, v245
  v_mul_f32 v246, v246, v247
  v_cvt_pk_bf16_f32 v231, v244, v246
  s_nop 1
  v_mfma_f32_16x16x32_bf16 v[240:243], v[232:235], v[228:231], v[240:243]
  s_nop 7
  v_cvt_pk_bf16_f32 v244, v240, v236
  v_lshlrev_b32 v240, 16, v244
  v_and_b32 v236, 0xffff0000, v244
  v_mul_f32 v245, 0xbfb8aa3b, v240
  v_exp_f32 v245, v245
  s_nop 0
  v_add_f32 v245, 1.0, v245
  v_rcp_f32 v245, v245
  s_nop 0
  v_cvt_pk_bf16_f32 v244, v245, v246
  v_lshlrev_b32 v245, 16, v244
  v_and_b32 v246, 0xffff0000, v244
  v_ashrrev_i32 v246, 31, v236
  v_or_b32 v246, 0x80000000, v246
  v_xor_b32 v246, v246, v236
  v_and_b32 v246, 0xffff0000, v246
  s_lshl_b32 s36, s36, 4
  v_add_u32 v247, s36, v14
  v_sub_u32 v248, 0xffff, v247
  v_or_b32 v246, v246, v248
  v_lshlrev_b32 v247, 2, v247
  v_lshl_add_u32 v247, v13, 28, v247
  s_mov_b32 s36, 0x70000
  buffer_store_dword v245, v247, s[4:7], s36 offen sc1
  s_mov_b32 s36, 0x72000
  buffer_store_dword v246, v247, s[4:7], s36 offen sc1
  s_waitcnt vmcnt(0)
  s_barrier
  v_mov_b32 v244, 1
  buffer_atomic_add v244, v3, s[8:11], 0 offen offset:72
L_mod_w:
  v_mov_b32 v16, 72
L_mod_rs:
  buffer_load_dword v17, v16, s[8:11], 0 offen sc1
  s_sub_u32 s31, s31, 1
  s_cbranch_scc1 L_exit
  s_waitcnt vmcnt(0)
  v_readfirstlane_b32 s33, v17
  s_nop 0
  s_cmp_ge_u32 s33, 32
  s_cbranch_scc1 L_mod_rs_ok
  s_sleep 2
  s_branch L_mod_rs
L_mod_rs_ok:
  s_mov_b32 s36, 0x72000
  s_mov_b32 s33, 0x73000
  buffer_load_dwordx4 v[16:19], v1, s[4:7], s36 offen offset:0 sc1
  buffer_load_dwordx4 v[20:23], v1, s[4:7], s36 offen offset:1024 sc1
  buffer_load_dwordx4 v[24:27], v1, s[4:7], s36 offen offset:2048 sc1
  buffer_load_dwordx4 v[28:31], v1, s[4:7], s36 offen offset:3072 sc1
  buffer_load_dwordx4 v[32:35], v1, s[4:7], s33 offen offset:0 sc1
  buffer_load_dwordx4 v[36:39], v1, s[4:7], s33 offen offset:1024 sc1
  buffer_load_dwordx4 v[40:43], v1, s[4:7], s33 offen offset:2048 sc1
  buffer_load_dwordx4 v[44:47], v1, s[4:7], s33 offen offset:3072 sc1
  v_lshrrev_b32 v12, 2, v14
  v_and_b32 v11, 1, v14
  v_lshl_add_u32 v50, v12, 1, v11
  v_lshlrev_b32 v51, 1, v13
  v_add_u32 v52, 1, v51
  v_mov_b32 v4, 0
  v_mov_b32 v5, 0
  v_mov_b32 v6, 0
  v_mov_b32 v53, 0
  s_mov_b32 s37, 0
  s_waitcnt vmcnt(0)
L_mod_top:
  v_max3_u32 v48, v16, v17, v18
  v_max3_u32 v48, v48, v19, v20
  v_max3_u32 v48, v48, v21, v22
  v_max3_u32 v48, v48, v23, v24
  v_max3_u32 v48, v48, v25, v26
  v_max3_u32 v48, v48, v27, v28
  v_max3_u32 v48, v48, v29, v30
  v_max3_u32 v48, v48, v31, v32
  v_max3_u32 v48, v48, v33, v34
  v_max3_u32 v48, v48, v35, v36
  v_max3_u32 v48, v48, v37, v38
  v_max3_u32 v48, v48, v39, v40
  v_max3_u32 v48, v48, v41, v42
  v_max3_u32 v48, v48, v43, v44
  v_max3_u32 v48, v48, v45, v46
  v_max_u32 v48, v48, v47
  s_nop 1
  v_max_u32_dpp v48, v48, v48 row_ror:8 row_mask:0xf bank_mask:0xf
  s_nop 1
  v_max_u32_dpp v48, v48, v48 row_ror:4 row_mask:0xf bank_mask:0xf
  s_nop 1
  v_max_u32_dpp v48, v48, v48 row_ror:2 row_mask:0xf bank_mask:0xf
  s_nop 1
  v_max_u32_dpp v48, v48, v48 row_ror:1 row_mask:0xf bank_mask:0xf
  v_mov_b32 v49, v48
  s_nop 1
  v_permlane16_swap_b32 v49, v48
  v_max_u32 v48, v48, v49
  v_mov_b32 v49, v48
  s_nop 1
  v_permlane32_swap_b32 v49, v48
  v_max_u32 v48, v48, v49
  v_cmp_ne_u32 vcc, v48, v16
  s_nop 1
  v_cndmask_b32 v16, 0, v16, vcc
  v_cmp_ne_u32 vcc, v48, v17
  s_nop 1
  v_cndmask_b32 v17, 0, v17, vcc
  v_cmp_ne_u32 vcc, v48, v18
  s_nop 1
  v_cndmask_b32 v18, 0, v18, vcc
  v_cmp_ne_u32 vcc, v48, v19
  s_nop 1
  v_cndmask_b32 v19, 0, v19, vcc
  v_cmp_ne_u32 vcc, v48, v20
  s_nop 1
  v_cndmask_b32 v20, 0, v20, vcc
  v_cmp_ne_u32 vcc, v48, v21
  s_nop 1
  v_cndmask_b32 v21, 0, v21, vcc
  v_cmp_ne_u32 vcc, v48, v22
  s_nop 1
  v_cndmask_b32 v22, 0, v22, vcc
  v_cmp_ne_u32 vcc, v48, v23
  s_nop 1
  v_cndmask_b32 v23, 0, v23, vcc
  v_cmp_ne_u32 vcc, v48, v24
  s_nop 1
  v_cndmask_b32 v24, 0, v24, vcc
  v_cmp_ne_u32 vcc, v48, v25
  s_nop 1
  v_cndmask_b32 v25, 0, v25, vcc
  v_cmp_ne_u32 vcc, v48, v26
  s_nop 1
  v_cndmask_b32 v26, 0, v26, vcc
  v_cmp_ne_u32 vcc, v48, v27
  s_nop 1
  v_cndmask_b32 v27, 0, v27, vcc
  v_cmp_ne_u32 vcc, v48, v28
  s_nop 1
  v_cndmask_b32 v28, 0, v28, vcc
  v_cmp_ne_u32 vcc, v48, v29
  s_nop 1
  v_cndmask_b32 v29, 0, v29, vcc
  v_cmp_ne_u32 vcc, v48, v30
  s_nop 1
  v_cndmask_b32 v30, 0, v30, vcc
  v_cmp_ne_u32 vcc, v48, v31
  s_nop 1
  v_cndmask_b32 v31, 0, v31, vcc
  v_cmp_ne_u32 vcc, v48, v32
  s_nop 1
  v_cndmask_b32 v32, 0, v32, vcc
  v_cmp_ne_u32 vcc, v48, v33
  s_nop 1
  v_cndmask_b32 v33, 0, v33, vcc
  v_cmp_ne_u32 vcc, v48, v34
  s_nop 1
  v_cndmask_b32 v34, 0, v34, vcc
  v_cmp_ne_u32 vcc, v48, v35
  s_nop 1
  v_cndmask_b32 v35, 0, v35, vcc
  v_cmp_ne_u32 vcc, v48, v36
  s_nop 1
  v_cndmask_b32 v36, 0, v36, vcc
  v_cmp_ne_u32 vcc, v48, v37
  s_nop 1
  v_cndmask_b32 v37, 0, v37, vcc
  v_cmp_ne_u32 vcc, v48, v38
  s_nop 1
  v_cndmask_b32 v38, 0, v38, vcc
  v_cmp_ne_u32 vcc, v48, v39
  s_nop 1
  v_cndmask_b32 v39, 0, v39, vcc
  v_cmp_ne_u32 vcc, v48, v40
  s_nop 1
  v_cndmask_b32 v40, 0, v40, vcc
  v_cmp_ne_u32 vcc, v48, v41
  s_nop 1
  v_cndmask_b32 v41, 0, v41, vcc
  v_cmp_ne_u32 vcc, v48, v42
  s_nop 1
  v_cndmask_b32 v42, 0, v42, vcc
  v_cmp_ne_u32 vcc, v48, v43
  s_nop 1
  v_cndmask_b32 v43, 0, v43, vcc
  v_cmp_ne_u32 vcc, v48, v44
  s_nop 1
  v_cndmask_b32 v44, 0, v44, vcc
  v_cmp_ne_u32 vcc, v48, v45
  s_nop 1
  v_cndmask_b32 v45, 0, v45, vcc
  v_cmp_ne_u32 vcc, v48, v46
  s_nop 1
  v_cndmask_b32 v46, 0, v46, vcc
  v_cmp_ne_u32 vcc, v48, v47
  s_nop 1
  v_cndmask_b32 v47, 0, v47, vcc
  v_cmp_eq_u32 vcc, s37, v50
  s_nop 1
  v_cndmask_b32 v4, v4, v48, vcc
  v_cmp_eq_u32 vcc, s37, v51
  s_nop 1
  v_cndmask_b32 v5, v5, v48, vcc
  v_cmp_eq_u32 vcc, s37, v52
  s_nop 1
  v_cndmask_b32 v6, v6, v48, vcc
  v_cmp_eq_u32 vcc, s37, v15
  s_nop 1
  v_cndmask_b32 v53, v53, v48, vcc
  s_add_u32 s37, s37, 1
  s_cmp_lt_u32 s37, 8
  s_cbranch_scc1 L_mod_top
  v_and_b32 v53, 0xffff, v53
  v_sub_u32 v53, 0xffff, v53
  v_lshrrev_b32 v12, 3, v15
  v_min_u32 v12, 1, v12
  v_lshlrev_b32 v12, 30, v12
  v_lshl_add_u32 v12, v15, 2, v12
  s_mov_b32 s36, 0x74000
  buffer_store_dword v53, v12, s[4:7], s36 offen sc1
  v_and_b32 v4, 0xffff, v4
  v_sub_u32 v4, 0xffff, v4
  v_mul_u32_u24 v12, 1152, v4
  v_lshl_add_u32 v12, v13, 5, v12
  v_and_b32 v11, 2, v15
  v_lshl_add_u32 v12, v11, 1, v12
  buffer_load_dword v16, v12, s[24:27], 0 offen offset:0
  buffer_load_dword v17, v12, s[24:27], 0 offen offset:8
  buffer_load_dword v18, v12, s[24:27], 0 offen offset:16
  buffer_load_dword v19, v12, s[24:27], 0 offen offset:24
  buffer_load_dword v20, v12, s[24:27], 0 offen offset:128
  buffer_load_dword v21, v12, s[24:27], 0 offen offset:136
  buffer_load_dword v22, v12, s[24:27], 0 offen offset:144
  buffer_load_dword v23, v12, s[24:27], 0 offen offset:152
  buffer_load_dword v24, v12, s[24:27], 0 offen offset:256
  buffer_load_dword v25, v12, s[24:27], 0 offen offset:264
  buffer_load_dword v26, v12, s[24:27], 0 offen offset:272
  buffer_load_dword v27, v12, s[24:27], 0 offen offset:280
  buffer_load_dword v28, v12, s[24:27], 0 offen offset:384
  buffer_load_dword v29, v12, s[24:27], 0 offen offset:392
  buffer_load_dword v30, v12, s[24:27], 0 offen offset:400
  buffer_load_dword v31, v12, s[24:27], 0 offen offset:408
  buffer_load_dword v32, v12, s[24:27], 0 offen offset:512
  buffer_load_dword v33, v12, s[24:27], 0 offen offset:520
  buffer_load_dword v34, v12, s[24:27], 0 offen offset:528
  buffer_load_dword v35, v12, s[24:27], 0 offen offset:536
  buffer_load_dword v36, v12, s[24:27], 0 offen offset:640
  buffer_load_dword v37, v12, s[24:27], 0 offen offset:648
  buffer_load_dword v38, v12, s[24:27], 0 offen offset:656
  buffer_load_dword v39, v12, s[24:27], 0 offen offset:664
  buffer_load_dword v40, v12, s[24:27], 0 offen offset:768
  buffer_load_dword v41, v12, s[24:27], 0 offen offset:776
  buffer_load_dword v42, v12, s[24:27], 0 offen offset:784
  buffer_load_dword v43, v12, s[24:27], 0 offen offset:792
  buffer_load_dword v44, v12, s[24:27], 0 offen offset:896
  buffer_load_dword v45, v12, s[24:27], 0 offen offset:904
  buffer_load_dword v46, v12, s[24:27], 0 offen offset:912
  buffer_load_dword v47, v12, s[24:27], 0 offen offset:920
  buffer_load_dword v48, v12, s[24:27], 0 offen offset:1024
  buffer_load_dword v49, v12, s[24:27], 0 offen offset:1032
  buffer_load_dword v50, v12, s[24:27], 0 offen offset:1040
  buffer_load_dword v51, v12, s[24:27], 0 offen offset:1048
  s_waitcnt vmcnt(0)
  v_mov_b32 v72, 96
L_mod_ld:
  buffer_load_dword v73, v72, s[8:11], 0 offen sc1
  s_sub_u32 s31, s31, 1
  s_cbranch_scc1 L_exit
  s_waitcnt vmcnt(0)
  v_readfirstlane_b32 s33, v73
  s_nop 0
  s_cmp_ge_u32 s33, 32
  s_cbranch_scc1 L_mod_ld_ok
  s_sleep 2
  s_branch L_mod_ld
L_mod_ld_ok:
  s_mov_b32 s12, s82
  s_mov_b32 s13, s83
  s_mov_b32 s14, 0x510000
  s_mov_b32 s15, 0x20000
  s_mov_b32 s16, s84
  s_mov_b32 s17, s85
  s_mov_b32 s18, 0x510000
  s_mov_b32 s19, 0x20000
  s_mov_b32 s20, s86
  s_mov_b32 s21, s87
  s_mov_b32 s22, 0x510000
  s_mov_b32 s23, 0x20000
  s_lshr_b32 s36, s30, 1
  s_mul_i32 s37, s36, 65536
  s_add_u32 s37, s37, 32768
  s_and_b32 s33, s30, 1
  s_lshl_b32 s35, s33, 12
  s_add_u32 s35, s35, s37
  s_lshl_b32 s33, s33, 5
  v_lshrrev_b32 v67, 3, v15
  v_add_u32 v67, s33, v67
  s_lshl_b32 s38, s34, 8
  v_bfe_u32 v12, v15, 4, 1
  v_lshlrev_b32 v12, 1, v12
  v_and_b32 v11, 7, v15
  v_xor_b32 v12, v12, v11
  v_mul_u32_u24 v60, 9216, v67
  v_lshl_add_u32 v60, v12, 4, v60
  s_lshr_b32 s33, s30, 1
  s_lshl_b32 s33, s33, 7
  s_add_u32 s33, s33, s38
  v_add_u32 v60, s33, v60
  v_xor_b32 v61, 64, v60
  s_mul_i32 s38, s34, 147456
  v_bfe_u32 v12, v15, 5, 1
  v_lshlrev_b32 v12, 2, v12
  v_and_b32 v11, 7, v15
  v_xor_b32 v12, v12, v11
  v_mul_u32_u24 v62, 1152, v67
  v_lshl_add_u32 v62, v12, 4, v62
  s_lshr_b32 s33, s30, 1
  s_lshl_b32 s33, s33, 7
  s_add_u32 s33, s33, s38
  v_add_u32 v62, s33, v62
  v_lshrrev_b32 v12, 2, v14
  v_lshl_add_u32 v11, v13, 3, v12
  v_lshlrev_b32 v11, 7, v11
  v_and_b32 v10, 3, v14
  v_lshl_add_u32 v11, v10, 3, v11
  v_lshrrev_b32 v12, 1, v12
  v_and_b32 v10, 1, v13
  v_lshl_add_u32 v12, v10, 1, v12
  s_and_b32 s33, s30, 1
  s_lshl_b32 s33, s33, 1
  v_xor_b32 v12, s33, v12
  v_lshl_add_u32 v11, v12, 5, v11
  v_add_u32 v63, s37, v11
  v_xor_b32 v64, 32, v63
  v_lshlrev_b32 v66, 4, v15
  v_add_u32 v66, s35, v66
  v_lshrrev_b32 v12, 1, v15
  v_mul_u32_u24 v68, 1152, v12
  v_and_b32 v11, 1, v15
  v_lshl_add_u32 v68, v11, 4, v68
  s_lshl_b32 s33, s30, 5
  s_add_u32 s38, s38, s33
  s_add_u32 s38, s38, 1024
  v_add_u32 v68, s38, v68
  v_lshrrev_b32 v12, 3, v14
  v_lshlrev_b32 v10, 4, v12
  v_lshl_add_u32 v10, v13, 2, v10
  v_bfe_u32 v12, v14, 2, 1
  v_add_u32 v10, v10, v12
  s_lshl_b32 s38, s30, 12
  s_add_u32 s38, s38, 16384
  v_lshlrev_b32 v12, 5, v10
  v_and_b32 v11, 3, v14
  v_lshl_add_u32 v69, v11, 3, v12
  v_add_u32 v69, s38, v69
  v_bfe_u32 v12, v10, 2, 1
  s_and_b32 s33, s30, 1
  v_xor_b32 v12, s33, v12
  v_lshlrev_b32 v12, 6, v12
  v_lshl_add_u32 v12, v10, 7, v12
  v_and_b32 v11, 3, v14
  v_lshl_add_u32 v12, v11, 3, v12
  v_add_u32 v65, s37, v12
  s_add_u32 m0, s38, 0
  s_mov_b32 s36, 0
  buffer_load_dwordx4 v68, s[20:23], s36 offen lds
  s_add_u32 m0, s38, 1024
  s_mov_b32 s36, 36864
  buffer_load_dwordx4 v68, s[20:23], s36 offen lds
  s_add_u32 m0, s38, 2048
  s_mov_b32 s36, 73728
  buffer_load_dwordx4 v68, s[20:23], s36 offen lds
  s_add_u32 m0, s38, 3072
  s_mov_b32 s36, 110592
  buffer_load_dwordx4 v68, s[20:23], s36 offen lds
  s_add_u32 m0, s35, 0
  s_mov_b32 s36, 0x0
  buffer_load_dwordx4 v60, s[12:15], s36 offen  lds
  s_add_u32 m0, s35, 1024
  s_mov_b32 s36, 0x12000
  buffer_load_dwordx4 v61, s[12:15], s36 offen  lds
  s_add_u32 m0, s35, 2048
  s_mov_b32 s36, 0x24000
  buffer_load_dwordx4 v60, s[12:15], s36 offen  lds
  s_add_u32 m0, s35, 3072
  s_mov_b32 s36, 0x36000
  buffer_load_dwordx4 v61, s[12:15], s36 offen  lds
  s_add_u32 m0, s35, 8192
  s_mov_b32 s36, 0x0
  buffer_load_dwordx4 v60, s[16:19], s36 offen  lds
  s_add_u32 m0, s35, 9216
  s_mov_b32 s36, 0x12000
  buffer_load_dwordx4 v61, s[16:19], s36 offen  lds
  s_add_u32 m0, s35, 10240
  s_mov_b32 s36, 0x24000
  buffer_load_dwordx4 v60, s[16:19], s36 offen  lds
  s_add_u32 m0, s35, 11264
  s_mov_b32 s36, 0x36000
  buffer_load_dwordx4 v61, s[16:19], s36 offen  lds
  s_add_u32 m0, s35, 16384
  s_mov_b32 s36, 0x90000
  buffer_load_dwordx4 v60, s[12:15], s36 offen  lds
  s_add_u32 m0, s35, 17408
  s_mov_b32 s36, 0xa2000
  buffer_load_dwordx4 v61, s[12:15], s36 offen  lds
  s_add_u32 m0, s35, 18432
  s_mov_b32 s36, 0xb4000
  buffer_load_dwordx4 v60, s[12:15], s36 offen  lds
  s_add_u32 m0, s35, 19456
  s_mov_b32 s36, 0xc6000
  buffer_load_dwordx4 v61, s[12:15], s36 offen  lds
  s_waitcnt vmcnt(8) lgkmcnt(0)
  s_barrier
  ds_read_b64_tr_b16 a[0:1], v63 offset:0
  ds_read_b64_tr_b16 a[2:3], v63 offset:512
  ds_read_b64_tr_b16 a[4:5], v63 offset:4096
  ds_read_b64_tr_b16 a[6:7], v63 offset:4608
  ds_read_b64_tr_b16 a[8:9], v64 offset:0
  ds_read_b64_tr_b16 a[10:11], v64 offset:512
  ds_read_b64_tr_b16 a[12:13], v64 offset:4096
  ds_read_b64_tr_b16 a[14:15], v64 offset:4608
  s_add_u32 m0, s35, 24576
  s_mov_b32 s36, 0x90000
  buffer_load_dwordx4 v60, s[16:19], s36 offen  lds
  s_add_u32 m0, s35, 25600
  s_mov_b32 s36, 0xa2000
  buffer_load_dwordx4 v61, s[16:19], s36 offen  lds
  s_add_u32 m0, s35, 26624
  s_mov_b32 s36, 0xb4000
  buffer_load_dwordx4 v60, s[16:19], s36 offen  lds
  s_add_u32 m0, s35, 27648
  s_mov_b32 s36, 0xc6000
  buffer_load_dwordx4 v61, s[16:19], s36 offen  lds
  s_waitcnt vmcnt(8) lgkmcnt(0)
  s_barrier
  ds_read_b64_tr_b16 a[16:17], v63 offset:8192
  ds_read_b64_tr_b16 a[18:19], v63 offset:8704
  ds_read_b64_tr_b16 a[20:21], v63 offset:12288
  ds_read_b64_tr_b16 a[22:23], v63 offset:12800
  ds_read_b64_tr_b16 a[24:25], v64 offset:8192
  ds_read_b64_tr_b16 a[26:27], v64 offset:8704
  ds_read_b64_tr_b16 a[28:29], v64 offset:12288
  ds_read_b64_tr_b16 a[30:31], v64 offset:12800
  s_add_u32 m0, s35, 32768
  s_mov_b32 s36, 0x120000
  buffer_load_dwordx4 v60, s[12:15], s36 offen  lds
  s_add_u32 m0, s35, 33792
  s_mov_b32 s36, 0x132000
  buffer_load_dwordx4 v61, s[12:15], s36 offen  lds
  s_add_u32 m0, s35, 34816
  s_mov_b32 s36, 0x144000
  buffer_load_dwordx4 v60, s[12:15], s36 offen  lds
  s_add_u32 m0, s35, 35840
  s_mov_b32 s36, 0x156000
  buffer_load_dwordx4 v61, s[12:15], s36 offen  lds
  s_waitcnt vmcnt(8) lgkmcnt(0)
  s_barrier
  ds_read_b64_tr_b16 a[32:33], v63 offset:16384
  ds_read_b64_tr_b16 a[34:35], v63 offset:16896
  ds_read_b64_tr_b16 a[36:37], v63 offset:20480
  ds_read_b64_tr_b16 a[38:39], v63 offset:20992
  ds_read_b64_tr_b16 a[40:41], v64 offset:16384
  ds_read_b64_tr_b16 a[42:43], v64 offset:16896
  ds_read_b64_tr_b16 a[44:45], v64 offset:20480
  ds_read_b64_tr_b16 a[46:47], v64 offset:20992
  s_add_u32 m0, s35, 40960
  s_mov_b32 s36, 0x120000
  buffer_load_dwordx4 v60, s[16:19], s36 offen  lds
  s_add_u32 m0, s35, 41984
  s_mov_b32 s36, 0x132000
  buffer_load_dwordx4 v61, s[16:19], s36 offen  lds
  s_add_u32 m0, s35, 43008
  s_mov_b32 s36, 0x144000
  buffer_load_dwordx4 v60, s[16:19], s36 offen  lds
  s_add_u32 m0, s35, 44032
  s_mov_b32 s36, 0x156000
  buffer_load_dwordx4 v61, s[16:19], s36 offen  lds
  s_waitcnt vmcnt(8) lgkmcnt(0)
  s_barrier
  ds_read_b64_tr_b16 a[48:49], v63 offset:24576
  ds_read_b64_tr_b16 a[50:51], v63 offset:25088
  ds_read_b64_tr_b16 a[52:53], v63 offset:28672
  ds_read_b64_tr_b16 a[54:55], v63 offset:29184
  ds_read_b64_tr_b16 a[56:57], v64 offset:24576
  ds_read_b64_tr_b16 a[58:59], v64 offset:25088
  ds_read_b64_tr_b16 a[60:61], v64 offset:28672
  ds_read_b64_tr_b16 a[62:63], v64 offset:29184
  s_add_u32 m0, s35, 49152
  s_mov_b32 s36, 0x1b0000
  buffer_load_dwordx4 v60, s[12:15], s36 offen  lds
  s_add_u32 m0, s35, 50176
  s_mov_b32 s36, 0x1c2000
  buffer_load_dwordx4 v61, s[12:15], s36 offen  lds
  s_add_u32 m0, s35, 51200
  s_mov_b32 s36, 0x1d4000
  buffer_load_dwordx4 v60, s[12:15], s36 offen  lds
  s_add_u32 m0, s35, 52224
  s_mov_b32 s36, 0x1e6000
  buffer_load_dwordx4 v61, s[12:15], s36 offen  lds
  s_waitcnt vmcnt(8) lgkmcnt(0)
  s_barrier
  ds_read_b64_tr_b16 a[64:65], v63 offset:32768
  ds_read_b64_tr_b16 a[66:67], v63 offset:33280
  ds_read_b64_tr_b16 a[68:69], v63 offset:36864
  ds_read_b64_tr_b16 a[70:71], v63 offset:37376
  ds_read_b64_tr_b16 a[72:73], v64 offset:32768
  ds_read_b64_tr_b16 a[74:75], v64 offset:33280
  ds_read_b64_tr_b16 a[76:77], v64 offset:36864
  ds_read_b64_tr_b16 a[78:79], v64 offset:37376
  s_add_u32 m0, s35, 57344
  s_mov_b32 s36, 0x1b0000
  buffer_load_dwordx4 v60, s[16:19], s36 offen  lds
  s_add_u32 m0, s35, 58368
  s_mov_b32 s36, 0x1c2000
  buffer_load_dwordx4 v61, s[16:19], s36 offen  lds
  s_add_u32 m0, s35, 59392
  s_mov_b32 s36, 0x1d4000
  buffer_load_dwordx4 v60, s[16:19], s36 offen  lds
  s_add_u32 m0, s35, 60416
  s_mov_b32 s36, 0x1e6000
  buffer_load_dwordx4 v61, s[16:19], s36 offen  lds
  s_waitcnt vmcnt(8) lgkmcnt(0)
  s_barrier
  ds_read_b64_tr_b16 a[80:81], v63 offset:40960
  ds_read_b64_tr_b16 a[82:83], v63 offset:41472
  ds_read_b64_tr_b16 a[84:85], v63 offset:45056
  ds_read_b64_tr_b16 a[86:87], v63 offset:45568
  ds_read_b64_tr_b16 a[88:89], v64 offset:40960
  ds_read_b64_tr_b16 a[90:91], v64 offset:41472
  ds_read_b64_tr_b16 a[92:93], v64 offset:45056
  ds_read_b64_tr_b16 a[94:95], v64 offset:45568
  s_add_u32 m0, s35, 0
  s_mov_b32 s36, 0x240000
  buffer_load_dwordx4 v60, s[12:15], s36 offen  lds
  s_add_u32 m0, s35, 1024
  s_mov_b32 s36, 0x252000
  buffer_load_dwordx4 v61, s[12:15], s36 offen  lds
  s_add_u32 m0, s35, 2048
  s_mov_b32 s36, 0x264000
  buffer_load_dwordx4 v60, s[12:15], s36 offen  lds
  s_add_u32 m0, s35, 3072
  s_mov_b32 s36, 0x276000
  buffer_load_dwordx4 v61, s[12:15], s36 offen  lds
  s_waitcnt vmcnt(8) lgkmcnt(0)
  s_barrier
  ds_read_b64_tr_b16 a[96:97], v63 offset:49152
  ds_read_b64_tr_b16 a[98:99], v63 offset:49664
  ds_read_b64_tr_b16 a[100:101], v63 offset:53248
  ds_read_b64_tr_b16 a[102:103], v63 offset:53760
  ds_read_b64_tr_b16 a[104:105], v64 offset:49152
  ds_read_b64_tr_b16 a[106:107], v64 offset:49664
  ds_read_b64_tr_b16 a[108:109], v64 offset:53248
  ds_read_b64_tr_b16 a[110:111], v64 offset:53760
  s_add_u32 m0, s35, 8192
  s_mov_b32 s36, 0x240000
  buffer_load_dwordx4 v60, s[16:19], s36 offen  lds
  s_add_u32 m0, s35, 9216
  s_mov_b32 s36, 0x252000
  buffer_load_dwordx4 v61, s[16:19], s36 offen  lds
  s_add_u32 m0, s35, 10240
  s_mov_b32 s36, 0x264000
  buffer_load_dwordx4 v60, s[16:19], s36 offen  lds
  s_add_u32 m0, s35, 11264
  s_mov_b32 s36, 0x276000
  buffer_load_dwordx4 v61, s[16:19], s36 offen  lds
  s_waitcnt vmcnt(8) lgkmcnt(0)
  s_barrier
  ds_read_b64_tr_b16 a[112:113], v63 offset:57344
  ds_read_b64_tr_b16 a[114:115], v63 offset:57856
  ds_read_b64_tr_b16 a[116:117], v63 offset:61440
  ds_read_b64_tr_b16 a[118:119], v63 offset:61952
  ds_read_b64_tr_b16 a[120:121], v64 offset:57344
  ds_read_b64_tr_b16 a[122:123], v64 offset:57856
  ds_read_b64_tr_b16 a[124:125], v64 offset:61440
  ds_read_b64_tr_b16 a[126:127], v64 offset:61952
  s_add_u32 m0, s35, 16384
  s_mov_b32 s36, 0x2d0000
  buffer_load_dwordx4 v60, s[12:15], s36 offen  lds
  s_add_u32 m0, s35, 17408
  s_mov_b32 s36, 0x2e2000
  buffer_load_dwordx4 v61, s[12:15], s36 offen  lds
  s_add_u32 m0, s35, 18432
  s_mov_b32 s36, 0x2f4000
  buffer_load_dwordx4 v60, s[12:15], s36 offen  lds
  s_add_u32 m0, s35, 19456
  s_mov_b32 s36, 0x306000
  buffer_load_dwordx4 v61, s[12:15], s36 offen  lds
  s_waitcnt vmcnt(8) lgkmcnt(0)
  s_barrier
  ds_read_b64_tr_b16 a[128:129], v63 offset:0
  ds_read_b64_tr_b16 a[130:131], v63 offset:512
  ds_read_b64_tr_b16 a[132:133], v63 offset:4096
  ds_read_b64_tr_b16 a[134:135], v63 offset:4608
  ds_read_b64_tr_b16 a[136:137], v64 offset:0
  ds_read_b64_tr_b16 a[138:139], v64 offset:512
  ds_read_b64_tr_b16 a[140:141], v64 offset:4096
  ds_read_b64_tr_b16 a[142:143], v64 offset:4608
  s_add_u32 m0, s35, 24576
  s_mov_b32 s36, 0x2d0000
  buffer_load_dwordx4 v60, s[16:19], s36 offen  lds
  s_add_u32 m0, s35, 25600
  s_mov_b32 s36, 0x2e2000
  buffer_load_dwordx4 v61, s[16:19], s36 offen  lds
  s_add_u32 m0, s35, 26624
  s_mov_b32 s36, 0x2f4000
  buffer_load_dwordx4 v60, s[16:19], s36 offen  lds
  s_add_u32 m0, s35, 27648
  s_mov_b32 s36, 0x306000
  buffer_load_dwordx4 v61, s[16:19], s36 offen  lds
  s_waitcnt vmcnt(8) lgkmcnt(0)
  s_barrier
  ds_read_b64_tr_b16 a[144:145], v63 offset:8192
  ds_read_b64_tr_b16 a[146:147], v63 offset:8704
  ds_read_b64_tr_b16 a[148:149], v63 offset:12288
  ds_read_b64_tr_b16 a[150:151], v63 offset:12800
  ds_read_b64_tr_b16 a[152:153], v64 offset:8192
  ds_read_b64_tr_b16 a[154:155], v64 offset:8704
  ds_read_b64_tr_b16 a[156:157], v64 offset:12288
  ds_read_b64_tr_b16 a[158:159], v64 offset:12800
  s_add_u32 m0, s35, 32768
  s_mov_b32 s36, 0x360000
  buffer_load_dwordx4 v60, s[12:15], s36 offen  lds
  s_add_u32 m0, s35, 33792
  s_mov_b32 s36, 0x372000
  buffer_load_dwordx4 v61, s[12:15], s36 offen  lds
  s_add_u32 m0, s35, 34816
  s_mov_b32 s36, 0x384000
  buffer_load_dwordx4 v60, s[12:15], s36 offen  lds
  s_add_u32 m0, s35, 35840
  s_mov_b32 s36, 0x396000
  buffer_load_dwordx4 v61, s[12:15], s36 offen  lds
  s_waitcnt vmcnt(8) lgkmcnt(0)
  s_barrier
  ds_read_b64_tr_b16 a[160:161], v63 offset:16384
  ds_read_b64_tr_b16 a[162:163], v63 offset:16896
  ds_read_b64_tr_b16 a[164:165], v63 offset:20480
  ds_read_b64_tr_b16 a[166:167], v63 offset:20992
  ds_read_b64_tr_b16 a[168:169], v64 offset:16384
  ds_read_b64_tr_b16 a[170:171], v64 offset:16896
  ds_read_b64_tr_b16 a[172:173], v64 offset:20480
  ds_read_b64_tr_b16 a[174:175], v64 offset:20992
  s_add_u32 m0, s35, 40960
  s_mov_b32 s36, 0x360000
  buffer_load_dwordx4 v60, s[16:19], s36 offen  lds
  s_add_u32 m0, s35, 41984
  s_mov_b32 s36, 0x372000
  buffer_load_dwordx4 v61, s[16:19], s36 offen  lds
  s_add_u32 m0, s35, 43008
  s_mov_b32 s36, 0x384000
  buffer_load_dwordx4 v60, s[16:19], s36 offen  lds
  s_add_u32 m0, s35, 44032
  s_mov_b32 s36, 0x396000
  buffer_load_dwordx4 v61, s[16:19], s36 offen  lds
  s_waitcnt vmcnt(8) lgkmcnt(0)
  s_barrier
  ds_read_b64_tr_b16 a[176:177], v63 offset:24576
  ds_read_b64_tr_b16 a[178:179], v63 offset:25088
  ds_read_b64_tr_b16 a[180:181], v63 offset:28672
  ds_read_b64_tr_b16 a[182:183], v63 offset:29184
  ds_read_b64_tr_b16 a[184:185], v64 offset:24576
  ds_read_b64_tr_b16 a[186:187], v64 offset:25088
  ds_read_b64_tr_b16 a[188:189], v64 offset:28672
  ds_read_b64_tr_b16 a[190:191], v64 offset:29184
  s_add_u32 m0, s35, 49152
  s_mov_b32 s36, 0x3f0000
  buffer_load_dwordx4 v60, s[12:15], s36 offen  lds
  s_add_u32 m0, s35, 50176
  s_mov_b32 s36, 0x402000
  buffer_load_dwordx4 v61, s[12:15], s36 offen  lds
  s_add_u32 m0, s35, 51200
  s_mov_b32 s36, 0x414000
  buffer_load_dwordx4 v60, s[12:15], s36 offen  lds
  s_add_u32 m0, s35, 52224
  s_mov_b32 s36, 0x426000
  buffer_load_dwordx4 v61, s[12:15], s36 offen  lds
  s_waitcnt vmcnt(8) lgkmcnt(0)
  s_barrier
  ds_read_b64_tr_b16 a[192:193], v63 offset:32768
  ds_read_b64_tr_b16 a[194:195], v63 offset:33280
  ds_read_b64_tr_b16 a[196:197], v63 offset:36864
  ds_read_b64_tr_b16 a[198:199], v63 offset:37376
  ds_read_b64_tr_b16 a[200:201], v64 offset:32768
  ds_read_b64_tr_b16 a[202:203], v64 offset:33280
  ds_read_b64_tr_b16 a[204:205], v64 offset:36864
  ds_read_b64_tr_b16 a[206:207], v64 offset:37376
  s_add_u32 m0, s35, 57344
  s_mov_b32 s36, 0x3f0000
  buffer_load_dwordx4 v60, s[16:19], s36 offen  lds
  s_add_u32 m0, s35, 58368
  s_mov_b32 s36, 0x402000
  buffer_load_dwordx4 v61, s[16:19], s36 offen  lds
  s_add_u32 m0, s35, 59392
  s_mov_b32 s36, 0x414000
  buffer_load_dwordx4 v60, s[16:19], s36 offen  lds
  s_add_u32 m0, s35, 60416
  s_mov_b32 s36, 0x426000
  buffer_load_dwordx4 v61, s[16:19], s36 offen  lds
  s_waitcnt vmcnt(8) lgkmcnt(0)
  s_barrier
  ds_read_b64_tr_b16 a[208:209], v63 offset:40960
  ds_read_b64_tr_b16 a[210:211], v63 offset:41472
  ds_read_b64_tr_b16 a[212:213], v63 offset:45056
  ds_read_b64_tr_b16 a[214:215], v63 offset:45568
  ds_read_b64_tr_b16 a[216:217], v64 offset:40960
  ds_read_b64_tr_b16 a[218:219], v64 offset:41472
  ds_read_b64_tr_b16 a[220:221], v64 offset:45056
  ds_read_b64_tr_b16 a[222:223], v64 offset:45568
  s_add_u32 m0, s35, 0
  s_mov_b32 s36, 0x480000
  buffer_load_dwordx4 v60, s[12:15], s36 offen  lds
  s_add_u32 m0, s35, 1024
  s_mov_b32 s36, 0x492000
  buffer_load_dwordx4 v61, s[12:15], s36 offen  lds
  s_add_u32 m0, s35, 2048
  s_mov_b32 s36, 0x4a4000
  buffer_load_dwordx4 v60, s[12:15], s36 offen  lds
  s_add_u32 m0, s35, 3072
  s_mov_b32 s36, 0x4b6000
  buffer_load_dwordx4 v61, s[12:15], s36 offen  lds
  s_waitcnt vmcnt(8) lgkmcnt(0)
  s_barrier
  ds_read_b64_tr_b16 a[224:225], v63 offset:49152
  ds_read_b64_tr_b16 a[226:227], v63 offset:49664
  ds_read_b64_tr_b16 a[228:229], v63 offset:53248
  ds_read_b64_tr_b16 a[230:231], v63 offset:53760
  ds_read_b64_tr_b16 a[232:233], v64 offset:49152
  ds_read_b64_tr_b16 a[234:235], v64 offset:49664
  ds_read_b64_tr_b16 a[236:237], v64 offset:53248
  ds_read_b64_tr_b16 a[238:239], v64 offset:53760
  s_add_u32 m0, s35, 8192
  s_mov_b32 s36, 0x480000
  buffer_load_dwordx4 v60, s[16:19], s36 offen  lds
  s_add_u32 m0, s35, 9216
  s_mov_b32 s36, 0x492000
  buffer_load_dwordx4 v61, s[16:19], s36 offen  lds
  s_add_u32 m0, s35, 10240
  s_mov_b32 s36, 0x4a4000
  buffer_load_dwordx4 v60, s[16:19], s36 offen  lds
  s_add_u32 m0, s35, 11264
  s_mov_b32 s36, 0x4b6000
  buffer_load_dwordx4 v61, s[16:19], s36 offen  lds
  s_waitcnt vmcnt(8) lgkmcnt(0)
  s_barrier
  ds_read_b64_tr_b16 a[240:241], v63 offset:57344
  ds_read_b64_tr_b16 a[242:243], v63 offset:57856
  ds_read_b64_tr_b16 a[244:245], v63 offset:61440
  ds_read_b64_tr_b16 a[246:247], v63 offset:61952
  ds_read_b64_tr_b16 a[248:249], v64 offset:57344
  ds_read_b64_tr_b16 a[250:251], v64 offset:57856
  ds_read_b64_tr_b16 a[252:253], v64 offset:61440
  ds_read_b64_tr_b16 a[254:255], v64 offset:61952
  s_add_u32 m0, s35, 16384
  s_mov_b32 s36, 0x0
  buffer_load_dwordx4 v62, s[20:23], s36 offen  lds
  s_add_u32 m0, s35, 17408
  s_mov_b32 s36, 0x2400
  buffer_load_dwordx4 v62, s[20:23], s36 offen  lds
  s_add_u32 m0, s35, 18432
  s_mov_b32 s36, 0x4800
  buffer_load_dwordx4 v62, s[20:23], s36 offen  lds
  s_add_u32 m0, s35, 19456
  s_mov_b32 s36, 0x6c00
  buffer_load_dwordx4 v62, s[20:23], s36 offen  lds
  s_waitcnt vmcnt(8) lgkmcnt(0)
  s_barrier
  ds_read_b64_tr_b16 v[80:81], v63 offset:0
  ds_read_b64_tr_b16 v[82:83], v63 offset:512
  ds_read_b64_tr_b16 v[84:85], v63 offset:4096
  ds_read_b64_tr_b16 v[86:87], v63 offset:4608
  ds_read_b64_tr_b16 v[88:89], v64 offset:0
  ds_read_b64_tr_b16 v[90:91], v64 offset:512
  ds_read_b64_tr_b16 v[92:93], v64 offset:4096
  ds_read_b64_tr_b16 v[94:95], v64 offset:4608
  s_add_u32 m0, s35, 24576
  s_mov_b32 s36, 0x12000
  buffer_load_dwordx4 v62, s[20:23], s36 offen  lds
  s_add_u32 m0, s35, 25600
  s_mov_b32 s36, 0x14400
  buffer_load_dwordx4 v62, s[20:23], s36 offen  lds
  s_add_u32 m0, s35, 26624
  s_mov_b32 s36, 0x16800
  buffer_load_dwordx4 v62, s[20:23], s36 offen  lds
  s_add_u32 m0, s35, 27648
  s_mov_b32 s36, 0x18c00
  buffer_load_dwordx4 v62, s[20:23], s36 offen  lds
  s_waitcnt vmcnt(8) lgkmcnt(0)
  s_barrier
  ds_read_b64_tr_b16 v[96:97], v63 offset:8192
  ds_read_b64_tr_b16 v[98:99], v63 offset:8704
  ds_read_b64_tr_b16 v[100:101], v63 offset:12288
  ds_read_b64_tr_b16 v[102:103], v63 offset:12800
  ds_read_b64_tr_b16 v[104:105], v64 offset:8192
  ds_read_b64_tr_b16 v[106:107], v64 offset:8704
  ds_read_b64_tr_b16 v[108:109], v64 offset:12288
  ds_read_b64_tr_b16 v[110:111], v64 offset:12800
  s_add_u32 m0, s35, 32768
  s_mov_b32 s36, 0x100
  buffer_load_dwordx4 v62, s[20:23], s36 offen  lds
  s_add_u32 m0, s35, 33792
  s_mov_b32 s36, 0x2500
  buffer_load_dwordx4 v62, s[20:23], s36 offen  lds
  s_add_u32 m0, s35, 34816
  s_mov_b32 s36, 0x4900
  buffer_load_dwordx4 v62, s[20:23], s36 offen  lds
  s_add_u32 m0, s35, 35840
  s_mov_b32 s36, 0x6d00
  buffer_load_dwordx4 v62, s[20:23], s36 offen  lds
  s_waitcnt vmcnt(8) lgkmcnt(0)
  s_barrier
  ds_read_b64_tr_b16 v[112:113], v65 offset:16384
  ds_read_b64_tr_b16 v[114:115], v65 offset:16640
  ds_read_b64_tr_b16 v[116:117], v65 offset:20480
  ds_read_b64_tr_b16 v[118:119], v65 offset:20736
  ds_read_b64_tr_b16 v[120:121], v65 offset:16416
  ds_read_b64_tr_b16 v[122:123], v65 offset:16672
  ds_read_b64_tr_b16 v[124:125], v65 offset:20512
  ds_read_b64_tr_b16 v[126:127], v65 offset:20768
  s_add_u32 m0, s35, 40960
  s_mov_b32 s36, 0x12100
  buffer_load_dwordx4 v62, s[20:23], s36 offen  lds
  s_add_u32 m0, s35, 41984
  s_mov_b32 s36, 0x14500
  buffer_load_dwordx4 v62, s[20:23], s36 offen  lds
  s_add_u32 m0, s35, 43008
  s_mov_b32 s36, 0x16900
  buffer_load_dwordx4 v62, s[20:23], s36 offen  lds
  s_add_u32 m0, s35, 44032
  s_mov_b32 s36, 0x18d00
  buffer_load_dwordx4 v62, s[20:23], s36 offen  lds
  s_waitcnt vmcnt(8) lgkmcnt(0)
  s_barrier
  ds_read_b64_tr_b16 v[128:129], v65 offset:24576
  ds_read_b64_tr_b16 v[130:131], v65 offset:24832
  ds_read_b64_tr_b16 v[132:133], v65 offset:28672
  ds_read_b64_tr_b16 v[134:135], v65 offset:28928
  ds_read_b64_tr_b16 v[136:137], v65 offset:24608
  ds_read_b64_tr_b16 v[138:139], v65 offset:24864
  ds_read_b64_tr_b16 v[140:141], v65 offset:28704
  ds_read_b64_tr_b16 v[142:143], v65 offset:28960
  s_add_u32 m0, s35, 49152
  s_mov_b32 s36, 0x200
  buffer_load_dwordx4 v62, s[20:23], s36 offen  lds
  s_add_u32 m0, s35, 50176
  s_mov_b32 s36, 0x2600
  buffer_load_dwordx4 v62, s[20:23], s36 offen  lds
  s_add_u32 m0, s35, 51200
  s_mov_b32 s36, 0x4a00
  buffer_load_dwordx4 v62, s[20:23], s36 offen  lds
  s_add_u32 m0, s35, 52224
  s_mov_b32 s36, 0x6e00
  buffer_load_dwordx4 v62, s[20:23], s36 offen  lds
  s_waitcnt vmcnt(8) lgkmcnt(0)
  s_barrier
  ds_read_b64_tr_b16 v[144:145], v65 offset:32768
  ds_read_b64_tr_b16 v[146:147], v65 offset:33024
  ds_read_b64_tr_b16 v[148:149], v65 offset:36864
  ds_read_b64_tr_b16 v[150:151], v65 offset:37120
  ds_read_b64_tr_b16 v[152:153], v65 offset:32800
  ds_read_b64_tr_b16 v[154:155], v65 offset:33056
  ds_read_b64_tr_b16 v[156:157], v65 offset:36896
  ds_read_b64_tr_b16 v[158:159], v65 offset:37152
  s_add_u32 m0, s35, 57344
  s_mov_b32 s36, 0x12200
  buffer_load_dwordx4 v62, s[20:23], s36 offen  lds
  s_add_u32 m0, s35, 58368
  s_mov_b32 s36, 0x14600
  buffer_load_dwordx4 v62, s[20:23], s36 offen  lds
  s_add_u32 m0, s35, 59392
  s_mov_b32 s36, 0x16a00
  buffer_load_dwordx4 v62, s[20:23], s36 offen  lds
  s_add_u32 m0, s35, 60416
  s_mov_b32 s36, 0x18e00
  buffer_load_dwordx4 v62, s[20:23], s36 offen  lds
  s_waitcnt vmcnt(8) lgkmcnt(0)
  s_barrier
  ds_read_b64_tr_b16 v[160:161], v65 offset:40960
  ds_read_b64_tr_b16 v[162:163], v65 offset:41216
  ds_read_b64_tr_b16 v[164:165], v65 offset:45056
  ds_read_b64_tr_b16 v[166:167], v65 offset:45312
  ds_read_b64_tr_b16 v[168:169], v65 offset:40992
  ds_read_b64_tr_b16 v[170:171], v65 offset:41248
  ds_read_b64_tr_b16 v[172:173], v65 offset:45088
  ds_read_b64_tr_b16 v[174:175], v65 offset:45344
  s_add_u32 m0, s35, 0
  s_mov_b32 s36, 0x300
  buffer_load_dwordx4 v62, s[20:23], s36 offen  lds
  s_add_u32 m0, s35, 1024
  s_mov_b32 s36, 0x2700
  buffer_load_dwordx4 v62, s[20:23], s36 offen  lds
  s_add_u32 m0, s35, 2048
  s_mov_b32 s36, 0x4b00
  buffer_load_dwordx4 v62, s[20:23], s36 offen  lds
  s_add_u32 m0, s35, 3072
  s_mov_b32 s36, 0x6f00
  buffer_load_dwordx4 v62, s[20:23], s36 offen  lds
  s_waitcnt vmcnt(8) lgkmcnt(0)
  s_barrier
  ds_read_b64_tr_b16 v[176:177], v65 offset:49152
  ds_read_b64_tr_b16 v[178:179], v65 offset:49408
  ds_read_b64_tr_b16 v[180:181], v65 offset:53248
  ds_read_b64_tr_b16 v[182:183], v65 offset:53504
  ds_read_b64_tr_b16 v[184:185], v65 offset:49184
  ds_read_b64_tr_b16 v[186:187], v65 offset:49440
  ds_read_b64_tr_b16 v[188:189], v65 offset:53280
  ds_read_b64_tr_b16 v[190:191], v65 offset:53536
  s_add_u32 m0, s35, 8192
  s_mov_b32 s36, 0x12300
  buffer_load_dwordx4 v62, s[20:23], s36 offen  lds
  s_add_u32 m0, s35, 9216
  s_mov_b32 s36, 0x14700
  buffer_load_dwordx4 v62, s[20:23], s36 offen  lds
  s_add_u32 m0, s35, 10240
  s_mov_b32 s36, 0x16b00
  buffer_load_dwordx4 v62, s[20:23], s36 offen  lds
  s_add_u32 m0, s35, 11264
  s_mov_b32 s36, 0x18f00
  buffer_load_dwordx4 v62, s[20:23], s36 offen  lds
  s_waitcnt vmcnt(8) lgkmcnt(0)
  s_barrier
  ds_read_b64_tr_b16 v[192:193], v65 offset:57344
  ds_read_b64_tr_b16 v[194:195], v65 offset:57600
  ds_read_b64_tr_b16 v[196:197], v65 offset:61440
  ds_read_b64_tr_b16 v[198:199], v65 offset:61696
  ds_read_b64_tr_b16 v[200:201], v65 offset:57376
  ds_read_b64_tr_b16 v[202:203], v65 offset:57632
  ds_read_b64_tr_b16 v[204:205], v65 offset:61472
  ds_read_b64_tr_b16 v[206:207], v65 offset:61728
  s_waitcnt vmcnt(4) lgkmcnt(0)
  s_barrier
  ds_read_b64_tr_b16 v[208:209], v65 offset:0
  ds_read_b64_tr_b16 v[210:211], v65 offset:256
  ds_read_b64_tr_b16 v[212:213], v65 offset:4096
  ds_read_b64_tr_b16 v[214:215], v65 offset:4352
  ds_read_b64_tr_b16 v[216:217], v65 offset:32
  ds_read_b64_tr_b16 v[218:219], v65 offset:288
  ds_read_b64_tr_b16 v[220:221], v65 offset:4128
  ds_read_b64_tr_b16 v[222:223], v65 offset:4384
  s_waitcnt vmcnt(0) lgkmcnt(0)
  s_barrier
  ds_read_b64_tr_b16 v[224:225], v65 offset:8192
  ds_read_b64_tr_b16 v[226:227], v65 offset:8448
  ds_read_b64_tr_b16 v[228:229], v65 offset:12288
  ds_read_b64_tr_b16 v[230:231], v65 offset:12544
  ds_read_b64_tr_b16 v[232:233], v65 offset:8224
  ds_read_b64_tr_b16 v[234:235], v65 offset:8480
  ds_read_b64_tr_b16 v[236:237], v65 offset:12320
  ds_read_b64_tr_b16 v[238:239], v65 offset:12576
  s_waitcnt lgkmcnt(0)
  s_barrier
  ds_read_b64_tr_b16 v[240:241], v69 offset:0
  ds_read_b64_tr_b16 v[242:243], v69 offset:64
  ds_read_b64_tr_b16 v[244:245], v69 offset:1024
  ds_read_b64_tr_b16 v[246:247], v69 offset:1088
  ds_read_b64_tr_b16 v[248:249], v69 offset:2048
  ds_read_b64_tr_b16 v[250:251], v69 offset:2112
  ds_read_b64_tr_b16 v[252:253], v69 offset:3072
  ds_read_b64_tr_b16 v[254:255], v69 offset:3136
  v_mov_b64 v[52:53], 0
  v_mov_b64 v[54:55], 0
  v_mov_b64 v[56:57], 0
  v_mov_b64 v[58:59], 0
  v_mov_b64 v[60:61], 0
  v_mov_b64 v[62:63], 0
  v_mov_b64 v[64:65], 0
  v_mov_b64 v[66:67], 0
  v_smfmac_f32_16x16x64_bf16 v[52:55], v[16:19], a[0:7], v2
  v_smfmac_f32_16x16x64_bf16 v[56:59], v[16:19], a[8:15], v2
  v_smfmac_f32_16x16x64_bf16 v[60:63], v[16:19], a[16:23], v2
  v_smfmac_f32_16x16x64_bf16 v[64:67], v[16:19], a[24:31], v2
  v_smfmac_f32_16x16x64_bf16 v[52:55], v[20:23], a[32:39], v2
  v_smfmac_f32_16x16x64_bf16 v[56:59], v[20:23], a[40:47], v2
  v_smfmac_f32_16x16x64_bf16 v[60:63], v[20:23], a[48:55], v2
  v_smfmac_f32_16x16x64_bf16 v[64:67], v[20:23], a[56:63], v2
  v_smfmac_f32_16x16x64_bf16 v[52:55], v[24:27], a[64:71], v2
  v_smfmac_f32_16x16x64_bf16 v[56:59], v[24:27], a[72:79], v2
  v_smfmac_f32_16x16x64_bf16 v[60:63], v[24:27], a[80:87], v2
  v_smfmac_f32_16x16x64_bf16 v[64:67], v[24:27], a[88:95], v2
  v_smfmac_f32_16x16x64_bf16 v[52:55], v[28:31], a[96:103], v2
  v_smfmac_f32_16x16x64_bf16 v[56:59], v[28:31], a[104:111], v2
  v_smfmac_f32_16x16x64_bf16 v[60:63], v[28:31], a[112:119], v2
  v_smfmac_f32_16x16x64_bf16 v[64:67], v[28:31], a[120:127], v2
  v_smfmac_f32_16x16x64_bf16 v[52:55], v[32:35], a[128:135], v2
  v_smfmac_f32_16x16x64_bf16 v[56:59], v[32:35], a[136:143], v2
  v_smfmac_f32_16x16x64_bf16 v[60:63], v[32:35], a[144:151], v2
  v_smfmac_f32_16x16x64_bf16 v[64:67], v[32:35], a[152:159], v2
  v_smfmac_f32_16x16x64_bf16 v[52:55], v[36:39], a[160:167], v2
  v_smfmac_f32_16x16x64_bf16 v[56:59], v[36:39], a[168:175], v2
  v_smfmac_f32_16x16x64_bf16 v[60:63], v[36:39], a[176:183], v2
  v_smfmac_f32_16x16x64_bf16 v[64:67], v[36:39], a[184:191], v2
  v_smfmac_f32_16x16x64_bf16 v[52:55], v[40:43], a[192:199], v2
  v_smfmac_f32_16x16x64_bf16 v[56:59], v[40:43], a[200:207], v2
  v_smfmac_f32_16x16x64_bf16 v[60:63], v[40:43], a[208:215], v2
  v_smfmac_f32_16x16x64_bf16 v[64:67], v[40:43], a[216:223], v2
  v_smfmac_f32_16x16x64_bf16 v[52:55], v[44:47], a[224:231], v2
  v_smfmac_f32_16x16x64_bf16 v[56:59], v[44:47], a[232:239], v2
  v_smfmac_f32_16x16x64_bf16 v[60:63], v[44:47], a[240:247], v2
  v_smfmac_f32_16x16x64_bf16 v[64:67], v[44:47], a[248:255], v2
  v_smfmac_f32_16x16x64_bf16 v[52:55], v[48:51], v[80:87], v2
  v_smfmac_f32_16x16x64_bf16 v[56:59], v[48:51], v[88:95], v2
  v_smfmac_f32_16x16x64_bf16 v[60:63], v[48:51], v[96:103], v2
  v_smfmac_f32_16x16x64_bf16 v[64:67], v[48:51], v[104:111], v2
  v_pk_add_f32 v[52:53], v[52:53], v[54:55]
  v_pk_add_f32 v[56:57], v[56:57], v[58:59]
  v_pk_add_f32 v[60:61], v[60:61], v[62:63]
  s_nop 2
  v_pk_add_f32 v[64:65], v[64:65], v[66:67]
  v_cvt_pk_bf16_f32 v68, v52, v53
  v_lshlrev_b32 v52, 16, v68
  v_and_b32 v53, 0xffff0000, v68
  v_cvt_pk_bf16_f32 v68, v56, v57
  v_lshlrev_b32 v56, 16, v68
  v_and_b32 v57, 0xffff0000, v68
  v_cvt_pk_bf16_f32 v68, v60, v61
  v_lshlrev_b32 v60, 16, v68
  v_and_b32 v61, 0xffff0000, v68
  v_cvt_pk_bf16_f32 v68, v64, v65
  v_lshlrev_b32 v64, 16, v68
  v_and_b32 v65, 0xffff0000, v68
  v_mul_f32 v69, 0xbfb8aa3b, v52
  v_exp_f32 v69, v69
  s_nop 0
  v_add_f32 v69, 1.0, v69
  v_rcp_f32 v69, v69
  s_nop 0
  v_mul_f32 v52, v52, v69
  v_mul_f32 v69, 0xbfb8aa3b, v53
  v_exp_f32 v69, v69
  s_nop 0
  v_add_f32 v69, 1.0, v69
  v_rcp_f32 v69, v69
  s_nop 0
  v_mul_f32 v53, v53, v69
  v_cvt_pk_bf16_f32 v68, v52, v53
  v_lshlrev_b32 v52, 16, v68
  v_and_b32 v53, 0xffff0000, v68
  v_mul_f32 v52, v52, v60
  v_mul_f32 v53, v53, v61
  v_cvt_pk_bf16_f32 v70, v52, v53
  v_mul_f32 v69, 0xbfb8aa3b, v56
  v_exp_f32 v69, v69
  s_nop 0
  v_add_f32 v69, 1.0, v69
  v_rcp_f32 v69, v69
  s_nop 0
  v_mul_f32 v56, v56, v69
  v_mul_f32 v69, 0xbfb8aa3b, v57
  v_exp_f32 v69, v69
  s_nop 0
  v_add_f32 v69, 1.0, v69
  v_rcp_f32 v69, v69
  s_nop 0
  v_mul_f32 v57, v57, v69
  v_cvt_pk_bf16_f32 v68, v56, v57
  v_lshlrev_b32 v56, 16, v68
  v_and_b32 v57, 0xffff0000, v68
  v_mul_f32 v56, v56, v64
  v_mul_f32 v57, v57, v65
  v_cvt_pk_bf16_f32 v71, v56, v57
  v_lshlrev_b32 v12, 5, v14
  v_lshl_add_u32 v12, v13, 3, v12
  s_lshl_b32 s36, s30, 9
  v_add_u32 v12, s36, v12
  ds_write_b64 v12, v[70:71]
  v_lshlrev_b32 v11, 8, v13
  v_lshl_add_u32 v11, v14, 3, v11
  v_mov_b64 v[16:17], 0
  v_mov_b64 v[18:19], 0
  v_mov_b64 v[20:21], 0
  v_mov_b64 v[22:23], 0
  v_mov_b64 v[24:25], 0
  v_mov_b64 v[26:27], 0
  v_mov_b64 v[28:29], 0
  v_mov_b64 v[30:31], 0
  v_mov_b64 v[32:33], 0
  v_mov_b64 v[34:35], 0
  v_mov_b64 v[36:37], 0
  v_mov_b64 v[38:39], 0
  v_mov_b64 v[40:41], 0
  v_mov_b64 v[42:43], 0
  v_mov_b64 v[44:45], 0
  v_mov_b64 v[46:47], 0
  v_mov_b64 v[48:49], 0
  v_mov_b64 v[50:51], 0
  s_waitcnt lgkmcnt(0)
  s_barrier
  ds_read_b64_tr_b16 v[72:73], v11 offset:0
  ds_read_b64_tr_b16 v[74:75], v11 offset:128
  ds_read_b64_tr_b16 v[76:77], v11 offset:1024
  ds_read_b64_tr_b16 v[78:79], v11 offset:1152
  s_waitcnt lgkmcnt(2)
  v_smfmac_f32_16x16x64_bf16 v[16:19], v[72:75], v[112:119], v2
  s_waitcnt lgkmcnt(0)
  v_smfmac_f32_16x16x64_bf16 v[16:19], v[76:79], v[128:135], v2
  v_smfmac_f32_16x16x64_bf16 v[20:23], v[72:75], v[120:127], v2
  v_smfmac_f32_16x16x64_bf16 v[20:23], v[76:79], v[136:143], v2
  v_smfmac_f32_16x16x64_bf16 v[24:27], v[72:75], v[144:151], v2
  v_smfmac_f32_16x16x64_bf16 v[24:27], v[76:79], v[160:167], v2
  v_smfmac_f32_16x16x64_bf16 v[28:31], v[72:75], v[152:159], v2
  v_smfmac_f32_16x16x64_bf16 v[28:31], v[76:79], v[168:175], v2
  v_smfmac_f32_16x16x64_bf16 v[32:35], v[72:75], v[176:183], v2
  v_smfmac_f32_16x16x64_bf16 v[32:35], v[76:79], v[192:199], v2
  v_smfmac_f32_16x16x64_bf16 v[36:39], v[72:75], v[184:191], v2
  v_smfmac_f32_16x16x64_bf16 v[36:39], v[76:79], v[200:207], v2
  v_smfmac_f32_16x16x64_bf16 v[40:43], v[72:75], v[208:215], v2
  v_smfmac_f32_16x16x64_bf16 v[40:43], v[76:79], v[224:231], v2
  v_smfmac_f32_16x16x64_bf16 v[44:47], v[72:75], v[216:223], v2
  v_smfmac_f32_16x16x64_bf16 v[44:47], v[76:79], v[232:239], v2
  v_smfmac_f32_16x16x64_bf16 v[48:51], v[72:75], v[240:247], v2
  v_smfmac_f32_16x16x64_bf16 v[48:51], v[76:79], v[248:255], v2
  s_lshl_b32 s37, s34, 9
  s_add_u32 s37, s37, 0x100000
  s_mul_i32 s38, s30, 36864
  s_add_u32 s38, s38, s37
  v_pk_add_f32 v[16:17], v[16:17], v[18:19]
  s_add_u32 s36, s38, 0
  buffer_store_dwordx2 v[16:17], v7, s[4:7], s36 offen sc1
  v_pk_add_f32 v[20:21], v[20:21], v[22:23]
  s_add_u32 s36, s38, 18432
  buffer_store_dwordx2 v[20:21], v7, s[4:7], s36 offen sc1
  v_pk_add_f32 v[24:25], v[24:25], v[26:27]
  s_add_u32 s36, s38, 147456
  buffer_store_dwordx2 v[24:25], v7, s[4:7], s36 offen sc1
  v_pk_add_f32 v[28:29], v[28:29], v[30:31]
  s_add_u32 s36, s38, 165888
  buffer_store_dwordx2 v[28:29], v7, s[4:7], s36 offen sc1
  v_pk_add_f32 v[32:33], v[32:33], v[34:35]
  s_add_u32 s36, s38, 294912
  buffer_store_dwordx2 v[32:33], v7, s[4:7], s36 offen sc1
  v_pk_add_f32 v[36:37], v[36:37], v[38:39]
  s_add_u32 s36, s38, 313344
  buffer_store_dwordx2 v[36:37], v7, s[4:7], s36 offen sc1
  v_pk_add_f32 v[40:41], v[40:41], v[42:43]
  s_add_u32 s36, s38, 442368
  buffer_store_dwordx2 v[40:41], v7, s[4:7], s36 offen sc1
  v_pk_add_f32 v[44:45], v[44:45], v[46:47]
  s_add_u32 s36, s38, 460800
  buffer_store_dwordx2 v[44:45], v7, s[4:7], s36 offen sc1
  v_pk_add_f32 v[48:49], v[48:49], v[50:51]
  s_mul_i32 s36, s30, 18432
  s_add_u32 s36, s36, s37
  s_add_u32 s36, s36, 589824
  buffer_store_dwordx2 v[48:49], v7, s[4:7], s36 offen sc1
  s_waitcnt vmcnt(0)
  s_barrier
  v_mov_b32 v68, 1
  buffer_atomic_add v68, v3, s[8:11], 0 offen offset:80
  s_cmp_lg_u32 s30, 0
  s_cbranch_scc1 L_mod_e
  v_mov_b32 v16, 80
L_mod_m1:
  buffer_load_dword v17, v16, s[8:11], 0 offen sc1
  s_sub_u32 s31, s31, 1
  s_cbranch_scc1 L_exit
  s_waitcnt vmcnt(0)
  v_readfirstlane_b32 s33, v17
  s_nop 0
  s_cmp_ge_u32 s33, 36
  s_cbranch_scc1 L_mod_m1_ok
  s_sleep 2
  s_branch L_mod_m1
L_mod_m1_ok:
  s_mul_i32 s36, s34, 18432
  s_add_u32 s36, s36, 0x100000
  buffer_load_dwordx2 v[80:81], v7, s[4:7], s36 offen offset:0 sc1
  buffer_load_dwordx2 v[82:83], v7, s[4:7], s36 offen offset:512 sc1
  buffer_load_dwordx2 v[84:85], v7, s[4:7], s36 offen offset:1024 sc1
  buffer_load_dwordx2 v[86:87], v7, s[4:7], s36 offen offset:1536 sc1
  buffer_load_dwordx2 v[88:89], v7, s[4:7], s36 offen offset:2048 sc1
  buffer_load_dwordx2 v[90:91], v7, s[4:7], s36 offen offset:2560 sc1
  buffer_load_dwordx2 v[92:93], v7, s[4:7], s36 offen offset:3072 sc1
  buffer_load_dwordx2 v[94:95], v7, s[4:7], s36 offen offset:3584 sc1
  s_add_u32 s36, s36, 4096
  buffer_load_dwordx2 v[96:97], v7, s[4:7], s36 offen offset:0 sc1
  buffer_load_dwordx2 v[98:99], v7, s[4:7], s36 offen offset:512 sc1
  buffer_load_dwordx2 v[100:101], v7, s[4:7], s36 offen offset:1024 sc1
  buffer_load_dwordx2 v[102:103], v7, s[4:7], s36 offen offset:1536 sc1
  buffer_load_dwordx2 v[104:105], v7, s[4:7], s36 offen offset:2048 sc1
  buffer_load_dwordx2 v[106:107], v7, s[4:7], s36 offen offset:2560 sc1
  buffer_load_dwordx2 v[108:109], v7, s[4:7], s36 offen offset:3072 sc1
  buffer_load_dwordx2 v[110:111], v7, s[4:7], s36 offen offset:3584 sc1
  s_add_u32 s36, s36, 4096
  buffer_load_dwordx2 v[112:113], v7, s[4:7], s36 offen offset:0 sc1
  buffer_load_dwordx2 v[114:115], v7, s[4:7], s36 offen offset:512 sc1
  buffer_load_dwordx2 v[116:117], v7, s[4:7], s36 offen offset:1024 sc1
  buffer_load_dwordx2 v[118:119], v7, s[4:7], s36 offen offset:1536 sc1
  buffer_load_dwordx2 v[120:121], v7, s[4:7], s36 offen offset:2048 sc1
  buffer_load_dwordx2 v[122:123], v7, s[4:7], s36 offen offset:2560 sc1
  buffer_load_dwordx2 v[124:125], v7, s[4:7], s36 offen offset:3072 sc1
  buffer_load_dwordx2 v[126:127], v7, s[4:7], s36 offen offset:3584 sc1
  s_add_u32 s36, s36, 4096
  buffer_load_dwordx2 v[128:129], v7, s[4:7], s36 offen offset:0 sc1
  buffer_load_dwordx2 v[130:131], v7, s[4:7], s36 offen offset:512 sc1
  buffer_load_dwordx2 v[132:133], v7, s[4:7], s36 offen offset:1024 sc1
  buffer_load_dwordx2 v[134:135], v7, s[4:7], s36 offen offset:1536 sc1
  buffer_load_dwordx2 v[136:137], v7, s[4:7], s36 offen offset:2048 sc1
  buffer_load_dwordx2 v[138:139], v7, s[4:7], s36 offen offset:2560 sc1
  buffer_load_dwordx2 v[140:141], v7, s[4:7], s36 offen offset:3072 sc1
  buffer_load_dwordx2 v[142:143], v7, s[4:7], s36 offen offset:3584 sc1
  s_add_u32 s36, s36, 4096
  buffer_load_dwordx2 v[144:145], v7, s[4:7], s36 offen offset:0 sc1
  buffer_load_dwordx2 v[146:147], v7, s[4:7], s36 offen offset:512 sc1
  buffer_load_dwordx2 v[148:149], v7, s[4:7], s36 offen offset:1024 sc1
  buffer_load_dwordx2 v[150:151], v7, s[4:7], s36 offen offset:1536 sc1
  v_and_b32 v5, 0xffff0000, v5
  v_ashrrev_i32 v16, 31, v5
  v_not_b32 v16, v16
  v_or_b32 v16, 0x80000000, v16
  v_xor_b32 v5, v5, v16
  v_and_b32 v5, 0xffff0000, v5
  v_mul_f32 v5, 0xbfb8aa3b, v5
  v_exp_f32 v5, v5
  s_nop 0
  v_add_f32 v5, 1.0, v5
  v_rcp_f32 v5, v5
  v_and_b32 v6, 0xffff0000, v6
  v_ashrrev_i32 v16, 31, v6
  v_not_b32 v16, v16
  v_or_b32 v16, 0x80000000, v16
  v_xor_b32 v6, v6, v16
  v_and_b32 v6, 0xffff0000, v6
  v_mul_f32 v6, 0xbfb8aa3b, v6
  v_exp_f32 v6, v6
  s_nop 0
  v_add_f32 v6, 1.0, v6
  v_rcp_f32 v6, v6
  s_nop 0
  v_cvt_pk_bf16_f32 v16, v5, v6
  v_lshlrev_b32 v5, 16, v16
  v_and_b32 v6, 0xffff0000, v16
  s_waitcnt vmcnt(34)
  v_pk_add_f32 v[80:81], v[80:81], v[82:83]
  s_waitcnt vmcnt(33)
  v_pk_add_f32 v[80:81], v[80:81], v[84:85]
  s_waitcnt vmcnt(32)
  v_pk_add_f32 v[80:81], v[80:81], v[86:87]
  s_waitcnt vmcnt(31)
  v_pk_add_f32 v[80:81], v[80:81], v[88:89]
  s_waitcnt vmcnt(30)
  v_pk_add_f32 v[80:81], v[80:81], v[90:91]
  s_waitcnt vmcnt(29)
  v_pk_add_f32 v[80:81], v[80:81], v[92:93]
  s_waitcnt vmcnt(28)
  v_pk_add_f32 v[80:81], v[80:81], v[94:95]
  s_waitcnt vmcnt(27)
  v_pk_add_f32 v[80:81], v[80:81], v[96:97]
  s_waitcnt vmcnt(26)
  v_pk_add_f32 v[80:81], v[80:81], v[98:99]
  s_waitcnt vmcnt(25)
  v_pk_add_f32 v[80:81], v[80:81], v[100:101]
  s_waitcnt vmcnt(24)
  v_pk_add_f32 v[80:81], v[80:81], v[102:103]
  s_waitcnt vmcnt(23)
  v_pk_add_f32 v[80:81], v[80:81], v[104:105]
  s_waitcnt vmcnt(22)
  v_pk_add_f32 v[80:81], v[80:81], v[106:107]
  s_waitcnt vmcnt(21)
  v_pk_add_f32 v[80:81], v[80:81], v[108:109]
  s_waitcnt vmcnt(20)
  v_pk_add_f32 v[80:81], v[80:81], v[110:111]
  s_waitcnt vmcnt(19)
  v_pk_add_f32 v[80:81], v[80:81], v[112:113]
  s_waitcnt vmcnt(18)
  v_pk_add_f32 v[80:81], v[80:81], v[114:115]
  s_waitcnt vmcnt(17)
  v_pk_add_f32 v[80:81], v[80:81], v[116:117]
  s_waitcnt vmcnt(16)
  v_pk_add_f32 v[80:81], v[80:81], v[118:119]
  s_waitcnt vmcnt(15)
  v_pk_add_f32 v[80:81], v[80:81], v[120:121]
  s_waitcnt vmcnt(14)
  v_pk_add_f32 v[80:81], v[80:81], v[122:123]
  s_waitcnt vmcnt(13)
  v_pk_add_f32 v[80:81], v[80:81], v[124:125]
  s_waitcnt vmcnt(12)
  v_pk_add_f32 v[80:81], v[80:81], v[126:127]
  s_waitcnt vmcnt(11)
  v_pk_add_f32 v[80:81], v[80:81], v[128:129]
  s_waitcnt vmcnt(10)
  v_pk_add_f32 v[80:81], v[80:81], v[130:131]
  s_waitcnt vmcnt(9)
  v_pk_add_f32 v[80:81], v[80:81], v[132:133]
  s_waitcnt vmcnt(8)
  v_pk_add_f32 v[80:81], v[80:81], v[134:135]
  s_waitcnt vmcnt(7)
  v_pk_add_f32 v[80:81], v[80:81], v[136:137]
  s_waitcnt vmcnt(6)
  v_pk_add_f32 v[80:81], v[80:81], v[138:139]
  s_waitcnt vmcnt(5)
  v_pk_add_f32 v[80:81], v[80:81], v[140:141]
  s_waitcnt vmcnt(4)
  v_pk_add_f32 v[80:81], v[80:81], v[142:143]
  s_waitcnt vmcnt(3)
  v_pk_add_f32 v[80:81], v[80:81], v[144:145]
  s_waitcnt vmcnt(2)
  v_pk_add_f32 v[80:81], v[80:81], v[146:147]
  s_waitcnt vmcnt(1)
  v_pk_add_f32 v[80:81], v[80:81], v[148:149]
  s_waitcnt vmcnt(0)
  v_pk_add_f32 v[80:81], v[80:81], v[150:151]
  v_cvt_pk_bf16_f32 v16, v80, v81
  v_lshlrev_b32 v80, 16, v16
  v_and_b32 v81, 0xffff0000, v16
  v_mul_f32 v80, v80, v5
  v_mul_f32 v81, v81, v6
  v_cvt_pk_bf16_f32 v80, v80, v81
  v_mul_u32_u24 v12, 2304, v13
  v_lshl_add_u32 v12, v14, 1, v12
  s_lshl_b32 s36, s34, 5
  s_add_u32 s36, s36, 0x75000
  buffer_store_short v80, v12, s[4:7], s36 offen sc1
  buffer_store_short_d16_hi v80, v12, s[4:7], s36 offen offset:1152 sc1
  s_waitcnt vmcnt(0)
  v_mov_b32 v16, 1
  buffer_atomic_add v16, v3, s[8:11], 0 offen offset:88
L_mod_e:
  s_cmp_ge_u32 s34, 18
  s_cselect_b32 s37, 4, 3
  s_cselect_b32 s33, 18, 0
  s_sub_u32 s34, s34, s33
  s_lshl_b32 s34, s34, 6
  s_branch L_o2
L_code_end:
  s_endpgm
.section .rodata,"a"
.p2align 6
.amdhsa_kernel gated_mix__memory_aug_recurrent_mem_tr__moe_arch_mod__prompt_kernel
  .amdhsa_next_free_vgpr 512
  .amdhsa_next_free_sgpr 102
  .amdhsa_accum_offset 256
  .amdhsa_group_segment_fixed_size 0
  .amdhsa_kernarg_size 128
  .amdhsa_user_sgpr_count 2
  .amdhsa_user_sgpr_kernarg_segment_ptr 1
  .amdhsa_system_sgpr_workgroup_id_x 1
.end_amdhsa_kernel
```
